```python
import torch

def _softmax(x, axis=-1):
    return torch.softmax(x, dim=axis)
def _gelu(x):
    return torch.nn.functional.gelu(x, approximate="tanh")
def _silu(x):
    return torch.nn.functional.silu(x)
def _sigmoid(x):
    return torch.sigmoid(x)
def _layernorm(x, axis=-1, eps=1e-5):
    m = x.mean(dim=axis, keepdim=True)
    v = x.var(dim=axis, keepdim=True, unbiased=False)
    return (x - m) / torch.sqrt(v + eps)
def _scatter_add(tgt, idx, src, axis=0):
    return tgt.clone().index_add_(axis, idx, src)
def _segment_sum(src, seg, n):
    out = torch.zeros((n,) + src.shape[1:], dtype=src.dtype)
    return out.index_add_(0, seg, src)
def _pad(x, pw):
    flat = tuple(v for pair in reversed(pw) for v in pair)
    return torch.nn.functional.pad(x, flat)

kernel_name = 'concat_heads__gqa_block_cached__mha_block_cached__near_ridge'

def setup_inputs():

    _w = (lambda a: (lambda t: t.to(torch.bfloat16) if t.is_floating_point() else t)(torch.as_tensor(a)))
    def _A_setup():
        B, Sq, D = 8, 112, 576
        Hq, Hkv, Sk, Dh = 32, 16, 1024, 128
        assert Hq % Hkv == 0, (Hq, Hkv)
        return {
            "x": _w((lambda *s: torch.randn(*s, dtype=torch.bfloat16) * 0.8)(B, Sq, D)),
            "k_cache": _w((lambda *s: torch.randn(*s, dtype=torch.bfloat16) * 0.8)(B, Hkv, Sk, Dh)),
            "v_cache": _w((lambda *s: torch.randn(*s, dtype=torch.bfloat16) * 0.05)(B, Hkv, Sk, Dh)),
            "wq": _w((lambda *s: torch.randn(*s, dtype=torch.bfloat16) * 0.8)(D, Hq * Dh) * (D ** -0.5)),
            "wo": _w((lambda *s: torch.randn(*s, dtype=torch.bfloat16) * 0.05)(Hq * Dh, D) * ((Hq * Dh) ** -0.5)),
        }
    _A_in = _A_setup()

    def _B_setup():
        B, Sq, D = 8, 112, 576
        H, Sk, Dh = 32, 1024, 128
        return {
            "x": _w((lambda *s: torch.randn(*s, dtype=torch.bfloat16) * 0.8)(B, Sq, D)),
            "k_cache": _w((lambda *s: torch.randn(*s, dtype=torch.bfloat16) * 0.8)(B, H, Sk, Dh)),
            "v_cache": _w((lambda *s: torch.randn(*s, dtype=torch.bfloat16) * 0.05)(B, H, Sk, Dh)),
            "wq": _w((lambda *s: torch.randn(*s, dtype=torch.bfloat16) * 0.8)(D, H * Dh) * (D ** -0.5)),
            "wo": _w((lambda *s: torch.randn(*s, dtype=torch.bfloat16) * 0.05)(H * Dh, D) * ((H * Dh) ** -0.5)),
        }
    _B_in = _B_setup()

    return {
        "A_x": _A_in["x"],
        "A_k_cache": _A_in["k_cache"],
        "A_v_cache": _A_in["v_cache"],
        "A_wq": _A_in["wq"],
        "A_wo": _A_in["wo"],
        "B_x": _B_in["x"],
        "B_k_cache": _B_in["k_cache"],
        "B_v_cache": _B_in["v_cache"],
        "B_wq": _B_in["wq"],
        "B_wo": _B_in["wo"],
    }

def reference(A_x, A_k_cache, A_v_cache, A_wq, A_wo, B_x, B_k_cache, B_v_cache, B_wq, B_wo):
    def _A_ref(x, k_cache, v_cache, wq, wo):
        B, Sq, D = x.shape
        Hq, Dh = 32, 128
        Hkv = k_cache.shape[1]
        rep = Hq // Hkv
        q = (lambda x, *d: x.permute(*d))((x @ wq).reshape(B, Sq, Hq, Dh), 0, 2, 1, 3)
        k = (lambda x, n, axis: torch.repeat_interleave(x, n, dim=axis))(k_cache, rep, axis=1)
        v = (lambda x, n, axis: torch.repeat_interleave(x, n, dim=axis))(v_cache, rep, axis=1)
        scores = torch.einsum("bhqd,bhkd->bhqk", q, k) * (Dh ** -0.5)
        p = _softmax(scores, axis=-1)
        o = torch.einsum("bhqk,bhkd->bhqd", p, v)
        return (lambda x, *d: x.permute(*d))(o, 0, 2, 1, 3).reshape(B, Sq, Hq * Dh) @ wo

    def _B_ref(x, k_cache, v_cache, wq, wo):
        B, Sq, D = x.shape
        H, Dh = 32, 128
        q = (lambda x, *d: x.permute(*d))((x @ wq).reshape(B, Sq, H, Dh), 0, 2, 1, 3)
        scores = torch.einsum("bhqd,bhkd->bhqk", q, k_cache) * (Dh ** -0.5)
        p = _softmax(scores, axis=-1)
        o = torch.einsum("bhqk,bhkd->bhqd", p, v_cache)
        return (lambda x, *d: x.permute(*d))(o, 0, 2, 1, 3).reshape(B, Sq, H * Dh) @ wo

    a = _A_ref(A_x, A_k_cache, A_v_cache, A_wq, A_wo)
    b = _B_ref(B_x, B_k_cache, B_v_cache, B_wq, B_wo)
    return torch.concatenate([a, b], axis=-1)
```

```asm
; @launch grid=(256,1,1) block=(256,1,1) lds=163840
.amdgcn_target "amdgcn-amd-amdhsa--gfx950"
.text
  .globl concat_heads__gqa_block_cached__mha_block_cached__near_ridge_kernel
  .p2align 8
  .type concat_heads__gqa_block_cached__mha_block_cached__near_ridge_kernel,@function
concat_heads__gqa_block_cached__mha_block_cached__near_ridge_kernel:
  s_cmp_ge_u32 s2, 256
  s_cbranch_scc1 L1_end
  s_load_dwordx16 s[36:51], s[0:1], 0
  s_load_dwordx4 s[52:55], s[0:1], 64
  s_load_dwordx2 s[56:57], s[0:1], 96
  v_lshrrev_b32 v1, 6, v0
  v_and_b32 v242, 63, v0
  v_readfirstlane_b32 s20, v1
  s_load_dwordx4 s[84:87], s[0:1], 80
  s_bfe_u32 s97, s2, 0x20001
  s_bfe_u32 s23, s2, 0x10003
  s_bfe_u32 s89, s2, 0x20004
  s_lshr_b32 s96, s2, 6
  s_lshl1_add_u32 s24, s96, s23
  s_cmp_lt_u32 s24, 8
  s_cselect_b32 s23, 1, 0
  s_xor_b32 s23, s23, s2
  s_and_b32 s23, s23, 1
  s_lshl_b32 s25, s97, 2
  s_add_u32 s25, s25, s89
  s_mul_i32 s29, s89, 1
  s_add_u32 s29, s29, s24
  s_and_b32 s29, s29, 3
  s_lshl_b32 s64, s29, 19
  s_lshl_b32 s65, s29, 7
  s_lshr_b32 s21, s20, 1
  s_and_b32 s22, s20, 1
  v_and_b32 v1, 15, v242
  v_lshrrev_b32 v2, 4, v242
  v_lshrrev_b32 v3, 3, v242
  v_and_b32 v4, 7, v242
  s_lshl_b32 s29, s20, 7
  v_lshl_add_u32 v6, v3, 13, s29
  v_and_b32 v7, 1, v2
  v_lshlrev_b32 v7, 1, v7
  v_xor_b32 v7, v7, v4
  v_xor_b32 v5, 0, v7
  v_lshl_add_u32 v5, v5, 4, v6
  v_add_u32 v168, 0, v5
  v_xor_b32 v5, 4, v7
  v_lshl_add_u32 v5, v5, 4, v6
  v_add_u32 v169, 64512, v5
  v_xor_b32 v5, 0, v7
  v_lshl_add_u32 v5, v5, 4, v6
  v_add_u32 v170, 129024, v5
  v_xor_b32 v5, 4, v7
  v_lshl_add_u32 v5, v5, 4, v6
  v_add_u32 v171, 193536, v5
  s_mul_i32 s29, s20, 36864
  v_mul_u32_u24 v6, 1152, v3
  v_add_u32 v6, s29, v6
  v_lshlrev_b32 v5, 1, v2
  v_xor_b32 v5, v5, v4
  v_lshl_add_u32 v172, v5, 4, v6
  v_add_u32 v173, 8192, v172
  v_add_u32 v174, 16384, v172
  v_add_u32 v175, 24576, v172
  s_waitcnt lgkmcnt(0)
  s_cmp_eq_u32 s23, 0
  s_cselect_b32 s4, s36, s46
  s_cselect_b32 s5, s37, s47
  s_cselect_b32 s8, s42, s52
  s_cselect_b32 s9, s43, s53
  s_cselect_b32 s38, s38, s48
  s_cselect_b32 s39, s39, s49
  s_cselect_b32 s40, s40, s50
  s_cselect_b32 s41, s41, s51
  s_mul_i32 s29, s24, 129024
  s_add_u32 s4, s4, s29
  s_addc_u32 s5, s5, 0
  s_mov_b32 s6, 129024
  s_mov_b32 s7, 0x20000
  s_lshl_b32 s29, s25, 9
  s_add_u32 s8, s8, s29
  s_addc_u32 s9, s9, 0
  s_sub_u32 s10, 4718592, s29
  s_mov_b32 s11, 0x20000
  s_lshl_b32 s58, s20, 12
  s_lshl_b32 s59, s20, 14
  s_add_u32 m0, s58, 131072
  s_nop 0
  buffer_load_dwordx4 v172, s[4:7], s65 offen offset:0  lds
  buffer_load_dwordx4 v173, s[4:7], s65 offen offset:1024  lds
  buffer_load_dwordx4 v174, s[4:7], s65 offen offset:2048  lds
  buffer_load_dwordx4 v175, s[4:7], s65 offen offset:3072  lds
  s_add_u32 s65, s65, 128
  s_cmp_eq_u32 s65, 1152
  s_cselect_b32 s65, 0, s65
  s_add_u32 m0, s59, 65536
  s_nop 0
  buffer_load_dwordx4 v168, s[8:11], s64 offen offset:0  lds
  buffer_load_dwordx4 v169, s[8:11], s64 offen offset:1024  lds
  buffer_load_dwordx4 v170, s[8:11], s64 offen offset:2048  lds
  buffer_load_dwordx4 v171, s[8:11], s64 offen offset:3072  lds
  s_add_u32 s64, s64, 262144
  s_add_u32 m0, s59, 69632
  s_nop 0
  buffer_load_dwordx4 v168, s[8:11], s64 offen offset:0  lds
  buffer_load_dwordx4 v169, s[8:11], s64 offen offset:1024  lds
  buffer_load_dwordx4 v170, s[8:11], s64 offen offset:2048  lds
  buffer_load_dwordx4 v171, s[8:11], s64 offen offset:3072  lds
  s_add_u32 s64, s64, 262144
  s_cmp_eq_u32 s64, 4718592
  s_cselect_b32 s64, 0, s64
  s_add_u32 m0, s58, 147456
  s_nop 0
  buffer_load_dwordx4 v172, s[4:7], s65 offen offset:0  lds
  buffer_load_dwordx4 v173, s[4:7], s65 offen offset:1024  lds
  buffer_load_dwordx4 v174, s[4:7], s65 offen offset:2048  lds
  buffer_load_dwordx4 v175, s[4:7], s65 offen offset:3072  lds
  s_add_u32 s65, s65, 128
  s_cmp_eq_u32 s65, 1152
  s_cselect_b32 s65, 0, s65
  s_lshl_b32 s29, s24, 4
  s_add_u32 s29, s29, s25
  s_lshl_b32 s30, s29, 1
  s_add_u32 s30, s30, s21
  s_cmp_eq_u32 s23, 0
  s_cselect_b32 s29, s29, s30
  s_lshl_b32 s29, s29, 1
  s_add_u32 s29, s29, s22
  s_lshl_b32 s29, s29, 17
  s_add_u32 s32, s40, s29
  s_addc_u32 s33, s41, 0
  s_add_u32 s12, s38, s29
  s_addc_u32 s13, s39, 0
  s_cmp_gt_u32 s21, s23
  s_cselect_b32 s12, s32, s12
  s_cselect_b32 s13, s33, s13
  s_mov_b32 s14, 0x20000
  s_mov_b32 s15, 0x20000
  s_mov_b32 s34, 0x20000
  s_mov_b32 s35, 0x20000
  s_mul_i32 s29, s23, 7340032
  s_mul_i32 s30, s24, 917504
  s_add_u32 s29, s29, s30
  s_lshl_b32 s30, s25, 2
  s_add_u32 s30, s30, s20
  s_lshl_b32 s30, s30, 11
  s_add_u32 s29, s29, s30
  s_add_u32 s16, s56, s29
  s_addc_u32 s17, s57, 0
  s_sub_u32 s18, 14680064, s29
  s_mov_b32 s19, 0x20000
  s_mov_b32 s31, 0
  s_lshl_b32 s29, s22, 14
  s_lshl_b32 s30, s21, 13
  s_add_u32 s30, s30, s29
  s_cmp_eq_u32 s23, 0
  s_cselect_b32 s60, s29, s59
  s_cselect_b32 s28, s30, s59
  s_cmp_eq_u32 s23, 0
  s_cselect_b32 s68, s44, s54
  s_cselect_b32 s69, s45, s55
  s_lshl3_add_u32 s29, s97, s24
  s_lshl2_add_u32 s29, s29, s89
  s_lshl2_add_u32 s29, s29, s20
  s_mul_i32 s29, s29, 9216
  s_add_u32 s44, s68, s29
  s_addc_u32 s45, s69, 0
  s_mov_b32 s46, 9216
  s_mov_b32 s47, 0x20000
  s_mul_i32 s29, s89, 288
  s_mul_i32 s30, s97, 1179648
  s_add_u32 s29, s29, s30
  s_add_u32 s68, s68, s29
  s_addc_u32 s69, s69, 0
  s_sub_u32 s70, 4718592, s29
  s_mov_b32 s71, 0x20000
  s_lshl_b32 s30, s23, 3
  s_add_u32 s30, s30, s24
  s_mul_i32 s29, s30, 917504
  s_lshl_b32 s74, s97, 15
  s_add_u32 s29, s29, s74
  s_add_u32 s72, s56, s29
  s_addc_u32 s73, s57, 0
  s_sub_u32 s74, 917504, s74
  s_mov_b32 s75, 0x20000
  s_lshl_b32 s29, s30, 11
  s_add_u32 s29, s29, 25165824
  s_add_u32 s76, s56, s29
  s_addc_u32 s77, s57, 0
  s_mov_b32 s78, 2048
  s_mov_b32 s79, 0x20000
  s_lshl_b32 s29, s30, 4
  s_add_u32 s80, s86, s29
  s_addc_u32 s81, s87, 0
  s_mov_b32 s82, 4
  s_mov_b32 s83, 0x20000
  s_mov_b32 s98, s84
  s_mov_b32 s99, s85
  s_lshl_b32 s30, s30, 2
  s_add_u32 s30, s30, s89
  s_lshl_b32 s30, s30, 2
  s_add_u32 s30, s30, s20
  s_lshl_b32 s30, s30, 15
  s_add_u32 s30, s30, 16777216
  s_add_u32 s84, s56, s30
  s_addc_u32 s85, s57, 0
  s_mov_b32 s86, 32768
  s_mov_b32 s87, 0x20000
  s_mul_i32 s67, s20, 5
  s_min_u32 s67, s67, 13
  s_mul_i32 s96, s96, 1
  s_lshl_b32 s88, s25, 7
  s_lshl_b32 s29, s96, 2
  s_lshr_b32 s42, 0x32103210, s29
  s_and_b32 s42, s42, 0xffff
  s_and_b32 s53, s24, 0
  s_lshl_b32 s53, s53, 1
  s_add_u32 s53, s53, s89
  s_add_u32 s52, s53, 1
  s_and_b32 s52, s52, 3
  s_mul_i32 s52, s52, 0x4444
  s_or_b32 s52, s52, s42
  s_add_u32 s29, s89, 2
  s_and_b32 s29, s29, 3
  s_mul_i32 s29, s29, 0x4444
  s_or_b32 s29, s29, s42
  s_lshl_b32 s29, s29, 16
  s_or_b32 s52, s52, s29
  s_add_u32 s53, s53, 3
  s_and_b32 s53, s53, 3
  s_mul_i32 s53, s53, 0x4444
  s_or_b32 s53, s53, s42
  s_lshr_b32 s54, s42, 8
  s_xor_b32 s54, s54, 0x86486411
  s_mov_b32 s55, 0x864864
  s_lshl_b32 s29, s67, 6
  s_lshl_b32 s67, s67, 10
  v_add_u32 v6, s29, v242
  s_add_u32 s29, s12, 8192
  s_addc_u32 s30, s13, 0
  s_mov_b32 s49, 8192
  s_mov_b32 s26, 8192
  s_cmp_eq_u32 s23, 0
  s_cmov_b32 s32, s29
  s_cmov_b32 s33, s30
  s_cmov_b32 s49, 32768
  s_cmov_b32 s26, 16384
  s_add_u32 s49, s49, s28
  s_mov_b32 s50, 4096
  s_mov_b32 s27, 0x10000
  v_and_b32 v8, 31, v242
  v_lshlrev_b32 v248, 2, v8
  v_mov_b32 v249, 0
  v_add_u32 v5, 0, v6
  v_mul_u32_u24 v7, 3641, v5
  v_lshrrev_b32 v7, 16, v7
  v_mul_u32_u24 v7, 864, v7
  v_lshl_add_u32 v5, v5, 4, v7
  v_subrev_u32 v251, 0, v5
  v_add_u32 v5, 64, v6
  v_mul_u32_u24 v7, 3641, v5
  v_lshrrev_b32 v7, 16, v7
  v_mul_u32_u24 v7, 864, v7
  v_lshl_add_u32 v5, v5, 4, v7
  v_subrev_u32 v252, 1024, v5
  v_add_u32 v5, 128, v6
  v_mul_u32_u24 v7, 3641, v5
  v_lshrrev_b32 v7, 16, v7
  v_mul_u32_u24 v7, 864, v7
  v_lshl_add_u32 v5, v5, 4, v7
  v_subrev_u32 v253, 2048, v5
  v_add_u32 v5, 192, v6
  v_mul_u32_u24 v7, 3641, v5
  v_lshrrev_b32 v7, 16, v7
  v_mul_u32_u24 v7, 864, v7
  v_lshl_add_u32 v5, v5, 4, v7
  v_subrev_u32 v254, 3072, v5
  v_add_u32 v5, 256, v6
  v_mul_u32_u24 v7, 3641, v5
  v_lshrrev_b32 v7, 16, v7
  v_mul_u32_u24 v7, 864, v7
  v_lshl_add_u32 v5, v5, 4, v7
  v_subrev_u32 v255, 0, v5
  v_add_u32 v5, 0, v2
  v_lshlrev_b32 v5, 1, v5
  v_xor_b32 v5, v5, v1
  v_lshlrev_b32 v5, 4, v5
  v_lshl_add_u32 v240, v2, 8, v5
  v_add_u32 v5, 4, v2
  v_lshlrev_b32 v5, 1, v5
  v_xor_b32 v5, v5, v1
  v_lshlrev_b32 v5, 4, v5
  v_lshl_add_u32 v241, v2, 8, v5
  v_lshl_add_u32 v6, v1, 8, s60
  v_lshlrev_b32 v7, 1, v4
  v_add_u32 v5, 0, v2
  v_xor_b32 v5, v5, v7
  v_lshl_add_u32 v228, v5, 4, v6
  v_add_u32 v5, 4, v2
  v_xor_b32 v5, v5, v7
  v_lshl_add_u32 v229, v5, 4, v6
  v_add_u32 v5, 8, v2
  v_xor_b32 v5, v5, v7
  v_lshl_add_u32 v230, v5, 4, v6
  v_add_u32 v5, 12, v2
  v_xor_b32 v5, v5, v7
  v_lshl_add_u32 v231, v5, 4, v6
  v_lshrrev_b32 v7, 2, v242
  v_and_b32 v9, 3, v242
  v_lshl_add_u32 v6, v7, 8, s60
  v_lshl_add_u32 v6, v9, 3, v6
  v_add_u32 v6, 8192, v6
  v_and_b32 v8, 7, v7
  s_lshl_b32 s29, s22, 2
  v_xor_b32 v8, s29, v8
  v_xor_b32 v5, 0, v8
  v_lshl_add_u32 v232, v5, 5, v6
  v_xor_b32 v5, 1, v8
  v_lshl_add_u32 v233, v5, 5, v6
  v_xor_b32 v5, 2, v8
  v_lshl_add_u32 v234, v5, 5, v6
  v_xor_b32 v5, 3, v8
  v_lshl_add_u32 v235, v5, 5, v6
  v_xor_b32 v5, 4, v8
  v_lshl_add_u32 v236, v5, 5, v6
  v_xor_b32 v5, 5, v8
  v_lshl_add_u32 v237, v5, 5, v6
  v_xor_b32 v5, 6, v8
  v_lshl_add_u32 v238, v5, 5, v6
  v_xor_b32 v5, 7, v8
  v_lshl_add_u32 v239, v5, 5, v6
  v_and_b32 v7, 3, v7
  v_lshl_add_u32 v6, v2, 3, v7
  s_add_u32 s29, s59, 65536
  v_lshl_add_u32 v6, v6, 7, s29
  v_lshl_add_u32 v6, v9, 3, v6
  v_and_b32 v8, 3, v3
  v_xor_b32 v5, 0, v8
  v_lshl_add_u32 v176, v5, 5, v6
  v_xor_b32 v5, 1, v8
  v_lshl_add_u32 v177, v5, 5, v6
  v_xor_b32 v5, 2, v8
  v_lshl_add_u32 v178, v5, 5, v6
  v_xor_b32 v5, 3, v8
  v_lshl_add_u32 v179, v5, 5, v6
  v_lshlrev_b32 v6, 7, v1
  v_and_b32 v7, 6, v1
  v_xor_b32 v5, v7, v2
  v_lshl_add_u32 v180, v5, 4, v6
  v_xor_b32 v181, 64, v180
  v_add_u32 v182, 131072, v180
  v_add_u32 v183, 131072, v181
  s_mov_b32 s62, 0x3e0293ee
  s_mov_b32 s63, s62
  s_mul_i32 s30, s21, 28672
  s_add_u32 s30, s30, 65536
  s_lshl_b32 s61, s22, 3
  v_and_b32 v243, 15, v242
  v_lshl_add_u32 v244, v243, 8, s30
  v_bfe_u32 v245, v242, 4, 1
  v_lshl_add_u32 v244, v245, 3, v244
  v_and_b32 v243, 7, v243
  v_lshlrev_b32 v243, 1, v243
  v_lshrrev_b32 v245, 5, v242
  v_xor_b32 v243, v243, v245
  v_xor_b32 v243, s61, v243
  s_sub_u32 s30, s30, s60
  s_andn2_b32 s61, s60, 0x4000
  v_xor_b32 v245, 0, v243
  v_lshl_add_u32 v196, v245, 4, v244
  v_add_u32 v200, s30, v228
  v_xor_b32 v245, 2, v243
  v_lshl_add_u32 v197, v245, 4, v244
  v_add_u32 v201, s30, v229
  v_xor_b32 v245, 4, v243
  v_lshl_add_u32 v198, v245, 4, v244
  v_add_u32 v202, s30, v230
  v_xor_b32 v245, 6, v243
  v_lshl_add_u32 v199, v245, 4, v244
  v_add_u32 v203, s30, v231
  v_lshrrev_b32 v243, 4, v242
  v_lshl_add_u32 v204, v243, 4, s61
  v_mov_b32 v224, 0x3f803f80
  v_mov_b32 v225, 0x3f803f80
  v_mov_b32 v226, 0x3f803f80
  v_mov_b32 v227, 0x3f803f80
  v_lshlrev_b32 v148, 4, v242
  s_lshl_b32 s29, s97, 13
  v_mov_b32 v144, -1
  v_mov_b32 v145, -1
  v_mov_b32 v146, -1
  v_mov_b32 v147, -1
  s_add_u32 s30, s97, 1
  s_and_b32 s30, s30, 3
  s_lshl_b32 s30, s30, 11
  s_add_u32 s30, s30, s29
  v_add_u32 v149, s30, v148
  s_add_u32 s30, s97, 2
  s_and_b32 s30, s30, 3
  s_lshl_b32 s30, s30, 11
  s_add_u32 s30, s30, s29
  v_add_u32 v150, s30, v148
  s_add_u32 s30, s97, 3
  s_and_b32 s30, s30, 3
  s_lshl_b32 s30, s30, 11
  s_add_u32 s30, s30, s29
  v_add_u32 v151, s30, v148
  v_add_lshl_u32 v152, v242, s20, 2
  v_mov_b32 v153, 1
  s_waitcnt vmcnt(8)
  s_barrier
  ds_read_b64_tr_b16 a[0:1], v176 offset:0
  ds_read_b64_tr_b16 a[2:3], v176 offset:512
  ds_read_b64_tr_b16 a[4:5], v177 offset:0
  ds_read_b64_tr_b16 a[6:7], v177 offset:512
  ds_read_b64_tr_b16 a[8:9], v178 offset:0
  ds_read_b64_tr_b16 a[10:11], v178 offset:512
  ds_read_b64_tr_b16 a[12:13], v179 offset:0
  ds_read_b64_tr_b16 a[14:15], v179 offset:512
  ds_read_b128 a[16:19], v182 offset:0
  ds_read_b128 a[20:23], v182 offset:2048
  ds_read_b128 a[24:27], v182 offset:4096
  ds_read_b128 a[28:31], v182 offset:6144
  ds_read_b128 a[32:35], v182 offset:8192
  ds_read_b128 a[36:39], v182 offset:10240
  ds_read_b128 a[40:43], v182 offset:12288
  s_waitcnt lgkmcnt(0) vmcnt(4)
  v_mfma_f32_16x16x32_bf16 v[0:3], a[0:3], a[16:19], 0
  ds_read_b64_tr_b16 a[44:45], v176 offset:4096
  v_mfma_f32_16x16x32_bf16 v[4:7], a[4:7], a[16:19], 0
  ds_read_b64_tr_b16 a[46:47], v176 offset:4608
  s_add_u32 m0, s59, 73728
  s_nop 0
  buffer_load_dwordx4 v168, s[8:11], s64 offen offset:0  lds
  v_mfma_f32_16x16x32_bf16 v[8:11], a[8:11], a[16:19], 0
  ds_read_b64_tr_b16 a[48:49], v177 offset:4096
  v_mfma_f32_16x16x32_bf16 v[12:15], a[12:15], a[16:19], 0
  ds_read_b64_tr_b16 a[50:51], v177 offset:4608
  buffer_load_dwordx4 v169, s[8:11], s64 offen offset:1024  lds
  v_mfma_f32_16x16x32_bf16 v[16:19], a[0:3], a[20:23], 0
  ds_read_b64_tr_b16 a[52:53], v178 offset:4096
  v_mfma_f32_16x16x32_bf16 v[20:23], a[4:7], a[20:23], 0
  ds_read_b64_tr_b16 a[54:55], v178 offset:4608
  buffer_load_dwordx4 v170, s[8:11], s64 offen offset:2048  lds
  v_mfma_f32_16x16x32_bf16 v[24:27], a[8:11], a[20:23], 0
  ds_read_b64_tr_b16 a[56:57], v179 offset:4096
  v_mfma_f32_16x16x32_bf16 v[28:31], a[12:15], a[20:23], 0
  ds_read_b64_tr_b16 a[58:59], v179 offset:4608
  buffer_load_dwordx4 v171, s[8:11], s64 offen offset:3072  lds
  s_add_u32 s64, s64, 262144
  v_mfma_f32_16x16x32_bf16 v[32:35], a[0:3], a[24:27], 0
  ds_read_b128 a[60:63], v183 offset:0
  v_mfma_f32_16x16x32_bf16 v[36:39], a[4:7], a[24:27], 0
  ds_read_b128 a[64:67], v183 offset:2048
  s_add_u32 m0, s59, 77824
  s_nop 0
  buffer_load_dwordx4 v168, s[8:11], s64 offen offset:0  lds
  v_mfma_f32_16x16x32_bf16 v[40:43], a[8:11], a[24:27], 0
  ds_read_b128 a[68:71], v183 offset:4096
  v_mfma_f32_16x16x32_bf16 v[44:47], a[12:15], a[24:27], 0
  ds_read_b128 a[72:75], v183 offset:6144
  buffer_load_dwordx4 v169, s[8:11], s64 offen offset:1024  lds
  v_mfma_f32_16x16x32_bf16 v[48:51], a[0:3], a[28:31], 0
  ds_read_b128 a[76:79], v183 offset:8192
  v_mfma_f32_16x16x32_bf16 v[52:55], a[4:7], a[28:31], 0
  ds_read_b128 a[80:83], v183 offset:10240
  v_mfma_f32_16x16x32_bf16 v[56:59], a[8:11], a[28:31], 0
  ds_read_b128 a[84:87], v183 offset:12288
  buffer_load_dwordx4 v170, s[8:11], s64 offen offset:2048  lds
  v_mfma_f32_16x16x32_bf16 v[60:63], a[12:15], a[28:31], 0
  v_mfma_f32_16x16x32_bf16 v[64:67], a[0:3], a[32:35], 0
  buffer_load_dwordx4 v171, s[8:11], s64 offen offset:3072  lds
  s_add_u32 s64, s64, 262144
  s_cmp_eq_u32 s64, 4718592
  s_cselect_b32 s64, 0, s64
  v_mfma_f32_16x16x32_bf16 v[68:71], a[4:7], a[32:35], 0
  v_mfma_f32_16x16x32_bf16 v[72:75], a[8:11], a[32:35], 0
  s_add_u32 m0, s58, 0
  s_nop 0
  buffer_load_dwordx4 v172, s[4:7], s65 offen offset:0  lds
  v_mfma_f32_16x16x32_bf16 v[76:79], a[12:15], a[32:35], 0
  v_mfma_f32_16x16x32_bf16 v[80:83], a[0:3], a[36:39], 0
  buffer_load_dwordx4 v173, s[4:7], s65 offen offset:1024  lds
  v_mfma_f32_16x16x32_bf16 v[84:87], a[4:7], a[36:39], 0
  v_mfma_f32_16x16x32_bf16 v[88:91], a[8:11], a[36:39], 0
  buffer_load_dwordx4 v174, s[4:7], s65 offen offset:2048  lds
  v_mfma_f32_16x16x32_bf16 v[92:95], a[12:15], a[36:39], 0
  v_mfma_f32_16x16x32_bf16 v[96:99], a[0:3], a[40:43], 0
  buffer_load_dwordx4 v175, s[4:7], s65 offen offset:3072  lds
  s_add_u32 s65, s65, 128
  s_cmp_eq_u32 s65, 1152
  s_cselect_b32 s65, 0, s65
  v_mfma_f32_16x16x32_bf16 v[100:103], a[4:7], a[40:43], 0
  v_mfma_f32_16x16x32_bf16 v[104:107], a[8:11], a[40:43], 0
  v_mfma_f32_16x16x32_bf16 v[108:111], a[12:15], a[40:43], 0
  s_waitcnt lgkmcnt(0) vmcnt(8)
  s_barrier
  v_mfma_f32_16x16x32_bf16 v[0:3], a[44:47], a[60:63], v[0:3]
  ds_read_b64_tr_b16 a[0:1], v176 offset:8192
  v_mfma_f32_16x16x32_bf16 v[4:7], a[48:51], a[60:63], v[4:7]
  ds_read_b64_tr_b16 a[2:3], v176 offset:8704
  s_add_u32 m0, s59, 65536
  s_nop 0
  buffer_load_dwordx4 v168, s[8:11], s64 offen offset:0  lds
  v_mfma_f32_16x16x32_bf16 v[8:11], a[52:55], a[60:63], v[8:11]
  ds_read_b64_tr_b16 a[4:5], v177 offset:8192
  v_mfma_f32_16x16x32_bf16 v[12:15], a[56:59], a[60:63], v[12:15]
  ds_read_b64_tr_b16 a[6:7], v177 offset:8704
  buffer_load_dwordx4 v169, s[8:11], s64 offen offset:1024  lds
  v_mfma_f32_16x16x32_bf16 v[16:19], a[44:47], a[64:67], v[16:19]
  ds_read_b64_tr_b16 a[8:9], v178 offset:8192
  v_mfma_f32_16x16x32_bf16 v[20:23], a[48:51], a[64:67], v[20:23]
  ds_read_b64_tr_b16 a[10:11], v178 offset:8704
  v_mfma_f32_16x16x32_bf16 v[24:27], a[52:55], a[64:67], v[24:27]
  ds_read_b64_tr_b16 a[12:13], v179 offset:8192
  buffer_load_dwordx4 v170, s[8:11], s64 offen offset:2048  lds
  v_mfma_f32_16x16x32_bf16 v[28:31], a[56:59], a[64:67], v[28:31]
  ds_read_b64_tr_b16 a[14:15], v179 offset:8704
  v_mfma_f32_16x16x32_bf16 v[32:35], a[44:47], a[68:71], v[32:35]
  ds_read_b128 a[16:19], v182 offset:16384
  v_mfma_f32_16x16x32_bf16 v[36:39], a[48:51], a[68:71], v[36:39]
  ds_read_b128 a[20:23], v182 offset:18432
  buffer_load_dwordx4 v171, s[8:11], s64 offen offset:3072  lds
  s_add_u32 s64, s64, 262144
  v_mfma_f32_16x16x32_bf16 v[40:43], a[52:55], a[68:71], v[40:43]
  ds_read_b128 a[24:27], v182 offset:20480
  v_mfma_f32_16x16x32_bf16 v[44:47], a[56:59], a[68:71], v[44:47]
  ds_read_b128 a[28:31], v182 offset:22528
  v_mfma_f32_16x16x32_bf16 v[48:51], a[44:47], a[72:75], v[48:51]
  ds_read_b128 a[32:35], v182 offset:24576
  s_add_u32 m0, s59, 69632
  s_nop 0
  buffer_load_dwordx4 v168, s[8:11], s64 offen offset:0  lds
  v_mfma_f32_16x16x32_bf16 v[52:55], a[48:51], a[72:75], v[52:55]
  ds_read_b128 a[36:39], v182 offset:26624
  v_mfma_f32_16x16x32_bf16 v[56:59], a[52:55], a[72:75], v[56:59]
  ds_read_b128 a[40:43], v182 offset:28672
  v_mfma_f32_16x16x32_bf16 v[60:63], a[56:59], a[72:75], v[60:63]
  buffer_load_dwordx4 v169, s[8:11], s64 offen offset:1024  lds
  v_mfma_f32_16x16x32_bf16 v[64:67], a[44:47], a[76:79], v[64:67]
  v_mfma_f32_16x16x32_bf16 v[68:71], a[48:51], a[76:79], v[68:71]
  v_mfma_f32_16x16x32_bf16 v[72:75], a[52:55], a[76:79], v[72:75]
  buffer_load_dwordx4 v170, s[8:11], s64 offen offset:2048  lds
  v_mfma_f32_16x16x32_bf16 v[76:79], a[56:59], a[76:79], v[76:79]
  v_mfma_f32_16x16x32_bf16 v[80:83], a[44:47], a[80:83], v[80:83]
  v_mfma_f32_16x16x32_bf16 v[84:87], a[48:51], a[80:83], v[84:87]
  buffer_load_dwordx4 v171, s[8:11], s64 offen offset:3072  lds
  s_add_u32 s64, s64, 262144
  s_cmp_eq_u32 s64, 4718592
  s_cselect_b32 s64, 0, s64
  v_mfma_f32_16x16x32_bf16 v[88:91], a[52:55], a[80:83], v[88:91]
  v_mfma_f32_16x16x32_bf16 v[92:95], a[56:59], a[80:83], v[92:95]
  v_mfma_f32_16x16x32_bf16 v[96:99], a[44:47], a[84:87], v[96:99]
  buffer_store_dword v249, v248, s[76:79], s88 offen sc1
  v_mfma_f32_16x16x32_bf16 v[100:103], a[48:51], a[84:87], v[100:103]
  v_mfma_f32_16x16x32_bf16 v[104:107], a[52:55], a[84:87], v[104:107]
  v_mfma_f32_16x16x32_bf16 v[108:111], a[56:59], a[84:87], v[108:111]
  s_waitcnt lgkmcnt(0) vmcnt(13)
  v_mfma_f32_16x16x32_bf16 v[0:3], a[0:3], a[16:19], v[0:3]
  ds_read_b64_tr_b16 a[44:45], v176 offset:12288
  v_mfma_f32_16x16x32_bf16 v[4:7], a[4:7], a[16:19], v[4:7]
  ds_read_b64_tr_b16 a[46:47], v176 offset:12800
  s_add_u32 m0, s58, 16384
  s_nop 0
  buffer_load_dwordx4 v172, s[4:7], s65 offen offset:0  lds
  v_mfma_f32_16x16x32_bf16 v[8:11], a[8:11], a[16:19], v[8:11]
  ds_read_b64_tr_b16 a[48:49], v177 offset:12288
  v_mfma_f32_16x16x32_bf16 v[12:15], a[12:15], a[16:19], v[12:15]
  ds_read_b64_tr_b16 a[50:51], v177 offset:12800
  buffer_load_dwordx4 v173, s[4:7], s65 offen offset:1024  lds
  v_mfma_f32_16x16x32_bf16 v[16:19], a[0:3], a[20:23], v[16:19]
  ds_read_b64_tr_b16 a[52:53], v178 offset:12288
  v_mfma_f32_16x16x32_bf16 v[20:23], a[4:7], a[20:23], v[20:23]
  ds_read_b64_tr_b16 a[54:55], v178 offset:12800
  v_mfma_f32_16x16x32_bf16 v[24:27], a[8:11], a[20:23], v[24:27]
  ds_read_b64_tr_b16 a[56:57], v179 offset:12288
  buffer_load_dwordx4 v174, s[4:7], s65 offen offset:2048  lds
  v_mfma_f32_16x16x32_bf16 v[28:31], a[12:15], a[20:23], v[28:31]
  ds_read_b64_tr_b16 a[58:59], v179 offset:12800
  v_mfma_f32_16x16x32_bf16 v[32:35], a[0:3], a[24:27], v[32:35]
  ds_read_b128 a[60:63], v183 offset:16384
  v_mfma_f32_16x16x32_bf16 v[36:39], a[4:7], a[24:27], v[36:39]
  ds_read_b128 a[64:67], v183 offset:18432
  buffer_load_dwordx4 v175, s[4:7], s65 offen offset:3072  lds
  s_add_u32 s65, s65, 128
  s_cmp_eq_u32 s65, 1152
  s_cselect_b32 s65, 0, s65
  v_mfma_f32_16x16x32_bf16 v[40:43], a[8:11], a[24:27], v[40:43]
  ds_read_b128 a[68:71], v183 offset:20480
  v_mfma_f32_16x16x32_bf16 v[44:47], a[12:15], a[24:27], v[44:47]
  ds_read_b128 a[72:75], v183 offset:22528
  v_mfma_f32_16x16x32_bf16 v[48:51], a[0:3], a[28:31], v[48:51]
  ds_read_b128 a[76:79], v183 offset:24576
  s_add_u32 m0, s59, 73728
  s_nop 0
  buffer_load_dwordx4 v168, s[8:11], s64 offen offset:0  lds
  v_mfma_f32_16x16x32_bf16 v[52:55], a[4:7], a[28:31], v[52:55]
  ds_read_b128 a[80:83], v183 offset:26624
  v_mfma_f32_16x16x32_bf16 v[56:59], a[8:11], a[28:31], v[56:59]
  ds_read_b128 a[84:87], v183 offset:28672
  v_mfma_f32_16x16x32_bf16 v[60:63], a[12:15], a[28:31], v[60:63]
  buffer_load_dwordx4 v169, s[8:11], s64 offen offset:1024  lds
  v_mfma_f32_16x16x32_bf16 v[64:67], a[0:3], a[32:35], v[64:67]
  v_mfma_f32_16x16x32_bf16 v[68:71], a[4:7], a[32:35], v[68:71]
  v_mfma_f32_16x16x32_bf16 v[72:75], a[8:11], a[32:35], v[72:75]
  buffer_load_dwordx4 v170, s[8:11], s64 offen offset:2048  lds
  v_mfma_f32_16x16x32_bf16 v[76:79], a[12:15], a[32:35], v[76:79]
  v_mfma_f32_16x16x32_bf16 v[80:83], a[0:3], a[36:39], v[80:83]
  v_mfma_f32_16x16x32_bf16 v[84:87], a[4:7], a[36:39], v[84:87]
  buffer_load_dwordx4 v171, s[8:11], s64 offen offset:3072  lds
  s_add_u32 s64, s64, 262144
  v_mfma_f32_16x16x32_bf16 v[88:91], a[8:11], a[36:39], v[88:91]
  v_mfma_f32_16x16x32_bf16 v[92:95], a[12:15], a[36:39], v[92:95]
  v_mfma_f32_16x16x32_bf16 v[96:99], a[0:3], a[40:43], v[96:99]
  buffer_store_dwordx4 v[144:147], v149, s[84:87], 0 offen offset:0 sc1 nt
  v_mfma_f32_16x16x32_bf16 v[100:103], a[4:7], a[40:43], v[100:103]
  v_mfma_f32_16x16x32_bf16 v[104:107], a[8:11], a[40:43], v[104:107]
  v_mfma_f32_16x16x32_bf16 v[108:111], a[12:15], a[40:43], v[108:111]
  s_waitcnt lgkmcnt(0) vmcnt(14)
  s_barrier
  v_mfma_f32_16x16x32_bf16 v[0:3], a[44:47], a[60:63], v[0:3]
  ds_read_b64_tr_b16 a[0:1], v176 offset:0
  v_mfma_f32_16x16x32_bf16 v[4:7], a[48:51], a[60:63], v[4:7]
  ds_read_b64_tr_b16 a[2:3], v176 offset:512
  s_add_u32 m0, s59, 77824
  s_nop 0
  buffer_load_dwordx4 v168, s[8:11], s64 offen offset:0  lds
  v_mfma_f32_16x16x32_bf16 v[8:11], a[52:55], a[60:63], v[8:11]
  ds_read_b64_tr_b16 a[4:5], v177 offset:0
  v_mfma_f32_16x16x32_bf16 v[12:15], a[56:59], a[60:63], v[12:15]
  ds_read_b64_tr_b16 a[6:7], v177 offset:512
  buffer_load_dwordx4 v169, s[8:11], s64 offen offset:1024  lds
  v_mfma_f32_16x16x32_bf16 v[16:19], a[44:47], a[64:67], v[16:19]
  ds_read_b64_tr_b16 a[8:9], v178 offset:0
  v_mfma_f32_16x16x32_bf16 v[20:23], a[48:51], a[64:67], v[20:23]
  ds_read_b64_tr_b16 a[10:11], v178 offset:512
  v_mfma_f32_16x16x32_bf16 v[24:27], a[52:55], a[64:67], v[24:27]
  ds_read_b64_tr_b16 a[12:13], v179 offset:0
  buffer_load_dwordx4 v170, s[8:11], s64 offen offset:2048  lds
  v_mfma_f32_16x16x32_bf16 v[28:31], a[56:59], a[64:67], v[28:31]
  ds_read_b64_tr_b16 a[14:15], v179 offset:512
  v_mfma_f32_16x16x32_bf16 v[32:35], a[44:47], a[68:71], v[32:35]
  ds_read_b128 a[16:19], v180 offset:0
  v_mfma_f32_16x16x32_bf16 v[36:39], a[48:51], a[68:71], v[36:39]
  ds_read_b128 a[20:23], v180 offset:2048
  buffer_load_dwordx4 v171, s[8:11], s64 offen offset:3072  lds
  s_add_u32 s64, s64, 262144
  s_cmp_eq_u32 s64, 4718592
  s_cselect_b32 s64, 0, s64
  v_mfma_f32_16x16x32_bf16 v[40:43], a[52:55], a[68:71], v[40:43]
  ds_read_b128 a[24:27], v180 offset:4096
  v_mfma_f32_16x16x32_bf16 v[44:47], a[56:59], a[68:71], v[44:47]
  ds_read_b128 a[28:31], v180 offset:6144
  v_mfma_f32_16x16x32_bf16 v[48:51], a[44:47], a[72:75], v[48:51]
  ds_read_b128 a[32:35], v180 offset:8192
  s_add_u32 m0, s58, 32768
  s_nop 0
  buffer_load_dwordx4 v172, s[4:7], s65 offen offset:0  lds
  v_mfma_f32_16x16x32_bf16 v[52:55], a[48:51], a[72:75], v[52:55]
  ds_read_b128 a[36:39], v180 offset:10240
  v_mfma_f32_16x16x32_bf16 v[56:59], a[52:55], a[72:75], v[56:59]
  ds_read_b128 a[40:43], v180 offset:12288
  v_mfma_f32_16x16x32_bf16 v[60:63], a[56:59], a[72:75], v[60:63]
  buffer_load_dwordx4 v173, s[4:7], s65 offen offset:1024  lds
  v_mfma_f32_16x16x32_bf16 v[64:67], a[44:47], a[76:79], v[64:67]
  v_mfma_f32_16x16x32_bf16 v[68:71], a[48:51], a[76:79], v[68:71]
  v_mfma_f32_16x16x32_bf16 v[72:75], a[52:55], a[76:79], v[72:75]
  buffer_load_dwordx4 v174, s[4:7], s65 offen offset:2048  lds
  v_mfma_f32_16x16x32_bf16 v[76:79], a[56:59], a[76:79], v[76:79]
  v_mfma_f32_16x16x32_bf16 v[80:83], a[44:47], a[80:83], v[80:83]
  v_mfma_f32_16x16x32_bf16 v[84:87], a[48:51], a[80:83], v[84:87]
  buffer_load_dwordx4 v175, s[4:7], s65 offen offset:3072  lds
  s_add_u32 s65, s65, 128
  s_cmp_eq_u32 s65, 1152
  s_cselect_b32 s65, 0, s65
  v_mfma_f32_16x16x32_bf16 v[88:91], a[52:55], a[80:83], v[88:91]
  v_mfma_f32_16x16x32_bf16 v[92:95], a[56:59], a[80:83], v[92:95]
  v_mfma_f32_16x16x32_bf16 v[96:99], a[44:47], a[84:87], v[96:99]
  buffer_store_dwordx4 v[144:147], v149, s[84:87], 0 offen offset:1024 sc1 nt
  v_mfma_f32_16x16x32_bf16 v[100:103], a[48:51], a[84:87], v[100:103]
  v_mfma_f32_16x16x32_bf16 v[104:107], a[52:55], a[84:87], v[104:107]
  v_mfma_f32_16x16x32_bf16 v[108:111], a[56:59], a[84:87], v[108:111]
  s_waitcnt lgkmcnt(0) vmcnt(19)
  v_mfma_f32_16x16x32_bf16 v[0:3], a[0:3], a[16:19], v[0:3]
  ds_read_b64_tr_b16 a[44:45], v176 offset:4096
  v_mfma_f32_16x16x32_bf16 v[4:7], a[4:7], a[16:19], v[4:7]
  ds_read_b64_tr_b16 a[46:47], v176 offset:4608
  s_add_u32 m0, s59, 65536
  s_nop 0
  buffer_load_dwordx4 v168, s[8:11], s64 offen offset:0  lds
  v_mfma_f32_16x16x32_bf16 v[8:11], a[8:11], a[16:19], v[8:11]
  ds_read_b64_tr_b16 a[48:49], v177 offset:4096
  v_mfma_f32_16x16x32_bf16 v[12:15], a[12:15], a[16:19], v[12:15]
  ds_read_b64_tr_b16 a[50:51], v177 offset:4608
  v_mfma_f32_16x16x32_bf16 v[16:19], a[0:3], a[20:23], v[16:19]
  ds_read_b64_tr_b16 a[52:53], v178 offset:4096
  v_mfma_f32_16x16x32_bf16 v[20:23], a[4:7], a[20:23], v[20:23]
  ds_read_b64_tr_b16 a[54:55], v178 offset:4608
  v_mfma_f32_16x16x32_bf16 v[24:27], a[8:11], a[20:23], v[24:27]
  ds_read_b64_tr_b16 a[56:57], v179 offset:4096
  buffer_load_dwordx4 v169, s[8:11], s64 offen offset:1024  lds
  v_mfma_f32_16x16x32_bf16 v[28:31], a[12:15], a[20:23], v[28:31]
  ds_read_b64_tr_b16 a[58:59], v179 offset:4608
  v_mfma_f32_16x16x32_bf16 v[32:35], a[0:3], a[24:27], v[32:35]
  ds_read_b128 a[60:63], v181 offset:0
  v_mfma_f32_16x16x32_bf16 v[36:39], a[4:7], a[24:27], v[36:39]
  ds_read_b128 a[64:67], v181 offset:2048
  v_mfma_f32_16x16x32_bf16 v[40:43], a[8:11], a[24:27], v[40:43]
  ds_read_b128 a[68:71], v181 offset:4096
  v_mfma_f32_16x16x32_bf16 v[44:47], a[12:15], a[24:27], v[44:47]
  ds_read_b128 a[72:75], v181 offset:6144
  buffer_load_dwordx4 v170, s[8:11], s64 offen offset:2048  lds
  v_mfma_f32_16x16x32_bf16 v[48:51], a[0:3], a[28:31], v[48:51]
  ds_read_b128 a[76:79], v181 offset:8192
  v_mfma_f32_16x16x32_bf16 v[52:55], a[4:7], a[28:31], v[52:55]
  ds_read_b128 a[80:83], v181 offset:10240
  v_mfma_f32_16x16x32_bf16 v[56:59], a[8:11], a[28:31], v[56:59]
  ds_read_b128 a[84:87], v181 offset:12288
  v_mfma_f32_16x16x32_bf16 v[60:63], a[12:15], a[28:31], v[60:63]
  v_mfma_f32_16x16x32_bf16 v[64:67], a[0:3], a[32:35], v[64:67]
  buffer_load_dwordx4 v171, s[8:11], s64 offen offset:3072  lds
  s_add_u32 s64, s64, 262144
  v_mfma_f32_16x16x32_bf16 v[68:71], a[4:7], a[32:35], v[68:71]
  v_mfma_f32_16x16x32_bf16 v[72:75], a[8:11], a[32:35], v[72:75]
  v_mfma_f32_16x16x32_bf16 v[76:79], a[12:15], a[32:35], v[76:79]
  v_mfma_f32_16x16x32_bf16 v[80:83], a[0:3], a[36:39], v[80:83]
  v_mfma_f32_16x16x32_bf16 v[84:87], a[4:7], a[36:39], v[84:87]
  buffer_store_dwordx4 v[144:147], v150, s[84:87], 0 offen offset:0 sc1 nt
  v_mfma_f32_16x16x32_bf16 v[88:91], a[8:11], a[36:39], v[88:91]
  v_mfma_f32_16x16x32_bf16 v[92:95], a[12:15], a[36:39], v[92:95]
  v_mfma_f32_16x16x32_bf16 v[96:99], a[0:3], a[40:43], v[96:99]
  v_mfma_f32_16x16x32_bf16 v[100:103], a[4:7], a[40:43], v[100:103]
  v_mfma_f32_16x16x32_bf16 v[104:107], a[8:11], a[40:43], v[104:107]
  v_mfma_f32_16x16x32_bf16 v[108:111], a[12:15], a[40:43], v[108:111]
  s_waitcnt lgkmcnt(0) vmcnt(15)
  s_barrier
  v_mfma_f32_16x16x32_bf16 v[0:3], a[44:47], a[60:63], v[0:3]
  ds_read_b64_tr_b16 a[0:1], v176 offset:8192
  v_mfma_f32_16x16x32_bf16 v[4:7], a[48:51], a[60:63], v[4:7]
  ds_read_b64_tr_b16 a[2:3], v176 offset:8704
  s_add_u32 m0, s59, 69632
  s_nop 0
  buffer_load_dwordx4 v168, s[8:11], s64 offen offset:0  lds
  v_mfma_f32_16x16x32_bf16 v[8:11], a[52:55], a[60:63], v[8:11]
  ds_read_b64_tr_b16 a[4:5], v177 offset:8192
  v_mfma_f32_16x16x32_bf16 v[12:15], a[56:59], a[60:63], v[12:15]
  ds_read_b64_tr_b16 a[6:7], v177 offset:8704
  buffer_load_dwordx4 v169, s[8:11], s64 offen offset:1024  lds
  v_mfma_f32_16x16x32_bf16 v[16:19], a[44:47], a[64:67], v[16:19]
  ds_read_b64_tr_b16 a[8:9], v178 offset:8192
  v_mfma_f32_16x16x32_bf16 v[20:23], a[48:51], a[64:67], v[20:23]
  ds_read_b64_tr_b16 a[10:11], v178 offset:8704
  v_mfma_f32_16x16x32_bf16 v[24:27], a[52:55], a[64:67], v[24:27]
  ds_read_b64_tr_b16 a[12:13], v179 offset:8192
  buffer_load_dwordx4 v170, s[8:11], s64 offen offset:2048  lds
  v_mfma_f32_16x16x32_bf16 v[28:31], a[56:59], a[64:67], v[28:31]
  ds_read_b64_tr_b16 a[14:15], v179 offset:8704
  v_mfma_f32_16x16x32_bf16 v[32:35], a[44:47], a[68:71], v[32:35]
  ds_read_b128 a[16:19], v180 offset:16384
  v_mfma_f32_16x16x32_bf16 v[36:39], a[48:51], a[68:71], v[36:39]
  ds_read_b128 a[20:23], v180 offset:18432
  buffer_load_dwordx4 v171, s[8:11], s64 offen offset:3072  lds
  s_add_u32 s64, s64, 262144
  s_cmp_eq_u32 s64, 4718592
  s_cselect_b32 s64, 0, s64
  v_mfma_f32_16x16x32_bf16 v[40:43], a[52:55], a[68:71], v[40:43]
  ds_read_b128 a[24:27], v180 offset:20480
  v_mfma_f32_16x16x32_bf16 v[44:47], a[56:59], a[68:71], v[44:47]
  ds_read_b128 a[28:31], v180 offset:22528
  v_mfma_f32_16x16x32_bf16 v[48:51], a[44:47], a[72:75], v[48:51]
  ds_read_b128 a[32:35], v180 offset:24576
  s_add_u32 m0, s58, 49152
  s_nop 0
  buffer_load_dwordx4 v172, s[4:7], s65 offen offset:0  lds
  v_mfma_f32_16x16x32_bf16 v[52:55], a[48:51], a[72:75], v[52:55]
  ds_read_b128 a[36:39], v180 offset:26624
  v_mfma_f32_16x16x32_bf16 v[56:59], a[52:55], a[72:75], v[56:59]
  ds_read_b128 a[40:43], v180 offset:28672
  v_mfma_f32_16x16x32_bf16 v[60:63], a[56:59], a[72:75], v[60:63]
  buffer_load_dwordx4 v173, s[4:7], s65 offen offset:1024  lds
  v_mfma_f32_16x16x32_bf16 v[64:67], a[44:47], a[76:79], v[64:67]
  v_mfma_f32_16x16x32_bf16 v[68:71], a[48:51], a[76:79], v[68:71]
  v_mfma_f32_16x16x32_bf16 v[72:75], a[52:55], a[76:79], v[72:75]
  buffer_load_dwordx4 v174, s[4:7], s65 offen offset:2048  lds
  v_mfma_f32_16x16x32_bf16 v[76:79], a[56:59], a[76:79], v[76:79]
  v_mfma_f32_16x16x32_bf16 v[80:83], a[44:47], a[80:83], v[80:83]
  v_mfma_f32_16x16x32_bf16 v[84:87], a[48:51], a[80:83], v[84:87]
  buffer_load_dwordx4 v175, s[4:7], s65 offen offset:3072  lds
  s_add_u32 s65, s65, 128
  s_cmp_eq_u32 s65, 1152
  s_cselect_b32 s65, 0, s65
  v_mfma_f32_16x16x32_bf16 v[88:91], a[52:55], a[80:83], v[88:91]
  v_mfma_f32_16x16x32_bf16 v[92:95], a[56:59], a[80:83], v[92:95]
  v_mfma_f32_16x16x32_bf16 v[96:99], a[44:47], a[84:87], v[96:99]
  buffer_store_dwordx4 v[144:147], v150, s[84:87], 0 offen offset:1024 sc1 nt
  v_mfma_f32_16x16x32_bf16 v[100:103], a[48:51], a[84:87], v[100:103]
  v_mfma_f32_16x16x32_bf16 v[104:107], a[52:55], a[84:87], v[104:107]
  v_mfma_f32_16x16x32_bf16 v[108:111], a[56:59], a[84:87], v[108:111]
  s_waitcnt lgkmcnt(0) vmcnt(19)
  v_mfma_f32_16x16x32_bf16 v[0:3], a[0:3], a[16:19], v[0:3]
  ds_read_b64_tr_b16 a[44:45], v176 offset:12288
  v_mfma_f32_16x16x32_bf16 v[4:7], a[4:7], a[16:19], v[4:7]
  ds_read_b64_tr_b16 a[46:47], v176 offset:12800
  s_add_u32 m0, s59, 73728
  s_nop 0
  buffer_load_dwordx4 v168, s[8:11], s64 offen offset:0  lds
  v_mfma_f32_16x16x32_bf16 v[8:11], a[8:11], a[16:19], v[8:11]
  ds_read_b64_tr_b16 a[48:49], v177 offset:12288
  v_mfma_f32_16x16x32_bf16 v[12:15], a[12:15], a[16:19], v[12:15]
  ds_read_b64_tr_b16 a[50:51], v177 offset:12800
  v_mfma_f32_16x16x32_bf16 v[16:19], a[0:3], a[20:23], v[16:19]
  ds_read_b64_tr_b16 a[52:53], v178 offset:12288
  v_mfma_f32_16x16x32_bf16 v[20:23], a[4:7], a[20:23], v[20:23]
  ds_read_b64_tr_b16 a[54:55], v178 offset:12800
  v_mfma_f32_16x16x32_bf16 v[24:27], a[8:11], a[20:23], v[24:27]
  ds_read_b64_tr_b16 a[56:57], v179 offset:12288
  buffer_load_dwordx4 v169, s[8:11], s64 offen offset:1024  lds
  v_mfma_f32_16x16x32_bf16 v[28:31], a[12:15], a[20:23], v[28:31]
  ds_read_b64_tr_b16 a[58:59], v179 offset:12800
  v_mfma_f32_16x16x32_bf16 v[32:35], a[0:3], a[24:27], v[32:35]
  ds_read_b128 a[60:63], v181 offset:16384
  v_mfma_f32_16x16x32_bf16 v[36:39], a[4:7], a[24:27], v[36:39]
  ds_read_b128 a[64:67], v181 offset:18432
  v_mfma_f32_16x16x32_bf16 v[40:43], a[8:11], a[24:27], v[40:43]
  ds_read_b128 a[68:71], v181 offset:20480
  v_mfma_f32_16x16x32_bf16 v[44:47], a[12:15], a[24:27], v[44:47]
  ds_read_b128 a[72:75], v181 offset:22528
  buffer_load_dwordx4 v170, s[8:11], s64 offen offset:2048  lds
  v_mfma_f32_16x16x32_bf16 v[48:51], a[0:3], a[28:31], v[48:51]
  ds_read_b128 a[76:79], v181 offset:24576
  v_mfma_f32_16x16x32_bf16 v[52:55], a[4:7], a[28:31], v[52:55]
  ds_read_b128 a[80:83], v181 offset:26624
  v_mfma_f32_16x16x32_bf16 v[56:59], a[8:11], a[28:31], v[56:59]
  ds_read_b128 a[84:87], v181 offset:28672
  v_mfma_f32_16x16x32_bf16 v[60:63], a[12:15], a[28:31], v[60:63]
  v_mfma_f32_16x16x32_bf16 v[64:67], a[0:3], a[32:35], v[64:67]
  buffer_load_dwordx4 v171, s[8:11], s64 offen offset:3072  lds
  s_add_u32 s64, s64, 262144
  v_mfma_f32_16x16x32_bf16 v[68:71], a[4:7], a[32:35], v[68:71]
  v_mfma_f32_16x16x32_bf16 v[72:75], a[8:11], a[32:35], v[72:75]
  v_mfma_f32_16x16x32_bf16 v[76:79], a[12:15], a[32:35], v[76:79]
  v_mfma_f32_16x16x32_bf16 v[80:83], a[0:3], a[36:39], v[80:83]
  v_mfma_f32_16x16x32_bf16 v[84:87], a[4:7], a[36:39], v[84:87]
  buffer_store_dwordx4 v[144:147], v151, s[84:87], 0 offen offset:0 sc1 nt
  v_mfma_f32_16x16x32_bf16 v[88:91], a[8:11], a[36:39], v[88:91]
  v_mfma_f32_16x16x32_bf16 v[92:95], a[12:15], a[36:39], v[92:95]
  v_mfma_f32_16x16x32_bf16 v[96:99], a[0:3], a[40:43], v[96:99]
  v_mfma_f32_16x16x32_bf16 v[100:103], a[4:7], a[40:43], v[100:103]
  v_mfma_f32_16x16x32_bf16 v[104:107], a[8:11], a[40:43], v[104:107]
  v_mfma_f32_16x16x32_bf16 v[108:111], a[12:15], a[40:43], v[108:111]
  s_waitcnt lgkmcnt(0) vmcnt(15)
  s_barrier
  v_mfma_f32_16x16x32_bf16 v[0:3], a[44:47], a[60:63], v[0:3]
  ds_read_b64_tr_b16 a[0:1], v176 offset:0
  v_mfma_f32_16x16x32_bf16 v[4:7], a[48:51], a[60:63], v[4:7]
  ds_read_b64_tr_b16 a[2:3], v176 offset:512
  s_add_u32 m0, s59, 77824
  s_nop 0
  buffer_load_dwordx4 v168, s[8:11], s64 offen offset:0  lds
  v_mfma_f32_16x16x32_bf16 v[8:11], a[52:55], a[60:63], v[8:11]
  ds_read_b64_tr_b16 a[4:5], v177 offset:0
  v_mfma_f32_16x16x32_bf16 v[12:15], a[56:59], a[60:63], v[12:15]
  ds_read_b64_tr_b16 a[6:7], v177 offset:512
  buffer_load_dwordx4 v169, s[8:11], s64 offen offset:1024  lds
  v_mfma_f32_16x16x32_bf16 v[16:19], a[44:47], a[64:67], v[16:19]
  ds_read_b64_tr_b16 a[8:9], v178 offset:0
  v_mfma_f32_16x16x32_bf16 v[20:23], a[48:51], a[64:67], v[20:23]
  ds_read_b64_tr_b16 a[10:11], v178 offset:512
  v_mfma_f32_16x16x32_bf16 v[24:27], a[52:55], a[64:67], v[24:27]
  ds_read_b64_tr_b16 a[12:13], v179 offset:0
  buffer_load_dwordx4 v170, s[8:11], s64 offen offset:2048  lds
  v_mfma_f32_16x16x32_bf16 v[28:31], a[56:59], a[64:67], v[28:31]
  ds_read_b64_tr_b16 a[14:15], v179 offset:512
  v_mfma_f32_16x16x32_bf16 v[32:35], a[44:47], a[68:71], v[32:35]
  ds_read_b128 a[16:19], v180 offset:32768
  v_mfma_f32_16x16x32_bf16 v[36:39], a[48:51], a[68:71], v[36:39]
  ds_read_b128 a[20:23], v180 offset:34816
  buffer_load_dwordx4 v171, s[8:11], s64 offen offset:3072  lds
  s_add_u32 s64, s64, 262144
  s_cmp_eq_u32 s64, 4718592
  s_cselect_b32 s64, 0, s64
  v_mfma_f32_16x16x32_bf16 v[40:43], a[52:55], a[68:71], v[40:43]
  ds_read_b128 a[24:27], v180 offset:36864
  v_mfma_f32_16x16x32_bf16 v[44:47], a[56:59], a[68:71], v[44:47]
  ds_read_b128 a[28:31], v180 offset:38912
  v_mfma_f32_16x16x32_bf16 v[48:51], a[44:47], a[72:75], v[48:51]
  ds_read_b128 a[32:35], v180 offset:40960
  s_add_u32 m0, s58, 0
  s_nop 0
  buffer_load_dwordx4 v172, s[4:7], s65 offen offset:0  lds
  v_mfma_f32_16x16x32_bf16 v[52:55], a[48:51], a[72:75], v[52:55]
  ds_read_b128 a[36:39], v180 offset:43008
  v_mfma_f32_16x16x32_bf16 v[56:59], a[52:55], a[72:75], v[56:59]
  ds_read_b128 a[40:43], v180 offset:45056
  v_mfma_f32_16x16x32_bf16 v[60:63], a[56:59], a[72:75], v[60:63]
  buffer_load_dwordx4 v173, s[4:7], s65 offen offset:1024  lds
  v_mfma_f32_16x16x32_bf16 v[64:67], a[44:47], a[76:79], v[64:67]
  v_mfma_f32_16x16x32_bf16 v[68:71], a[48:51], a[76:79], v[68:71]
  v_mfma_f32_16x16x32_bf16 v[72:75], a[52:55], a[76:79], v[72:75]
  buffer_load_dwordx4 v174, s[4:7], s65 offen offset:2048  lds
  v_mfma_f32_16x16x32_bf16 v[76:79], a[56:59], a[76:79], v[76:79]
  v_mfma_f32_16x16x32_bf16 v[80:83], a[44:47], a[80:83], v[80:83]
  v_mfma_f32_16x16x32_bf16 v[84:87], a[48:51], a[80:83], v[84:87]
  buffer_load_dwordx4 v175, s[4:7], s65 offen offset:3072  lds
  s_add_u32 s65, s65, 128
  s_cmp_eq_u32 s65, 1152
  s_cselect_b32 s65, 0, s65
  v_mfma_f32_16x16x32_bf16 v[88:91], a[52:55], a[80:83], v[88:91]
  v_mfma_f32_16x16x32_bf16 v[92:95], a[56:59], a[80:83], v[92:95]
  v_mfma_f32_16x16x32_bf16 v[96:99], a[44:47], a[84:87], v[96:99]
  buffer_store_dwordx4 v[144:147], v151, s[84:87], 0 offen offset:1024 sc1 nt
  v_mfma_f32_16x16x32_bf16 v[100:103], a[48:51], a[84:87], v[100:103]
  v_mfma_f32_16x16x32_bf16 v[104:107], a[52:55], a[84:87], v[104:107]
  v_mfma_f32_16x16x32_bf16 v[108:111], a[56:59], a[84:87], v[108:111]
  s_waitcnt lgkmcnt(0) vmcnt(19)
  v_mfma_f32_16x16x32_bf16 v[0:3], a[0:3], a[16:19], v[0:3]
  ds_read_b64_tr_b16 a[44:45], v176 offset:4096
  v_mfma_f32_16x16x32_bf16 v[4:7], a[4:7], a[16:19], v[4:7]
  ds_read_b64_tr_b16 a[46:47], v176 offset:4608
  s_add_u32 m0, s59, 65536
  s_nop 0
  buffer_load_dwordx4 v168, s[8:11], s64 offen offset:0  lds
  v_mfma_f32_16x16x32_bf16 v[8:11], a[8:11], a[16:19], v[8:11]
  ds_read_b64_tr_b16 a[48:49], v177 offset:4096
  v_mfma_f32_16x16x32_bf16 v[12:15], a[12:15], a[16:19], v[12:15]
  ds_read_b64_tr_b16 a[50:51], v177 offset:4608
  v_mfma_f32_16x16x32_bf16 v[16:19], a[0:3], a[20:23], v[16:19]
  ds_read_b64_tr_b16 a[52:53], v178 offset:4096
  v_mfma_f32_16x16x32_bf16 v[20:23], a[4:7], a[20:23], v[20:23]
  ds_read_b64_tr_b16 a[54:55], v178 offset:4608
  v_mfma_f32_16x16x32_bf16 v[24:27], a[8:11], a[20:23], v[24:27]
  ds_read_b64_tr_b16 a[56:57], v179 offset:4096
  v_mfma_f32_16x16x32_bf16 v[28:31], a[12:15], a[20:23], v[28:31]
  ds_read_b64_tr_b16 a[58:59], v179 offset:4608
  buffer_load_dwordx4 v169, s[8:11], s64 offen offset:1024  lds
  v_mfma_f32_16x16x32_bf16 v[32:35], a[0:3], a[24:27], v[32:35]
  ds_read_b128 a[60:63], v181 offset:32768
  v_mfma_f32_16x16x32_bf16 v[36:39], a[4:7], a[24:27], v[36:39]
  ds_read_b128 a[64:67], v181 offset:34816
  v_mfma_f32_16x16x32_bf16 v[40:43], a[8:11], a[24:27], v[40:43]
  ds_read_b128 a[68:71], v181 offset:36864
  v_mfma_f32_16x16x32_bf16 v[44:47], a[12:15], a[24:27], v[44:47]
  ds_read_b128 a[72:75], v181 offset:38912
  v_mfma_f32_16x16x32_bf16 v[48:51], a[0:3], a[28:31], v[48:51]
  ds_read_b128 a[76:79], v181 offset:40960
  v_mfma_f32_16x16x32_bf16 v[52:55], a[4:7], a[28:31], v[52:55]
  ds_read_b128 a[80:83], v181 offset:43008
  v_mfma_f32_16x16x32_bf16 v[56:59], a[8:11], a[28:31], v[56:59]
  ds_read_b128 a[84:87], v181 offset:45056
  buffer_load_dwordx4 v170, s[8:11], s64 offen offset:2048  lds
  v_mfma_f32_16x16x32_bf16 v[60:63], a[12:15], a[28:31], v[60:63]
  v_mfma_f32_16x16x32_bf16 v[64:67], a[0:3], a[32:35], v[64:67]
  v_mfma_f32_16x16x32_bf16 v[68:71], a[4:7], a[32:35], v[68:71]
  v_mfma_f32_16x16x32_bf16 v[72:75], a[8:11], a[32:35], v[72:75]
  v_mfma_f32_16x16x32_bf16 v[76:79], a[12:15], a[32:35], v[76:79]
  v_mfma_f32_16x16x32_bf16 v[80:83], a[0:3], a[36:39], v[80:83]
  buffer_load_dwordx4 v171, s[8:11], s64 offen offset:3072  lds
  s_add_u32 s64, s64, 262144
  v_mfma_f32_16x16x32_bf16 v[84:87], a[4:7], a[36:39], v[84:87]
  v_mfma_f32_16x16x32_bf16 v[88:91], a[8:11], a[36:39], v[88:91]
  v_mfma_f32_16x16x32_bf16 v[92:95], a[12:15], a[36:39], v[92:95]
  v_mfma_f32_16x16x32_bf16 v[96:99], a[0:3], a[40:43], v[96:99]
  v_mfma_f32_16x16x32_bf16 v[100:103], a[4:7], a[40:43], v[100:103]
  v_mfma_f32_16x16x32_bf16 v[104:107], a[8:11], a[40:43], v[104:107]
  v_mfma_f32_16x16x32_bf16 v[108:111], a[12:15], a[40:43], v[108:111]
  s_waitcnt lgkmcnt(0) vmcnt(14)
  s_barrier
  v_mfma_f32_16x16x32_bf16 v[0:3], a[44:47], a[60:63], v[0:3]
  ds_read_b64_tr_b16 a[0:1], v176 offset:8192
  v_mfma_f32_16x16x32_bf16 v[4:7], a[48:51], a[60:63], v[4:7]
  ds_read_b64_tr_b16 a[2:3], v176 offset:8704
  s_add_u32 m0, s59, 69632
  s_nop 0
  buffer_load_dwordx4 v168, s[8:11], s64 offen offset:0  lds
  v_mfma_f32_16x16x32_bf16 v[8:11], a[52:55], a[60:63], v[8:11]
  ds_read_b64_tr_b16 a[4:5], v177 offset:8192
  v_mfma_f32_16x16x32_bf16 v[12:15], a[56:59], a[60:63], v[12:15]
  ds_read_b64_tr_b16 a[6:7], v177 offset:8704
  v_mfma_f32_16x16x32_bf16 v[16:19], a[44:47], a[64:67], v[16:19]
  ds_read_b64_tr_b16 a[8:9], v178 offset:8192
  buffer_load_dwordx4 v169, s[8:11], s64 offen offset:1024  lds
  v_mfma_f32_16x16x32_bf16 v[20:23], a[48:51], a[64:67], v[20:23]
  ds_read_b64_tr_b16 a[10:11], v178 offset:8704
  v_mfma_f32_16x16x32_bf16 v[24:27], a[52:55], a[64:67], v[24:27]
  ds_read_b64_tr_b16 a[12:13], v179 offset:8192
  v_mfma_f32_16x16x32_bf16 v[28:31], a[56:59], a[64:67], v[28:31]
  ds_read_b64_tr_b16 a[14:15], v179 offset:8704
  buffer_load_dwordx4 v170, s[8:11], s64 offen offset:2048  lds
  v_mfma_f32_16x16x32_bf16 v[32:35], a[44:47], a[68:71], v[32:35]
  ds_read_b128 a[16:19], v180 offset:49152
  v_mfma_f32_16x16x32_bf16 v[36:39], a[48:51], a[68:71], v[36:39]
  ds_read_b128 a[20:23], v180 offset:51200
  v_mfma_f32_16x16x32_bf16 v[40:43], a[52:55], a[68:71], v[40:43]
  ds_read_b128 a[24:27], v180 offset:53248
  buffer_load_dwordx4 v171, s[8:11], s64 offen offset:3072  lds
  s_add_u32 s64, s64, 262144
  s_cmp_eq_u32 s64, 4718592
  s_cselect_b32 s64, 0, s64
  v_mfma_f32_16x16x32_bf16 v[44:47], a[56:59], a[68:71], v[44:47]
  ds_read_b128 a[28:31], v180 offset:55296
  v_mfma_f32_16x16x32_bf16 v[48:51], a[44:47], a[72:75], v[48:51]
  ds_read_b128 a[32:35], v180 offset:57344
  v_mfma_f32_16x16x32_bf16 v[52:55], a[48:51], a[72:75], v[52:55]
  ds_read_b128 a[36:39], v180 offset:59392
  v_mfma_f32_16x16x32_bf16 v[56:59], a[52:55], a[72:75], v[56:59]
  ds_read_b128 a[40:43], v180 offset:61440
  s_add_u32 m0, s58, 131072
  s_nop 0
  buffer_load_dwordx4 v172, s[4:7], s65 offen offset:0  lds
  v_mfma_f32_16x16x32_bf16 v[60:63], a[56:59], a[72:75], v[60:63]
  v_mfma_f32_16x16x32_bf16 v[64:67], a[44:47], a[76:79], v[64:67]
  v_mfma_f32_16x16x32_bf16 v[68:71], a[48:51], a[76:79], v[68:71]
  buffer_load_dwordx4 v173, s[4:7], s65 offen offset:1024  lds
  v_mfma_f32_16x16x32_bf16 v[72:75], a[52:55], a[76:79], v[72:75]
  v_mfma_f32_16x16x32_bf16 v[76:79], a[56:59], a[76:79], v[76:79]
  v_mfma_f32_16x16x32_bf16 v[80:83], a[44:47], a[80:83], v[80:83]
  buffer_load_dwordx4 v174, s[4:7], s65 offen offset:2048  lds
  v_mfma_f32_16x16x32_bf16 v[84:87], a[48:51], a[80:83], v[84:87]
  v_mfma_f32_16x16x32_bf16 v[88:91], a[52:55], a[80:83], v[88:91]
  v_mfma_f32_16x16x32_bf16 v[92:95], a[56:59], a[80:83], v[92:95]
  buffer_load_dwordx4 v175, s[4:7], s65 offen offset:3072  lds
  s_add_u32 s65, s65, 128
  s_cmp_eq_u32 s65, 1152
  s_cselect_b32 s65, 0, s65
  v_mfma_f32_16x16x32_bf16 v[96:99], a[44:47], a[84:87], v[96:99]
  v_mfma_f32_16x16x32_bf16 v[100:103], a[48:51], a[84:87], v[100:103]
  v_mfma_f32_16x16x32_bf16 v[104:107], a[52:55], a[84:87], v[104:107]
  v_mfma_f32_16x16x32_bf16 v[108:111], a[56:59], a[84:87], v[108:111]
  s_waitcnt lgkmcnt(0) vmcnt(17)
  v_mfma_f32_16x16x32_bf16 v[0:3], a[0:3], a[16:19], v[0:3]
  ds_read_b64_tr_b16 a[44:45], v176 offset:12288
  v_mfma_f32_16x16x32_bf16 v[4:7], a[4:7], a[16:19], v[4:7]
  ds_read_b64_tr_b16 a[46:47], v176 offset:12800
  s_add_u32 m0, s59, 73728
  s_nop 0
  buffer_load_dwordx4 v168, s[8:11], s64 offen offset:0  lds
  v_mfma_f32_16x16x32_bf16 v[8:11], a[8:11], a[16:19], v[8:11]
  ds_read_b64_tr_b16 a[48:49], v177 offset:12288
  v_mfma_f32_16x16x32_bf16 v[12:15], a[12:15], a[16:19], v[12:15]
  ds_read_b64_tr_b16 a[50:51], v177 offset:12800
  v_mfma_f32_16x16x32_bf16 v[16:19], a[0:3], a[20:23], v[16:19]
  ds_read_b64_tr_b16 a[52:53], v178 offset:12288
  v_mfma_f32_16x16x32_bf16 v[20:23], a[4:7], a[20:23], v[20:23]
  ds_read_b64_tr_b16 a[54:55], v178 offset:12800
  v_mfma_f32_16x16x32_bf16 v[24:27], a[8:11], a[20:23], v[24:27]
  ds_read_b64_tr_b16 a[56:57], v179 offset:12288
  v_mfma_f32_16x16x32_bf16 v[28:31], a[12:15], a[20:23], v[28:31]
  ds_read_b64_tr_b16 a[58:59], v179 offset:12800
  buffer_load_dwordx4 v169, s[8:11], s64 offen offset:1024  lds
  v_mfma_f32_16x16x32_bf16 v[32:35], a[0:3], a[24:27], v[32:35]
  ds_read_b128 a[60:63], v181 offset:49152
  v_mfma_f32_16x16x32_bf16 v[36:39], a[4:7], a[24:27], v[36:39]
  ds_read_b128 a[64:67], v181 offset:51200
  v_mfma_f32_16x16x32_bf16 v[40:43], a[8:11], a[24:27], v[40:43]
  ds_read_b128 a[68:71], v181 offset:53248
  v_mfma_f32_16x16x32_bf16 v[44:47], a[12:15], a[24:27], v[44:47]
  ds_read_b128 a[72:75], v181 offset:55296
  v_mfma_f32_16x16x32_bf16 v[48:51], a[0:3], a[28:31], v[48:51]
  ds_read_b128 a[76:79], v181 offset:57344
  v_mfma_f32_16x16x32_bf16 v[52:55], a[4:7], a[28:31], v[52:55]
  ds_read_b128 a[80:83], v181 offset:59392
  v_mfma_f32_16x16x32_bf16 v[56:59], a[8:11], a[28:31], v[56:59]
  ds_read_b128 a[84:87], v181 offset:61440
  buffer_load_dwordx4 v170, s[8:11], s64 offen offset:2048  lds
  v_mfma_f32_16x16x32_bf16 v[60:63], a[12:15], a[28:31], v[60:63]
  v_mfma_f32_16x16x32_bf16 v[64:67], a[0:3], a[32:35], v[64:67]
  v_mfma_f32_16x16x32_bf16 v[68:71], a[4:7], a[32:35], v[68:71]
  v_mfma_f32_16x16x32_bf16 v[72:75], a[8:11], a[32:35], v[72:75]
  v_mfma_f32_16x16x32_bf16 v[76:79], a[12:15], a[32:35], v[76:79]
  v_mfma_f32_16x16x32_bf16 v[80:83], a[0:3], a[36:39], v[80:83]
  buffer_load_dwordx4 v171, s[8:11], s64 offen offset:3072  lds
  s_add_u32 s64, s64, 262144
  v_mfma_f32_16x16x32_bf16 v[84:87], a[4:7], a[36:39], v[84:87]
  v_mfma_f32_16x16x32_bf16 v[88:91], a[8:11], a[36:39], v[88:91]
  v_mfma_f32_16x16x32_bf16 v[92:95], a[12:15], a[36:39], v[92:95]
  v_mfma_f32_16x16x32_bf16 v[96:99], a[0:3], a[40:43], v[96:99]
  v_mfma_f32_16x16x32_bf16 v[100:103], a[4:7], a[40:43], v[100:103]
  v_mfma_f32_16x16x32_bf16 v[104:107], a[8:11], a[40:43], v[104:107]
  v_mfma_f32_16x16x32_bf16 v[108:111], a[12:15], a[40:43], v[108:111]
  s_waitcnt lgkmcnt(0) vmcnt(12)
  s_barrier
  v_mfma_f32_16x16x32_bf16 v[0:3], a[44:47], a[60:63], v[0:3]
  ds_read_b64_tr_b16 a[0:1], v176 offset:0
  v_mfma_f32_16x16x32_bf16 v[4:7], a[48:51], a[60:63], v[4:7]
  ds_read_b64_tr_b16 a[2:3], v176 offset:512
  s_add_u32 m0, s59, 77824
  s_nop 0
  buffer_load_dwordx4 v168, s[8:11], s64 offen offset:0  lds
  v_mfma_f32_16x16x32_bf16 v[8:11], a[52:55], a[60:63], v[8:11]
  ds_read_b64_tr_b16 a[4:5], v177 offset:0
  v_mfma_f32_16x16x32_bf16 v[12:15], a[56:59], a[60:63], v[12:15]
  ds_read_b64_tr_b16 a[6:7], v177 offset:512
  v_mfma_f32_16x16x32_bf16 v[16:19], a[44:47], a[64:67], v[16:19]
  ds_read_b64_tr_b16 a[8:9], v178 offset:0
  buffer_load_dwordx4 v169, s[8:11], s64 offen offset:1024  lds
  v_mfma_f32_16x16x32_bf16 v[20:23], a[48:51], a[64:67], v[20:23]
  ds_read_b64_tr_b16 a[10:11], v178 offset:512
  v_mfma_f32_16x16x32_bf16 v[24:27], a[52:55], a[64:67], v[24:27]
  ds_read_b64_tr_b16 a[12:13], v179 offset:0
  v_mfma_f32_16x16x32_bf16 v[28:31], a[56:59], a[64:67], v[28:31]
  ds_read_b64_tr_b16 a[14:15], v179 offset:512
  buffer_load_dwordx4 v170, s[8:11], s64 offen offset:2048  lds
  v_mfma_f32_16x16x32_bf16 v[32:35], a[44:47], a[68:71], v[32:35]
  ds_read_b128 a[16:19], v180 offset:0
  v_mfma_f32_16x16x32_bf16 v[36:39], a[48:51], a[68:71], v[36:39]
  ds_read_b128 a[20:23], v180 offset:2048
  v_mfma_f32_16x16x32_bf16 v[40:43], a[52:55], a[68:71], v[40:43]
  ds_read_b128 a[24:27], v180 offset:4096
  buffer_load_dwordx4 v171, s[8:11], s64 offen offset:3072  lds
  s_add_u32 s64, s64, 262144
  s_cmp_eq_u32 s64, 4718592
  s_cselect_b32 s64, 0, s64
  v_mfma_f32_16x16x32_bf16 v[44:47], a[56:59], a[68:71], v[44:47]
  ds_read_b128 a[28:31], v180 offset:6144
  v_mfma_f32_16x16x32_bf16 v[48:51], a[44:47], a[72:75], v[48:51]
  ds_read_b128 a[32:35], v180 offset:8192
  v_mfma_f32_16x16x32_bf16 v[52:55], a[48:51], a[72:75], v[52:55]
  ds_read_b128 a[36:39], v180 offset:10240
  v_mfma_f32_16x16x32_bf16 v[56:59], a[52:55], a[72:75], v[56:59]
  ds_read_b128 a[40:43], v180 offset:12288
  s_add_u32 m0, s58, 147456
  s_nop 0
  buffer_load_dwordx4 v172, s[4:7], s65 offen offset:0  lds
  v_mfma_f32_16x16x32_bf16 v[60:63], a[56:59], a[72:75], v[60:63]
  v_mfma_f32_16x16x32_bf16 v[64:67], a[44:47], a[76:79], v[64:67]
  v_mfma_f32_16x16x32_bf16 v[68:71], a[48:51], a[76:79], v[68:71]
  buffer_load_dwordx4 v173, s[4:7], s65 offen offset:1024  lds
  v_mfma_f32_16x16x32_bf16 v[72:75], a[52:55], a[76:79], v[72:75]
  v_mfma_f32_16x16x32_bf16 v[76:79], a[56:59], a[76:79], v[76:79]
  v_mfma_f32_16x16x32_bf16 v[80:83], a[44:47], a[80:83], v[80:83]
  buffer_load_dwordx4 v174, s[4:7], s65 offen offset:2048  lds
  v_mfma_f32_16x16x32_bf16 v[84:87], a[48:51], a[80:83], v[84:87]
  v_mfma_f32_16x16x32_bf16 v[88:91], a[52:55], a[80:83], v[88:91]
  v_mfma_f32_16x16x32_bf16 v[92:95], a[56:59], a[80:83], v[92:95]
  buffer_load_dwordx4 v175, s[4:7], s65 offen offset:3072  lds
  s_add_u32 s65, s65, 128
  s_cmp_eq_u32 s65, 1152
  s_cselect_b32 s65, 0, s65
  v_mfma_f32_16x16x32_bf16 v[96:99], a[44:47], a[84:87], v[96:99]
  v_mfma_f32_16x16x32_bf16 v[100:103], a[48:51], a[84:87], v[100:103]
  v_mfma_f32_16x16x32_bf16 v[104:107], a[52:55], a[84:87], v[104:107]
  v_mfma_f32_16x16x32_bf16 v[108:111], a[56:59], a[84:87], v[108:111]
  s_waitcnt lgkmcnt(0) vmcnt(16)
  v_mfma_f32_16x16x32_bf16 v[0:3], a[0:3], a[16:19], v[0:3]
  ds_read_b64_tr_b16 a[44:45], v176 offset:4096
  v_mfma_f32_16x16x32_bf16 v[4:7], a[4:7], a[16:19], v[4:7]
  ds_read_b64_tr_b16 a[46:47], v176 offset:4608
  s_add_u32 m0, s59, 65536
  s_nop 0
  buffer_load_dwordx4 v168, s[8:11], s64 offen offset:0  lds
  v_mfma_f32_16x16x32_bf16 v[8:11], a[8:11], a[16:19], v[8:11]
  ds_read_b64_tr_b16 a[48:49], v177 offset:4096
  v_mfma_f32_16x16x32_bf16 v[12:15], a[12:15], a[16:19], v[12:15]
  ds_read_b64_tr_b16 a[50:51], v177 offset:4608
  v_mfma_f32_16x16x32_bf16 v[16:19], a[0:3], a[20:23], v[16:19]
  ds_read_b64_tr_b16 a[52:53], v178 offset:4096
  v_mfma_f32_16x16x32_bf16 v[20:23], a[4:7], a[20:23], v[20:23]
  ds_read_b64_tr_b16 a[54:55], v178 offset:4608
  v_mfma_f32_16x16x32_bf16 v[24:27], a[8:11], a[20:23], v[24:27]
  ds_read_b64_tr_b16 a[56:57], v179 offset:4096
  v_mfma_f32_16x16x32_bf16 v[28:31], a[12:15], a[20:23], v[28:31]
  ds_read_b64_tr_b16 a[58:59], v179 offset:4608
  buffer_load_dwordx4 v169, s[8:11], s64 offen offset:1024  lds
  v_mfma_f32_16x16x32_bf16 v[32:35], a[0:3], a[24:27], v[32:35]
  ds_read_b128 a[60:63], v181 offset:0
  v_mfma_f32_16x16x32_bf16 v[36:39], a[4:7], a[24:27], v[36:39]
  ds_read_b128 a[64:67], v181 offset:2048
  v_mfma_f32_16x16x32_bf16 v[40:43], a[8:11], a[24:27], v[40:43]
  ds_read_b128 a[68:71], v181 offset:4096
  v_mfma_f32_16x16x32_bf16 v[44:47], a[12:15], a[24:27], v[44:47]
  ds_read_b128 a[72:75], v181 offset:6144
  v_mfma_f32_16x16x32_bf16 v[48:51], a[0:3], a[28:31], v[48:51]
  ds_read_b128 a[76:79], v181 offset:8192
  v_mfma_f32_16x16x32_bf16 v[52:55], a[4:7], a[28:31], v[52:55]
  ds_read_b128 a[80:83], v181 offset:10240
  v_mfma_f32_16x16x32_bf16 v[56:59], a[8:11], a[28:31], v[56:59]
  ds_read_b128 a[84:87], v181 offset:12288
  buffer_load_dwordx4 v170, s[8:11], s64 offen offset:2048  lds
  v_mfma_f32_16x16x32_bf16 v[60:63], a[12:15], a[28:31], v[60:63]
  v_mfma_f32_16x16x32_bf16 v[64:67], a[0:3], a[32:35], v[64:67]
  v_mfma_f32_16x16x32_bf16 v[68:71], a[4:7], a[32:35], v[68:71]
  v_mfma_f32_16x16x32_bf16 v[72:75], a[8:11], a[32:35], v[72:75]
  v_mfma_f32_16x16x32_bf16 v[76:79], a[12:15], a[32:35], v[76:79]
  v_mfma_f32_16x16x32_bf16 v[80:83], a[0:3], a[36:39], v[80:83]
  buffer_load_dwordx4 v171, s[8:11], s64 offen offset:3072  lds
  s_add_u32 s64, s64, 262144
  v_mfma_f32_16x16x32_bf16 v[84:87], a[4:7], a[36:39], v[84:87]
  v_mfma_f32_16x16x32_bf16 v[88:91], a[8:11], a[36:39], v[88:91]
  v_mfma_f32_16x16x32_bf16 v[92:95], a[12:15], a[36:39], v[92:95]
  v_mfma_f32_16x16x32_bf16 v[96:99], a[0:3], a[40:43], v[96:99]
  v_mfma_f32_16x16x32_bf16 v[100:103], a[4:7], a[40:43], v[100:103]
  v_mfma_f32_16x16x32_bf16 v[104:107], a[8:11], a[40:43], v[104:107]
  v_mfma_f32_16x16x32_bf16 v[108:111], a[12:15], a[40:43], v[108:111]
  s_waitcnt lgkmcnt(0) vmcnt(12)
  s_barrier
  v_mfma_f32_16x16x32_bf16 v[0:3], a[44:47], a[60:63], v[0:3]
  ds_read_b64_tr_b16 a[0:1], v176 offset:8192
  v_mfma_f32_16x16x32_bf16 v[4:7], a[48:51], a[60:63], v[4:7]
  ds_read_b64_tr_b16 a[2:3], v176 offset:8704
  s_add_u32 m0, s59, 69632
  s_nop 0
  buffer_load_dwordx4 v168, s[8:11], s64 offen offset:0  lds
  v_mfma_f32_16x16x32_bf16 v[8:11], a[52:55], a[60:63], v[8:11]
  ds_read_b64_tr_b16 a[4:5], v177 offset:8192
  v_mfma_f32_16x16x32_bf16 v[12:15], a[56:59], a[60:63], v[12:15]
  ds_read_b64_tr_b16 a[6:7], v177 offset:8704
  buffer_load_dwordx4 v169, s[8:11], s64 offen offset:1024  lds
  v_mfma_f32_16x16x32_bf16 v[16:19], a[44:47], a[64:67], v[16:19]
  ds_read_b64_tr_b16 a[8:9], v178 offset:8192
  v_mfma_f32_16x16x32_bf16 v[20:23], a[48:51], a[64:67], v[20:23]
  ds_read_b64_tr_b16 a[10:11], v178 offset:8704
  v_mfma_f32_16x16x32_bf16 v[24:27], a[52:55], a[64:67], v[24:27]
  ds_read_b64_tr_b16 a[12:13], v179 offset:8192
  buffer_load_dwordx4 v170, s[8:11], s64 offen offset:2048  lds
  v_mfma_f32_16x16x32_bf16 v[28:31], a[56:59], a[64:67], v[28:31]
  ds_read_b64_tr_b16 a[14:15], v179 offset:8704
  v_mfma_f32_16x16x32_bf16 v[32:35], a[44:47], a[68:71], v[32:35]
  ds_read_b128 a[16:19], v182 offset:0
  v_mfma_f32_16x16x32_bf16 v[36:39], a[48:51], a[68:71], v[36:39]
  ds_read_b128 a[20:23], v182 offset:2048
  buffer_load_dwordx4 v171, s[8:11], s64 offen offset:3072  lds
  s_add_u32 s64, s64, 262144
  s_cmp_eq_u32 s64, 4718592
  s_cselect_b32 s64, 0, s64
  v_mfma_f32_16x16x32_bf16 v[40:43], a[52:55], a[68:71], v[40:43]
  ds_read_b128 a[24:27], v182 offset:4096
  v_mfma_f32_16x16x32_bf16 v[44:47], a[56:59], a[68:71], v[44:47]
  ds_read_b128 a[28:31], v182 offset:6144
  v_mfma_f32_16x16x32_bf16 v[48:51], a[44:47], a[72:75], v[48:51]
  ds_read_b128 a[32:35], v182 offset:8192
  buffer_atomic_add v153, v152, s[80:83], 0 offen sc1
  v_mfma_f32_16x16x32_bf16 v[52:55], a[48:51], a[72:75], v[52:55]
  ds_read_b128 a[36:39], v182 offset:10240
  v_mfma_f32_16x16x32_bf16 v[56:59], a[52:55], a[72:75], v[56:59]
  ds_read_b128 a[40:43], v182 offset:12288
  v_mfma_f32_16x16x32_bf16 v[60:63], a[56:59], a[72:75], v[60:63]
  s_mov_b32 m0, s28
  s_nop 0
  buffer_load_dwordx4 v240, s[12:15], 0 offen offset:0 nt lds
  v_mfma_f32_16x16x32_bf16 v[64:67], a[44:47], a[76:79], v[64:67]
  v_mfma_f32_16x16x32_bf16 v[68:71], a[48:51], a[76:79], v[68:71]
  v_mfma_f32_16x16x32_bf16 v[72:75], a[52:55], a[76:79], v[72:75]
  buffer_load_dwordx4 v241, s[12:15], 0 offen offset:1024 nt lds
  v_mfma_f32_16x16x32_bf16 v[76:79], a[56:59], a[76:79], v[76:79]
  v_mfma_f32_16x16x32_bf16 v[80:83], a[44:47], a[80:83], v[80:83]
  v_mfma_f32_16x16x32_bf16 v[84:87], a[48:51], a[80:83], v[84:87]
  buffer_load_dwordx4 v240, s[12:15], 0 offen offset:2048 nt lds
  v_mfma_f32_16x16x32_bf16 v[88:91], a[52:55], a[80:83], v[88:91]
  v_mfma_f32_16x16x32_bf16 v[92:95], a[56:59], a[80:83], v[92:95]
  v_mfma_f32_16x16x32_bf16 v[96:99], a[44:47], a[84:87], v[96:99]
  buffer_load_dwordx4 v241, s[12:15], 0 offen offset:3072 nt lds
  v_mfma_f32_16x16x32_bf16 v[100:103], a[48:51], a[84:87], v[100:103]
  v_mfma_f32_16x16x32_bf16 v[104:107], a[52:55], a[84:87], v[104:107]
  v_mfma_f32_16x16x32_bf16 v[108:111], a[56:59], a[84:87], v[108:111]
  s_waitcnt lgkmcnt(0) vmcnt(17)
  v_mfma_f32_16x16x32_bf16 v[0:3], a[0:3], a[16:19], v[0:3]
  ds_read_b64_tr_b16 a[44:45], v176 offset:12288
  v_mfma_f32_16x16x32_bf16 v[4:7], a[4:7], a[16:19], v[4:7]
  ds_read_b64_tr_b16 a[46:47], v176 offset:12800
  s_add_u32 m0, m0, 4096
  s_nop 0
  buffer_load_dwordx4 v240, s[12:15], s50 offen offset:0 nt lds
  v_mfma_f32_16x16x32_bf16 v[8:11], a[8:11], a[16:19], v[8:11]
  ds_read_b64_tr_b16 a[48:49], v177 offset:12288
  v_mfma_f32_16x16x32_bf16 v[12:15], a[12:15], a[16:19], v[12:15]
  ds_read_b64_tr_b16 a[50:51], v177 offset:12800
  v_mfma_f32_16x16x32_bf16 v[16:19], a[0:3], a[20:23], v[16:19]
  ds_read_b64_tr_b16 a[52:53], v178 offset:12288
  v_mfma_f32_16x16x32_bf16 v[20:23], a[4:7], a[20:23], v[20:23]
  ds_read_b64_tr_b16 a[54:55], v178 offset:12800
  v_mfma_f32_16x16x32_bf16 v[24:27], a[8:11], a[20:23], v[24:27]
  ds_read_b64_tr_b16 a[56:57], v179 offset:12288
  v_mfma_f32_16x16x32_bf16 v[28:31], a[12:15], a[20:23], v[28:31]
  ds_read_b64_tr_b16 a[58:59], v179 offset:12800
  buffer_load_dwordx4 v241, s[12:15], s50 offen offset:1024 nt lds
  v_mfma_f32_16x16x32_bf16 v[32:35], a[0:3], a[24:27], v[32:35]
  ds_read_b128 a[60:63], v183 offset:0
  v_mfma_f32_16x16x32_bf16 v[36:39], a[4:7], a[24:27], v[36:39]
  ds_read_b128 a[64:67], v183 offset:2048
  v_mfma_f32_16x16x32_bf16 v[40:43], a[8:11], a[24:27], v[40:43]
  ds_read_b128 a[68:71], v183 offset:4096
  v_mfma_f32_16x16x32_bf16 v[44:47], a[12:15], a[24:27], v[44:47]
  ds_read_b128 a[72:75], v183 offset:6144
  v_mfma_f32_16x16x32_bf16 v[48:51], a[0:3], a[28:31], v[48:51]
  ds_read_b128 a[76:79], v183 offset:8192
  v_mfma_f32_16x16x32_bf16 v[52:55], a[4:7], a[28:31], v[52:55]
  ds_read_b128 a[80:83], v183 offset:10240
  v_mfma_f32_16x16x32_bf16 v[56:59], a[8:11], a[28:31], v[56:59]
  ds_read_b128 a[84:87], v183 offset:12288
  buffer_load_dwordx4 v240, s[12:15], s50 offen offset:2048 nt lds
  v_mfma_f32_16x16x32_bf16 v[60:63], a[12:15], a[28:31], v[60:63]
  v_mfma_f32_16x16x32_bf16 v[64:67], a[0:3], a[32:35], v[64:67]
  v_mfma_f32_16x16x32_bf16 v[68:71], a[4:7], a[32:35], v[68:71]
  v_mfma_f32_16x16x32_bf16 v[72:75], a[8:11], a[32:35], v[72:75]
  v_mfma_f32_16x16x32_bf16 v[76:79], a[12:15], a[32:35], v[76:79]
  v_mfma_f32_16x16x32_bf16 v[80:83], a[0:3], a[36:39], v[80:83]
  buffer_load_dwordx4 v241, s[12:15], s50 offen offset:3072 nt lds
  v_mfma_f32_16x16x32_bf16 v[84:87], a[4:7], a[36:39], v[84:87]
  v_mfma_f32_16x16x32_bf16 v[88:91], a[8:11], a[36:39], v[88:91]
  v_mfma_f32_16x16x32_bf16 v[92:95], a[12:15], a[36:39], v[92:95]
  v_mfma_f32_16x16x32_bf16 v[96:99], a[0:3], a[40:43], v[96:99]
  v_mfma_f32_16x16x32_bf16 v[100:103], a[4:7], a[40:43], v[100:103]
  v_mfma_f32_16x16x32_bf16 v[104:107], a[8:11], a[40:43], v[104:107]
  v_mfma_f32_16x16x32_bf16 v[108:111], a[12:15], a[40:43], v[108:111]
  s_waitcnt lgkmcnt(0) vmcnt(13)
  s_barrier
  v_mfma_f32_16x16x32_bf16 v[0:3], a[44:47], a[60:63], v[0:3]
  ds_read_b64_tr_b16 a[0:1], v176 offset:0
  v_mfma_f32_16x16x32_bf16 v[4:7], a[48:51], a[60:63], v[4:7]
  ds_read_b64_tr_b16 a[2:3], v176 offset:512
  s_mov_b32 m0, s49
  s_nop 0
  buffer_load_dwordx4 v240, s[32:35], 0 offen offset:0 nt lds
  v_mfma_f32_16x16x32_bf16 v[8:11], a[52:55], a[60:63], v[8:11]
  ds_read_b64_tr_b16 a[4:5], v177 offset:0
  v_mfma_f32_16x16x32_bf16 v[12:15], a[56:59], a[60:63], v[12:15]
  ds_read_b64_tr_b16 a[6:7], v177 offset:512
  v_mfma_f32_16x16x32_bf16 v[16:19], a[44:47], a[64:67], v[16:19]
  ds_read_b64_tr_b16 a[8:9], v178 offset:0
  v_mfma_f32_16x16x32_bf16 v[20:23], a[48:51], a[64:67], v[20:23]
  ds_read_b64_tr_b16 a[10:11], v178 offset:512
  v_mfma_f32_16x16x32_bf16 v[24:27], a[52:55], a[64:67], v[24:27]
  ds_read_b64_tr_b16 a[12:13], v179 offset:0
  v_mfma_f32_16x16x32_bf16 v[28:31], a[56:59], a[64:67], v[28:31]
  ds_read_b64_tr_b16 a[14:15], v179 offset:512
  buffer_load_dwordx4 v241, s[32:35], 0 offen offset:1024 nt lds
  v_mfma_f32_16x16x32_bf16 v[32:35], a[44:47], a[68:71], v[32:35]
  ds_read_b128 a[16:19], v182 offset:16384
  v_mfma_f32_16x16x32_bf16 v[36:39], a[48:51], a[68:71], v[36:39]
  ds_read_b128 a[20:23], v182 offset:18432
  v_mfma_f32_16x16x32_bf16 v[40:43], a[52:55], a[68:71], v[40:43]
  ds_read_b128 a[24:27], v182 offset:20480
  v_mfma_f32_16x16x32_bf16 v[44:47], a[56:59], a[68:71], v[44:47]
  ds_read_b128 a[28:31], v182 offset:22528
  v_mfma_f32_16x16x32_bf16 v[48:51], a[44:47], a[72:75], v[48:51]
  ds_read_b128 a[32:35], v182 offset:24576
  v_mfma_f32_16x16x32_bf16 v[52:55], a[48:51], a[72:75], v[52:55]
  ds_read_b128 a[36:39], v182 offset:26624
  v_mfma_f32_16x16x32_bf16 v[56:59], a[52:55], a[72:75], v[56:59]
  ds_read_b128 a[40:43], v182 offset:28672
  buffer_load_dwordx4 v240, s[32:35], 0 offen offset:2048 nt lds
  v_mfma_f32_16x16x32_bf16 v[60:63], a[56:59], a[72:75], v[60:63]
  v_mfma_f32_16x16x32_bf16 v[64:67], a[44:47], a[76:79], v[64:67]
  v_mfma_f32_16x16x32_bf16 v[68:71], a[48:51], a[76:79], v[68:71]
  v_mfma_f32_16x16x32_bf16 v[72:75], a[52:55], a[76:79], v[72:75]
  v_mfma_f32_16x16x32_bf16 v[76:79], a[56:59], a[76:79], v[76:79]
  v_mfma_f32_16x16x32_bf16 v[80:83], a[44:47], a[80:83], v[80:83]
  buffer_load_dwordx4 v241, s[32:35], 0 offen offset:3072 nt lds
  v_mfma_f32_16x16x32_bf16 v[84:87], a[48:51], a[80:83], v[84:87]
  v_mfma_f32_16x16x32_bf16 v[88:91], a[52:55], a[80:83], v[88:91]
  v_mfma_f32_16x16x32_bf16 v[92:95], a[56:59], a[80:83], v[92:95]
  v_mfma_f32_16x16x32_bf16 v[96:99], a[44:47], a[84:87], v[96:99]
  v_mfma_f32_16x16x32_bf16 v[100:103], a[48:51], a[84:87], v[100:103]
  v_mfma_f32_16x16x32_bf16 v[104:107], a[52:55], a[84:87], v[104:107]
  v_mfma_f32_16x16x32_bf16 v[108:111], a[56:59], a[84:87], v[108:111]
  s_waitcnt lgkmcnt(0) vmcnt(13)
  v_mfma_f32_16x16x32_bf16 v[0:3], a[0:3], a[16:19], v[0:3]
  ds_read_b64_tr_b16 a[44:45], v176 offset:4096
  v_mfma_f32_16x16x32_bf16 v[4:7], a[4:7], a[16:19], v[4:7]
  ds_read_b64_tr_b16 a[46:47], v176 offset:4608
  s_add_u32 m0, m0, 4096
  s_nop 0
  buffer_load_dwordx4 v240, s[32:35], s50 offen offset:0 nt lds
  v_mfma_f32_16x16x32_bf16 v[8:11], a[8:11], a[16:19], v[8:11]
  ds_read_b64_tr_b16 a[48:49], v177 offset:4096
  v_mfma_f32_16x16x32_bf16 v[12:15], a[12:15], a[16:19], v[12:15]
  ds_read_b64_tr_b16 a[50:51], v177 offset:4608
  v_mfma_f32_16x16x32_bf16 v[16:19], a[0:3], a[20:23], v[16:19]
  ds_read_b64_tr_b16 a[52:53], v178 offset:4096
  v_mfma_f32_16x16x32_bf16 v[20:23], a[4:7], a[20:23], v[20:23]
  ds_read_b64_tr_b16 a[54:55], v178 offset:4608
  v_mfma_f32_16x16x32_bf16 v[24:27], a[8:11], a[20:23], v[24:27]
  ds_read_b64_tr_b16 a[56:57], v179 offset:4096
  v_mfma_f32_16x16x32_bf16 v[28:31], a[12:15], a[20:23], v[28:31]
  ds_read_b64_tr_b16 a[58:59], v179 offset:4608
  buffer_load_dwordx4 v241, s[32:35], s50 offen offset:1024 nt lds
  v_mfma_f32_16x16x32_bf16 v[32:35], a[0:3], a[24:27], v[32:35]
  ds_read_b128 a[60:63], v183 offset:16384
  v_mfma_f32_16x16x32_bf16 v[36:39], a[4:7], a[24:27], v[36:39]
  ds_read_b128 a[64:67], v183 offset:18432
  v_mfma_f32_16x16x32_bf16 v[40:43], a[8:11], a[24:27], v[40:43]
  ds_read_b128 a[68:71], v183 offset:20480
  v_mfma_f32_16x16x32_bf16 v[44:47], a[12:15], a[24:27], v[44:47]
  ds_read_b128 a[72:75], v183 offset:22528
  v_mfma_f32_16x16x32_bf16 v[48:51], a[0:3], a[28:31], v[48:51]
  ds_read_b128 a[76:79], v183 offset:24576
  v_mfma_f32_16x16x32_bf16 v[52:55], a[4:7], a[28:31], v[52:55]
  ds_read_b128 a[80:83], v183 offset:26624
  v_mfma_f32_16x16x32_bf16 v[56:59], a[8:11], a[28:31], v[56:59]
  ds_read_b128 a[84:87], v183 offset:28672
  buffer_load_dwordx4 v240, s[32:35], s50 offen offset:2048 nt lds
  v_mfma_f32_16x16x32_bf16 v[60:63], a[12:15], a[28:31], v[60:63]
  v_mfma_f32_16x16x32_bf16 v[64:67], a[0:3], a[32:35], v[64:67]
  v_mfma_f32_16x16x32_bf16 v[68:71], a[4:7], a[32:35], v[68:71]
  v_mfma_f32_16x16x32_bf16 v[72:75], a[8:11], a[32:35], v[72:75]
  v_mfma_f32_16x16x32_bf16 v[76:79], a[12:15], a[32:35], v[76:79]
  v_mfma_f32_16x16x32_bf16 v[80:83], a[0:3], a[36:39], v[80:83]
  buffer_load_dwordx4 v241, s[32:35], s50 offen offset:3072 nt lds
  v_mfma_f32_16x16x32_bf16 v[84:87], a[4:7], a[36:39], v[84:87]
  v_mfma_f32_16x16x32_bf16 v[88:91], a[8:11], a[36:39], v[88:91]
  v_mfma_f32_16x16x32_bf16 v[92:95], a[12:15], a[36:39], v[92:95]
  v_mfma_f32_16x16x32_bf16 v[96:99], a[0:3], a[40:43], v[96:99]
  v_mfma_f32_16x16x32_bf16 v[100:103], a[4:7], a[40:43], v[100:103]
  v_mfma_f32_16x16x32_bf16 v[104:107], a[8:11], a[40:43], v[104:107]
  v_mfma_f32_16x16x32_bf16 v[108:111], a[12:15], a[40:43], v[108:111]
  s_waitcnt lgkmcnt(0)
  s_barrier
  v_mfma_f32_16x16x32_bf16 v[0:3], a[44:47], a[60:63], v[0:3]
  v_mfma_f32_16x16x32_bf16 v[4:7], a[48:51], a[60:63], v[4:7]
  v_mfma_f32_16x16x32_bf16 v[8:11], a[52:55], a[60:63], v[8:11]
  v_mfma_f32_16x16x32_bf16 v[12:15], a[56:59], a[60:63], v[12:15]
  v_mfma_f32_16x16x32_bf16 v[16:19], a[44:47], a[64:67], v[16:19]
  v_mfma_f32_16x16x32_bf16 v[20:23], a[48:51], a[64:67], v[20:23]
  v_mfma_f32_16x16x32_bf16 v[24:27], a[52:55], a[64:67], v[24:27]
  v_mfma_f32_16x16x32_bf16 v[28:31], a[56:59], a[64:67], v[28:31]
  v_mfma_f32_16x16x32_bf16 v[32:35], a[44:47], a[68:71], v[32:35]
  v_pk_mul_f32 v[0:1], v[0:1], s[62:63]
  v_pk_mul_f32 v[2:3], v[2:3], s[62:63]
  v_pk_mul_f32 v[4:5], v[4:5], s[62:63]
  v_pk_mul_f32 v[6:7], v[6:7], s[62:63]
  v_mfma_f32_16x16x32_bf16 v[36:39], a[48:51], a[68:71], v[36:39]
  v_pk_mul_f32 v[8:9], v[8:9], s[62:63]
  v_pk_mul_f32 v[10:11], v[10:11], s[62:63]
  v_pk_mul_f32 v[12:13], v[12:13], s[62:63]
  v_pk_mul_f32 v[14:15], v[14:15], s[62:63]
  v_mfma_f32_16x16x32_bf16 v[40:43], a[52:55], a[68:71], v[40:43]
  v_cvt_pk_bf16_f32 v0, v0, v1
  v_cvt_pk_bf16_f32 v1, v2, v3
  v_cvt_pk_bf16_f32 v2, v4, v5
  v_cvt_pk_bf16_f32 v3, v6, v7
  v_mfma_f32_16x16x32_bf16 v[44:47], a[56:59], a[68:71], v[44:47]
  v_cvt_pk_bf16_f32 v4, v8, v9
  v_cvt_pk_bf16_f32 v5, v10, v11
  v_cvt_pk_bf16_f32 v6, v12, v13
  v_cvt_pk_bf16_f32 v7, v14, v15
  v_mfma_f32_16x16x32_bf16 v[48:51], a[44:47], a[72:75], v[48:51]
  ds_write_b64 v196, v[0:1] offset:0
  ds_write_b64 v197, v[2:3] offset:0
  ds_write_b64 v198, v[4:5] offset:0
  ds_write_b64 v199, v[6:7] offset:0
  v_mfma_f32_16x16x32_bf16 v[52:55], a[48:51], a[72:75], v[52:55]
  v_pk_mul_f32 v[16:17], v[16:17], s[62:63]
  v_pk_mul_f32 v[18:19], v[18:19], s[62:63]
  v_pk_mul_f32 v[20:21], v[20:21], s[62:63]
  v_pk_mul_f32 v[22:23], v[22:23], s[62:63]
  v_mfma_f32_16x16x32_bf16 v[56:59], a[52:55], a[72:75], v[56:59]
  v_pk_mul_f32 v[24:25], v[24:25], s[62:63]
  v_pk_mul_f32 v[26:27], v[26:27], s[62:63]
  v_pk_mul_f32 v[28:29], v[28:29], s[62:63]
  v_pk_mul_f32 v[30:31], v[30:31], s[62:63]
  v_mfma_f32_16x16x32_bf16 v[60:63], a[56:59], a[72:75], v[60:63]
  v_cvt_pk_bf16_f32 v16, v16, v17
  v_cvt_pk_bf16_f32 v17, v18, v19
  v_cvt_pk_bf16_f32 v18, v20, v21
  v_cvt_pk_bf16_f32 v19, v22, v23
  v_mfma_f32_16x16x32_bf16 v[64:67], a[44:47], a[76:79], v[64:67]
  v_cvt_pk_bf16_f32 v20, v24, v25
  v_cvt_pk_bf16_f32 v21, v26, v27
  v_cvt_pk_bf16_f32 v22, v28, v29
  v_cvt_pk_bf16_f32 v23, v30, v31
  v_mfma_f32_16x16x32_bf16 v[68:71], a[48:51], a[76:79], v[68:71]
  ds_write_b64 v196, v[16:17] offset:4096
  ds_write_b64 v197, v[18:19] offset:4096
  ds_write_b64 v198, v[20:21] offset:4096
  ds_write_b64 v199, v[22:23] offset:4096
  v_mfma_f32_16x16x32_bf16 v[72:75], a[52:55], a[76:79], v[72:75]
  v_pk_mul_f32 v[32:33], v[32:33], s[62:63]
  v_pk_mul_f32 v[34:35], v[34:35], s[62:63]
  v_pk_mul_f32 v[36:37], v[36:37], s[62:63]
  v_pk_mul_f32 v[38:39], v[38:39], s[62:63]
  v_mfma_f32_16x16x32_bf16 v[76:79], a[56:59], a[76:79], v[76:79]
  v_pk_mul_f32 v[40:41], v[40:41], s[62:63]
  v_pk_mul_f32 v[42:43], v[42:43], s[62:63]
  v_pk_mul_f32 v[44:45], v[44:45], s[62:63]
  v_pk_mul_f32 v[46:47], v[46:47], s[62:63]
  v_mfma_f32_16x16x32_bf16 v[80:83], a[44:47], a[80:83], v[80:83]
  v_cvt_pk_bf16_f32 v32, v32, v33
  v_cvt_pk_bf16_f32 v33, v34, v35
  v_cvt_pk_bf16_f32 v34, v36, v37
  v_cvt_pk_bf16_f32 v35, v38, v39
  v_mfma_f32_16x16x32_bf16 v[84:87], a[48:51], a[80:83], v[84:87]
  v_cvt_pk_bf16_f32 v36, v40, v41
  v_cvt_pk_bf16_f32 v37, v42, v43
  v_cvt_pk_bf16_f32 v38, v44, v45
  v_cvt_pk_bf16_f32 v39, v46, v47
  v_mfma_f32_16x16x32_bf16 v[88:91], a[52:55], a[80:83], v[88:91]
  ds_write_b64 v196, v[32:33] offset:8192
  ds_write_b64 v197, v[34:35] offset:8192
  ds_write_b64 v198, v[36:37] offset:8192
  ds_write_b64 v199, v[38:39] offset:8192
  v_mfma_f32_16x16x32_bf16 v[92:95], a[56:59], a[80:83], v[92:95]
  v_pk_mul_f32 v[48:49], v[48:49], s[62:63]
  v_pk_mul_f32 v[50:51], v[50:51], s[62:63]
  v_pk_mul_f32 v[52:53], v[52:53], s[62:63]
  v_pk_mul_f32 v[54:55], v[54:55], s[62:63]
  v_mfma_f32_16x16x32_bf16 v[96:99], a[44:47], a[84:87], v[96:99]
  v_pk_mul_f32 v[56:57], v[56:57], s[62:63]
  v_pk_mul_f32 v[58:59], v[58:59], s[62:63]
  v_pk_mul_f32 v[60:61], v[60:61], s[62:63]
  v_pk_mul_f32 v[62:63], v[62:63], s[62:63]
  v_mfma_f32_16x16x32_bf16 v[100:103], a[48:51], a[84:87], v[100:103]
  v_cvt_pk_bf16_f32 v48, v48, v49
  v_cvt_pk_bf16_f32 v49, v50, v51
  v_cvt_pk_bf16_f32 v50, v52, v53
  v_cvt_pk_bf16_f32 v51, v54, v55
  v_mfma_f32_16x16x32_bf16 v[104:107], a[52:55], a[84:87], v[104:107]
  v_cvt_pk_bf16_f32 v52, v56, v57
  v_cvt_pk_bf16_f32 v53, v58, v59
  v_cvt_pk_bf16_f32 v54, v60, v61
  v_cvt_pk_bf16_f32 v55, v62, v63
  v_mfma_f32_16x16x32_bf16 v[108:111], a[56:59], a[84:87], v[108:111]
  ds_write_b64 v196, v[48:49] offset:12288
  ds_write_b64 v197, v[50:51] offset:12288
  ds_write_b64 v198, v[52:53] offset:12288
  ds_write_b64 v199, v[54:55] offset:12288
  v_pk_mul_f32 v[64:65], v[64:65], s[62:63]
  v_pk_mul_f32 v[66:67], v[66:67], s[62:63]
  v_pk_mul_f32 v[68:69], v[68:69], s[62:63]
  v_pk_mul_f32 v[70:71], v[70:71], s[62:63]
  v_pk_mul_f32 v[72:73], v[72:73], s[62:63]
  v_pk_mul_f32 v[74:75], v[74:75], s[62:63]
  v_pk_mul_f32 v[76:77], v[76:77], s[62:63]
  v_pk_mul_f32 v[78:79], v[78:79], s[62:63]
  v_cvt_pk_bf16_f32 v64, v64, v65
  v_cvt_pk_bf16_f32 v65, v66, v67
  v_cvt_pk_bf16_f32 v66, v68, v69
  v_cvt_pk_bf16_f32 v67, v70, v71
  v_cvt_pk_bf16_f32 v68, v72, v73
  v_cvt_pk_bf16_f32 v69, v74, v75
  v_cvt_pk_bf16_f32 v70, v76, v77
  v_cvt_pk_bf16_f32 v71, v78, v79
  ds_write_b64 v196, v[64:65] offset:16384
  ds_write_b64 v197, v[66:67] offset:16384
  ds_write_b64 v198, v[68:69] offset:16384
  ds_write_b64 v199, v[70:71] offset:16384
  v_pk_mul_f32 v[80:81], v[80:81], s[62:63]
  v_pk_mul_f32 v[82:83], v[82:83], s[62:63]
  v_pk_mul_f32 v[84:85], v[84:85], s[62:63]
  v_pk_mul_f32 v[86:87], v[86:87], s[62:63]
  v_pk_mul_f32 v[88:89], v[88:89], s[62:63]
  v_pk_mul_f32 v[90:91], v[90:91], s[62:63]
  v_pk_mul_f32 v[92:93], v[92:93], s[62:63]
  v_pk_mul_f32 v[94:95], v[94:95], s[62:63]
  v_cvt_pk_bf16_f32 v80, v80, v81
  v_cvt_pk_bf16_f32 v81, v82, v83
  v_cvt_pk_bf16_f32 v82, v84, v85
  v_cvt_pk_bf16_f32 v83, v86, v87
  v_cvt_pk_bf16_f32 v84, v88, v89
  v_cvt_pk_bf16_f32 v85, v90, v91
  v_cvt_pk_bf16_f32 v86, v92, v93
  v_cvt_pk_bf16_f32 v87, v94, v95
  ds_write_b64 v196, v[80:81] offset:20480
  ds_write_b64 v197, v[82:83] offset:20480
  ds_write_b64 v198, v[84:85] offset:20480
  ds_write_b64 v199, v[86:87] offset:20480
  v_pk_mul_f32 v[96:97], v[96:97], s[62:63]
  v_pk_mul_f32 v[98:99], v[98:99], s[62:63]
  v_pk_mul_f32 v[100:101], v[100:101], s[62:63]
  v_pk_mul_f32 v[102:103], v[102:103], s[62:63]
  v_pk_mul_f32 v[104:105], v[104:105], s[62:63]
  v_pk_mul_f32 v[106:107], v[106:107], s[62:63]
  v_pk_mul_f32 v[108:109], v[108:109], s[62:63]
  v_pk_mul_f32 v[110:111], v[110:111], s[62:63]
  v_cvt_pk_bf16_f32 v96, v96, v97
  v_cvt_pk_bf16_f32 v97, v98, v99
  v_cvt_pk_bf16_f32 v98, v100, v101
  v_cvt_pk_bf16_f32 v99, v102, v103
  v_cvt_pk_bf16_f32 v100, v104, v105
  v_cvt_pk_bf16_f32 v101, v106, v107
  v_cvt_pk_bf16_f32 v102, v108, v109
  v_cvt_pk_bf16_f32 v103, v110, v111
  ds_write_b64 v196, v[96:97] offset:24576
  ds_write_b64 v197, v[98:99] offset:24576
  ds_write_b64 v198, v[100:101] offset:24576
  ds_write_b64 v199, v[102:103] offset:24576
  s_waitcnt lgkmcnt(0) vmcnt(8)
  s_barrier
  ds_read_b128 v[112:115], v204 offset:0
  ds_read_b128 v[116:119], v204 offset:64
  ds_read_b128 v[120:123], v204 offset:128
  ds_read_b128 v[124:127], v204 offset:192
  ds_read_b128 a[112:115], v200 offset:0
  ds_read_b128 a[116:119], v201 offset:0
  ds_read_b128 a[120:123], v202 offset:0
  ds_read_b128 a[124:127], v203 offset:0
  ds_read_b128 a[128:131], v200 offset:4096
  ds_read_b128 a[132:135], v201 offset:4096
  ds_read_b128 a[136:139], v202 offset:4096
  ds_read_b128 a[140:143], v203 offset:4096
  ds_read_b128 a[144:147], v200 offset:8192
  ds_read_b128 a[148:151], v201 offset:8192
  ds_read_b128 a[152:155], v202 offset:8192
  s_waitcnt lgkmcnt(11)
  v_xor_b32 v112, 0x80008000, v112
  v_xor_b32 v113, 0x80008000, v113
  v_xor_b32 v114, 0x80008000, v114
  v_xor_b32 v115, 0x80008000, v115
  v_xor_b32 v116, 0x80008000, v116
  v_xor_b32 v117, 0x80008000, v117
  v_xor_b32 v118, 0x80008000, v118
  v_xor_b32 v119, 0x80008000, v119
  v_xor_b32 v120, 0x80008000, v120
  v_xor_b32 v121, 0x80008000, v121
  v_xor_b32 v122, 0x80008000, v122
  v_xor_b32 v123, 0x80008000, v123
  v_xor_b32 v124, 0x80008000, v124
  v_xor_b32 v125, 0x80008000, v125
  v_xor_b32 v126, 0x80008000, v126
  v_xor_b32 v127, 0x80008000, v127
  s_waitcnt lgkmcnt(7)
  v_mfma_f32_16x16x32_bf16 v[168:171], v[112:115], a[112:115], 0
  ds_read_b128 a[156:159], v203 offset:8192
  v_mfma_f32_16x16x32_bf16 v[168:171], v[116:119], a[116:119], v[168:171]
  ds_read_b128 a[160:163], v200 offset:12288
  v_mfma_f32_16x16x32_bf16 v[168:171], v[120:123], a[120:123], v[168:171]
  ds_read_b128 a[164:167], v201 offset:12288
  v_mfma_f32_16x16x32_bf16 v[168:171], v[124:127], a[124:127], v[168:171]
  ds_read_b128 a[168:171], v202 offset:12288
  s_waitcnt lgkmcnt(7)
  v_mfma_f32_16x16x32_bf16 v[172:175], v[112:115], a[128:131], 0
  ds_read_b128 a[172:175], v203 offset:12288
  v_mfma_f32_16x16x32_bf16 v[172:175], v[116:119], a[132:135], v[172:175]
  ds_read_b128 a[176:179], v200 offset:16384
  v_mfma_f32_16x16x32_bf16 v[172:175], v[120:123], a[136:139], v[172:175]
  ds_read_b128 a[180:183], v201 offset:16384
  v_mfma_f32_16x16x32_bf16 v[172:175], v[124:127], a[140:143], v[172:175]
  ds_read_b128 a[184:187], v202 offset:16384
  s_waitcnt lgkmcnt(7)
  v_mfma_f32_16x16x32_bf16 v[176:179], v[112:115], a[144:147], 0
  ds_read_b128 a[188:191], v203 offset:16384
  v_mfma_f32_16x16x32_bf16 v[176:179], v[116:119], a[148:151], v[176:179]
  ds_read_b128 a[192:195], v200 offset:20480
  v_mfma_f32_16x16x32_bf16 v[176:179], v[120:123], a[152:155], v[176:179]
  ds_read_b128 a[196:199], v201 offset:20480
  v_mfma_f32_16x16x32_bf16 v[176:179], v[124:127], a[156:159], v[176:179]
  ds_read_b128 a[200:203], v202 offset:20480
  s_waitcnt lgkmcnt(7)
  v_mfma_f32_16x16x32_bf16 v[180:183], v[112:115], a[160:163], 0
  ds_read_b128 a[204:207], v203 offset:20480
  v_mfma_f32_16x16x32_bf16 v[180:183], v[116:119], a[164:167], v[180:183]
  ds_read_b128 a[208:211], v200 offset:24576
  v_mfma_f32_16x16x32_bf16 v[180:183], v[120:123], a[168:171], v[180:183]
  ds_read_b128 a[212:215], v201 offset:24576
  v_mfma_f32_16x16x32_bf16 v[180:183], v[124:127], a[172:175], v[180:183]
  ds_read_b128 a[216:219], v202 offset:24576
  s_waitcnt lgkmcnt(7)
  v_mfma_f32_16x16x32_bf16 v[184:187], v[112:115], a[176:179], 0
  ds_read_b128 a[220:223], v203 offset:24576
  v_mfma_f32_16x16x32_bf16 v[184:187], v[116:119], a[180:183], v[184:187]
  ds_read_b128 a[224:227], v228 offset:0
  v_mfma_f32_16x16x32_bf16 v[184:187], v[120:123], a[184:187], v[184:187]
  ds_read_b128 a[228:231], v229 offset:0
  v_mfma_f32_16x16x32_bf16 v[184:187], v[124:127], a[188:191], v[184:187]
  ds_read_b128 a[232:235], v230 offset:0
  s_waitcnt lgkmcnt(7)
  v_mfma_f32_16x16x32_bf16 v[188:191], v[112:115], a[192:195], 0
  ds_read_b128 a[236:239], v231 offset:0
  v_mfma_f32_16x16x32_bf16 v[188:191], v[116:119], a[196:199], v[188:191]
  ds_read_b128 a[240:243], v228 offset:4096
  v_mfma_f32_16x16x32_bf16 v[188:191], v[120:123], a[200:203], v[188:191]
  ds_read_b128 a[244:247], v229 offset:4096
  v_mfma_f32_16x16x32_bf16 v[188:191], v[124:127], a[204:207], v[188:191]
  ds_read_b128 a[248:251], v230 offset:4096
  s_waitcnt lgkmcnt(7)
  v_mfma_f32_16x16x32_bf16 v[192:195], v[112:115], a[208:211], 0
  ds_read_b128 a[252:255], v231 offset:4096
  v_mfma_f32_16x16x32_bf16 v[192:195], v[116:119], a[212:215], v[192:195]
  v_mfma_f32_16x16x32_bf16 v[192:195], v[120:123], a[216:219], v[192:195]
  v_mfma_f32_16x16x32_bf16 v[192:195], v[124:127], a[220:223], v[192:195]
  s_waitcnt lgkmcnt(0)
  s_barrier
  s_cmp_eq_u32 s23, 0
  s_cbranch_scc1 L1_A_go
L1_B_go:
  v_mfma_f32_16x16x32_bf16 v[144:147], a[224:227], a[112:115], v[168:171]
  s_add_u32 m0, s27, s28
  s_add_u32 s29, s26, 4096
  buffer_load_dwordx4 v240, s[12:15], s26 offen offset:0 nt lds
  buffer_load_dwordx4 v241, s[12:15], s26 offen offset:1024 nt lds
  v_xor_b32 v228, 0x10000, v228
  v_mfma_f32_16x16x32_bf16 v[144:147], a[228:231], a[116:119], v[144:147]
  buffer_load_dwordx4 v240, s[12:15], s26 offen offset:2048 nt lds
  buffer_load_dwordx4 v241, s[12:15], s26 offen offset:3072 nt lds
  v_xor_b32 v229, 0x10000, v229
  v_mfma_f32_16x16x32_bf16 v[144:147], a[232:235], a[120:123], v[144:147]
  s_add_u32 m0, m0, 4096
  s_xor_b32 s27, s27, 0x10000
  buffer_load_dwordx4 v240, s[12:15], s29 offen offset:0 nt lds
  buffer_load_dwordx4 v241, s[12:15], s29 offen offset:1024 nt lds
  v_xor_b32 v230, 0x10000, v230
  v_mfma_f32_16x16x32_bf16 v[144:147], a[236:239], a[124:127], v[144:147]
  buffer_load_dwordx4 v240, s[12:15], s29 offen offset:2048 nt lds
  buffer_load_dwordx4 v241, s[12:15], s29 offen offset:3072 nt lds
  v_xor_b32 v231, 0x10000, v231
  v_mfma_f32_16x16x32_bf16 v[148:151], a[240:243], a[112:115], v[168:171]
  s_add_u32 m0, m0, 4096
  s_nop 0
  buffer_load_dwordx4 v240, s[32:35], s26 offen offset:0 nt lds
  buffer_load_dwordx4 v241, s[32:35], s26 offen offset:1024 nt lds
  v_mfma_f32_16x16x32_bf16 v[148:151], a[244:247], a[116:119], v[148:151]
  buffer_load_dwordx4 v240, s[32:35], s26 offen offset:2048 nt lds
  buffer_load_dwordx4 v241, s[32:35], s26 offen offset:3072 nt lds
  v_mfma_f32_16x16x32_bf16 v[148:151], a[248:251], a[120:123], v[148:151]
  s_add_u32 m0, m0, 4096
  s_nop 0
  buffer_load_dwordx4 v240, s[32:35], s29 offen offset:0 nt lds
  buffer_load_dwordx4 v241, s[32:35], s29 offen offset:1024 nt lds
  v_mfma_f32_16x16x32_bf16 v[148:151], a[252:255], a[124:127], v[148:151]
  buffer_load_dwordx4 v240, s[32:35], s29 offen offset:2048 nt lds
  buffer_load_dwordx4 v241, s[32:35], s29 offen offset:3072 nt lds
  s_add_u32 s26, s26, 8192
  s_mov_b32 s30, 6
  v_lshlrev_b32 v243, 4, v242
  s_add_u32 s61, s20, s31
  s_sub_u32 s90, 6, s89
  v_add_lshl_u32 v248, v242, s61, 2
  v_mov_b32 v249, 1
  s_waitcnt vmcnt(16)
  v_exp_f32 v144, v144
  ds_read_b64_tr_b16 v[112:113], v232 offset:0
  ds_read_b64_tr_b16 v[114:115], v232 offset:4096
  v_exp_f32 v145, v145
  ds_read_b64_tr_b16 v[116:117], v233 offset:0
  v_cvt_pk_bf16_f32 v160, v144, v145
  ds_read_b64_tr_b16 v[118:119], v233 offset:4096
  v_exp_f32 v146, v146
  ds_read_b64_tr_b16 v[120:121], v234 offset:0
  ds_read_b64_tr_b16 v[122:123], v234 offset:4096
  s_add_u32 m0, s27, s28
  s_add_u32 s29, s26, 4096
  buffer_load_dwordx4 v240, s[12:15], s26 offen offset:0 nt lds
  v_exp_f32 v147, v147
  ds_read_b64_tr_b16 v[124:125], v235 offset:0
  v_cvt_pk_bf16_f32 v161, v146, v147
  ds_read_b64_tr_b16 v[126:127], v235 offset:4096
  v_exp_f32 v148, v148
  ds_read_b64_tr_b16 v[128:129], v236 offset:0
  v_mfma_f32_16x16x32_bf16 v[152:155], a[224:227], a[128:131], v[172:175]
  ds_read_b64_tr_b16 v[130:131], v236 offset:4096
  buffer_load_dwordx4 v241, s[12:15], s26 offen offset:1024 nt lds
  v_mfma_f32_16x16x32_bf16 v[152:155], a[228:231], a[132:135], v[152:155]
  v_exp_f32 v149, v149
  ds_read_b64_tr_b16 v[132:133], v237 offset:0
  v_mfma_f32_16x16x32_bf16 v[152:155], a[232:235], a[136:139], v[152:155]
  v_cvt_pk_bf16_f32 v162, v148, v149
  ds_read_b64_tr_b16 v[134:135], v237 offset:4096
  v_mfma_f32_16x16x32_bf16 v[152:155], a[236:239], a[140:143], v[152:155]
  v_exp_f32 v150, v150
  ds_read_b64_tr_b16 v[136:137], v238 offset:0
  v_mfma_f32_16x16x32_bf16 v[156:159], a[240:243], a[128:131], v[172:175]
  v_exp_f32 v151, v151
  ds_read_b64_tr_b16 v[138:139], v238 offset:4096
  v_mfma_f32_16x16x32_bf16 v[156:159], a[244:247], a[132:135], v[156:159]
  v_cvt_pk_bf16_f32 v163, v150, v151
  ds_read_b64_tr_b16 v[140:141], v239 offset:0
  v_mfma_f32_16x16x32_bf16 v[156:159], a[248:251], a[136:139], v[156:159]
  ds_read_b64_tr_b16 v[142:143], v239 offset:4096
  v_mfma_f32_16x16x32_bf16 v[156:159], a[252:255], a[140:143], v[156:159]
  s_waitcnt lgkmcnt(8)
  v_mfma_f32_16x16x32_bf16 v[0:3], v[112:115], v[160:163], 0
  v_exp_f32 v152, v152
  v_mfma_f32_16x16x32_bf16 v[4:7], v[116:119], v[160:163], 0
  buffer_load_dwordx4 v240, s[12:15], s26 offen offset:2048 nt lds
  v_mfma_f32_16x16x32_bf16 v[8:11], v[120:123], v[160:163], 0
  v_exp_f32 v153, v153
  v_mfma_f32_16x16x32_bf16 v[12:15], v[124:127], v[160:163], 0
  v_cvt_pk_bf16_f32 v164, v152, v153
  s_waitcnt lgkmcnt(0)
  v_mfma_f32_16x16x32_bf16 a[0:3], v[128:131], v[160:163], 0
  v_exp_f32 v154, v154
  v_mfma_f32_16x16x32_bf16 a[4:7], v[132:135], v[160:163], 0
  v_mfma_f32_16x16x32_bf16 a[8:11], v[136:139], v[160:163], 0
  v_exp_f32 v155, v155
  v_mfma_f32_16x16x32_bf16 a[12:15], v[140:143], v[160:163], 0
  v_cvt_pk_bf16_f32 v165, v154, v155
  v_mfma_f32_16x16x32_bf16 v[196:199], v[224:227], v[160:163], 0
  v_exp_f32 v156, v156
  v_mfma_f32_16x16x32_bf16 v[144:147], a[224:227], a[144:147], v[176:179]
  buffer_load_dwordx4 v241, s[12:15], s26 offen offset:3072 nt lds
  v_mfma_f32_16x16x32_bf16 v[144:147], a[228:231], a[148:151], v[144:147]
  v_exp_f32 v157, v157
  v_mfma_f32_16x16x32_bf16 v[144:147], a[232:235], a[152:155], v[144:147]
  v_cvt_pk_bf16_f32 v166, v156, v157
  v_mfma_f32_16x16x32_bf16 v[144:147], a[236:239], a[156:159], v[144:147]
  v_exp_f32 v158, v158
  v_mfma_f32_16x16x32_bf16 v[148:151], a[240:243], a[144:147], v[176:179]
  v_exp_f32 v159, v159
  v_mfma_f32_16x16x32_bf16 v[148:151], a[244:247], a[148:151], v[148:151]
  v_cvt_pk_bf16_f32 v167, v158, v159
  v_mfma_f32_16x16x32_bf16 v[148:151], a[248:251], a[152:155], v[148:151]
  v_mfma_f32_16x16x32_bf16 v[148:151], a[252:255], a[156:159], v[148:151]
  v_xor_b32 v232, 0x10000, v232
  v_xor_b32 v233, 0x10000, v233
  v_mfma_f32_16x16x32_bf16 v[16:19], v[112:115], v[164:167], 0
  v_exp_f32 v144, v144
  v_mfma_f32_16x16x32_bf16 v[20:23], v[116:119], v[164:167], 0
  s_add_u32 m0, m0, 4096
  s_xor_b32 s27, s27, 0x10000
  buffer_load_dwordx4 v240, s[12:15], s29 offen offset:0 nt lds
  v_mfma_f32_16x16x32_bf16 v[24:27], v[120:123], v[164:167], 0
  v_exp_f32 v145, v145
  v_mfma_f32_16x16x32_bf16 v[28:31], v[124:127], v[164:167], 0
  v_cvt_pk_bf16_f32 v160, v144, v145
  v_mfma_f32_16x16x32_bf16 a[16:19], v[128:131], v[164:167], 0
  v_exp_f32 v146, v146
  v_mfma_f32_16x16x32_bf16 a[20:23], v[132:135], v[164:167], 0
  v_mfma_f32_16x16x32_bf16 a[24:27], v[136:139], v[164:167], 0
  v_exp_f32 v147, v147
  v_mfma_f32_16x16x32_bf16 a[28:31], v[140:143], v[164:167], 0
  v_cvt_pk_bf16_f32 v161, v146, v147
  v_mfma_f32_16x16x32_bf16 v[200:203], v[224:227], v[164:167], 0
  v_exp_f32 v148, v148
  v_mfma_f32_16x16x32_bf16 v[152:155], a[224:227], a[160:163], v[180:183]
  buffer_load_dwordx4 v241, s[12:15], s29 offen offset:1024 nt lds
  v_mfma_f32_16x16x32_bf16 v[152:155], a[228:231], a[164:167], v[152:155]
  v_exp_f32 v149, v149
  v_mfma_f32_16x16x32_bf16 v[152:155], a[232:235], a[168:171], v[152:155]
  v_cvt_pk_bf16_f32 v162, v148, v149
  v_mfma_f32_16x16x32_bf16 v[152:155], a[236:239], a[172:175], v[152:155]
  v_exp_f32 v150, v150
  v_mfma_f32_16x16x32_bf16 v[156:159], a[240:243], a[160:163], v[180:183]
  v_exp_f32 v151, v151
  v_mfma_f32_16x16x32_bf16 v[156:159], a[244:247], a[164:167], v[156:159]
  v_cvt_pk_bf16_f32 v163, v150, v151
  v_mfma_f32_16x16x32_bf16 v[156:159], a[248:251], a[168:171], v[156:159]
  buffer_load_dwordx4 v240, s[12:15], s29 offen offset:2048 nt lds
  v_mfma_f32_16x16x32_bf16 v[156:159], a[252:255], a[172:175], v[156:159]
  v_xor_b32 v234, 0x10000, v234
  v_xor_b32 v235, 0x10000, v235
  v_mfma_f32_16x16x32_bf16 v[32:35], v[112:115], v[160:163], 0
  v_exp_f32 v152, v152
  v_mfma_f32_16x16x32_bf16 v[36:39], v[116:119], v[160:163], 0
  v_mfma_f32_16x16x32_bf16 v[40:43], v[120:123], v[160:163], 0
  v_exp_f32 v153, v153
  v_mfma_f32_16x16x32_bf16 v[44:47], v[124:127], v[160:163], 0
  v_cvt_pk_bf16_f32 v164, v152, v153
  v_mfma_f32_16x16x32_bf16 a[32:35], v[128:131], v[160:163], 0
  v_exp_f32 v154, v154
  v_mfma_f32_16x16x32_bf16 a[36:39], v[132:135], v[160:163], 0
  buffer_load_dwordx4 v241, s[12:15], s29 offen offset:3072 nt lds
  v_mfma_f32_16x16x32_bf16 a[40:43], v[136:139], v[160:163], 0
  v_exp_f32 v155, v155
  v_mfma_f32_16x16x32_bf16 a[44:47], v[140:143], v[160:163], 0
  v_cvt_pk_bf16_f32 v165, v154, v155
  v_mfma_f32_16x16x32_bf16 v[204:207], v[224:227], v[160:163], 0
  v_exp_f32 v156, v156
  v_mfma_f32_16x16x32_bf16 v[144:147], a[224:227], a[176:179], v[184:187]
  v_mfma_f32_16x16x32_bf16 v[144:147], a[228:231], a[180:183], v[144:147]
  v_exp_f32 v157, v157
  v_mfma_f32_16x16x32_bf16 v[144:147], a[232:235], a[184:187], v[144:147]
  v_cvt_pk_bf16_f32 v166, v156, v157
  v_mfma_f32_16x16x32_bf16 v[144:147], a[236:239], a[188:191], v[144:147]
  v_exp_f32 v158, v158
  v_mfma_f32_16x16x32_bf16 v[148:151], a[240:243], a[176:179], v[184:187]
  v_exp_f32 v159, v159
  v_mfma_f32_16x16x32_bf16 v[148:151], a[244:247], a[180:183], v[148:151]
  v_cvt_pk_bf16_f32 v167, v158, v159
  v_mfma_f32_16x16x32_bf16 v[148:151], a[248:251], a[184:187], v[148:151]
  s_add_u32 m0, m0, 4096
  s_nop 0
  buffer_load_dwordx4 v240, s[32:35], s26 offen offset:0 nt lds
  v_mfma_f32_16x16x32_bf16 v[148:151], a[252:255], a[188:191], v[148:151]
  v_xor_b32 v236, 0x10000, v236
  v_xor_b32 v237, 0x10000, v237
  v_mfma_f32_16x16x32_bf16 v[48:51], v[112:115], v[164:167], 0
  v_exp_f32 v144, v144
  v_mfma_f32_16x16x32_bf16 v[52:55], v[116:119], v[164:167], 0
  v_mfma_f32_16x16x32_bf16 v[56:59], v[120:123], v[164:167], 0
  v_exp_f32 v145, v145
  v_mfma_f32_16x16x32_bf16 v[60:63], v[124:127], v[164:167], 0
  v_cvt_pk_bf16_f32 v160, v144, v145
  v_mfma_f32_16x16x32_bf16 a[48:51], v[128:131], v[164:167], 0
  v_exp_f32 v146, v146
  v_mfma_f32_16x16x32_bf16 a[52:55], v[132:135], v[164:167], 0
  buffer_load_dwordx4 v241, s[32:35], s26 offen offset:1024 nt lds
  v_mfma_f32_16x16x32_bf16 a[56:59], v[136:139], v[164:167], 0
  v_exp_f32 v147, v147
  v_mfma_f32_16x16x32_bf16 a[60:63], v[140:143], v[164:167], 0
  v_cvt_pk_bf16_f32 v161, v146, v147
  v_mfma_f32_16x16x32_bf16 v[208:211], v[224:227], v[164:167], 0
  v_exp_f32 v148, v148
  v_mfma_f32_16x16x32_bf16 v[152:155], a[224:227], a[192:195], v[188:191]
  buffer_load_dwordx4 v240, s[32:35], s26 offen offset:2048 nt lds
  v_mfma_f32_16x16x32_bf16 v[152:155], a[228:231], a[196:199], v[152:155]
  v_exp_f32 v149, v149
  v_mfma_f32_16x16x32_bf16 v[152:155], a[232:235], a[200:203], v[152:155]
  v_cvt_pk_bf16_f32 v162, v148, v149
  v_mfma_f32_16x16x32_bf16 v[152:155], a[236:239], a[204:207], v[152:155]
  v_exp_f32 v150, v150
  v_mfma_f32_16x16x32_bf16 v[156:159], a[240:243], a[192:195], v[188:191]
  v_exp_f32 v151, v151
  v_mfma_f32_16x16x32_bf16 v[156:159], a[244:247], a[196:199], v[156:159]
  v_cvt_pk_bf16_f32 v163, v150, v151
  v_mfma_f32_16x16x32_bf16 v[156:159], a[248:251], a[200:203], v[156:159]
  v_mfma_f32_16x16x32_bf16 v[156:159], a[252:255], a[204:207], v[156:159]
  v_xor_b32 v238, 0x10000, v238
  v_xor_b32 v239, 0x10000, v239
  v_mfma_f32_16x16x32_bf16 v[64:67], v[112:115], v[160:163], 0
  v_exp_f32 v152, v152
  v_mfma_f32_16x16x32_bf16 v[68:71], v[116:119], v[160:163], 0
  buffer_load_dwordx4 v241, s[32:35], s26 offen offset:3072 nt lds
  v_mfma_f32_16x16x32_bf16 v[72:75], v[120:123], v[160:163], 0
  v_exp_f32 v153, v153
  v_mfma_f32_16x16x32_bf16 v[76:79], v[124:127], v[160:163], 0
  v_cvt_pk_bf16_f32 v164, v152, v153
  v_mfma_f32_16x16x32_bf16 a[64:67], v[128:131], v[160:163], 0
  v_exp_f32 v154, v154
  v_mfma_f32_16x16x32_bf16 a[68:71], v[132:135], v[160:163], 0
  v_mfma_f32_16x16x32_bf16 a[72:75], v[136:139], v[160:163], 0
  v_exp_f32 v155, v155
  v_mfma_f32_16x16x32_bf16 a[76:79], v[140:143], v[160:163], 0
  v_cvt_pk_bf16_f32 v165, v154, v155
  v_mfma_f32_16x16x32_bf16 v[212:215], v[224:227], v[160:163], 0
  v_exp_f32 v156, v156
  v_mfma_f32_16x16x32_bf16 v[144:147], a[224:227], a[208:211], v[192:195]
  s_add_u32 m0, m0, 4096
  s_nop 0
  buffer_load_dwordx4 v240, s[32:35], s29 offen offset:0 nt lds
  v_mfma_f32_16x16x32_bf16 v[144:147], a[228:231], a[212:215], v[144:147]
  v_exp_f32 v157, v157
  s_waitcnt vmcnt(21)
  v_mfma_f32_16x16x32_bf16 v[144:147], a[232:235], a[216:219], v[144:147]
  v_cvt_pk_bf16_f32 v166, v156, v157
  ds_read_b128 a[224:227], v228 offset:0
  v_mfma_f32_16x16x32_bf16 v[144:147], a[236:239], a[220:223], v[144:147]
  v_exp_f32 v158, v158
  v_mfma_f32_16x16x32_bf16 v[148:151], a[240:243], a[208:211], v[192:195]
  v_exp_f32 v159, v159
  v_mfma_f32_16x16x32_bf16 v[148:151], a[244:247], a[212:215], v[148:151]
  v_cvt_pk_bf16_f32 v167, v158, v159
  ds_read_b128 a[228:231], v229 offset:0
  v_mfma_f32_16x16x32_bf16 v[148:151], a[248:251], a[216:219], v[148:151]
  ds_read_b128 a[232:235], v230 offset:0
  ds_read_b128 a[236:239], v231 offset:0
  v_mfma_f32_16x16x32_bf16 v[148:151], a[252:255], a[220:223], v[148:151]
  ds_read_b128 a[240:243], v228 offset:4096
  ds_read_b128 a[244:247], v229 offset:4096
  v_mfma_f32_16x16x32_bf16 v[80:83], v[112:115], v[164:167], 0
  v_exp_f32 v144, v144
  v_mfma_f32_16x16x32_bf16 v[84:87], v[116:119], v[164:167], 0
  ds_read_b128 a[248:251], v230 offset:4096
  ds_read_b128 a[252:255], v231 offset:4096
  v_mfma_f32_16x16x32_bf16 v[88:91], v[120:123], v[164:167], 0
  v_exp_f32 v145, v145
  v_mfma_f32_16x16x32_bf16 v[92:95], v[124:127], v[164:167], 0
  v_cvt_pk_bf16_f32 v160, v144, v145
  v_mfma_f32_16x16x32_bf16 a[80:83], v[128:131], v[164:167], 0
  v_exp_f32 v146, v146
  v_mfma_f32_16x16x32_bf16 a[84:87], v[132:135], v[164:167], 0
  buffer_load_dwordx4 v241, s[32:35], s29 offen offset:1024 nt lds
  v_mfma_f32_16x16x32_bf16 a[88:91], v[136:139], v[164:167], 0
  v_exp_f32 v147, v147
  v_mfma_f32_16x16x32_bf16 a[92:95], v[140:143], v[164:167], 0
  v_cvt_pk_bf16_f32 v161, v146, v147
  v_mfma_f32_16x16x32_bf16 v[216:219], v[224:227], v[164:167], 0
  v_exp_f32 v148, v148
  s_waitcnt lgkmcnt(0)
  v_mfma_f32_16x16x32_bf16 v[152:155], a[224:227], a[112:115], v[168:171]
  buffer_load_dwordx4 v240, s[32:35], s29 offen offset:2048 nt lds
  v_mfma_f32_16x16x32_bf16 v[152:155], a[228:231], a[116:119], v[152:155]
  v_exp_f32 v149, v149
  v_mfma_f32_16x16x32_bf16 v[152:155], a[232:235], a[120:123], v[152:155]
  v_cvt_pk_bf16_f32 v162, v148, v149
  v_mfma_f32_16x16x32_bf16 v[152:155], a[236:239], a[124:127], v[152:155]
  v_exp_f32 v150, v150
  v_mfma_f32_16x16x32_bf16 v[156:159], a[240:243], a[112:115], v[168:171]
  v_exp_f32 v151, v151
  v_mfma_f32_16x16x32_bf16 v[156:159], a[244:247], a[116:119], v[156:159]
  v_cvt_pk_bf16_f32 v163, v150, v151
  v_mfma_f32_16x16x32_bf16 v[156:159], a[248:251], a[120:123], v[156:159]
  buffer_load_dwordx4 v241, s[32:35], s29 offen offset:3072 nt lds
  s_add_u32 s26, s26, 8192
  v_xor_b32 v228, 0x10000, v228
  v_xor_b32 v229, 0x10000, v229
  v_mfma_f32_16x16x32_bf16 v[156:159], a[252:255], a[124:127], v[156:159]
  v_xor_b32 v230, 0x10000, v230
  v_xor_b32 v231, 0x10000, v231
  s_waitcnt vmcnt(16)
  v_mfma_f32_16x16x32_bf16 v[96:99], v[112:115], v[160:163], 0
  v_exp_f32 v152, v152
  ds_read_b64_tr_b16 v[112:113], v232 offset:0
  v_mfma_f32_16x16x32_bf16 v[100:103], v[116:119], v[160:163], 0
  ds_read_b64_tr_b16 v[114:115], v232 offset:4096
  v_mfma_f32_16x16x32_bf16 v[104:107], v[120:123], v[160:163], 0
  v_exp_f32 v153, v153
  ds_read_b64_tr_b16 v[116:117], v233 offset:0
  v_mfma_f32_16x16x32_bf16 v[108:111], v[124:127], v[160:163], 0
  v_cvt_pk_bf16_f32 v164, v152, v153
  ds_read_b64_tr_b16 v[118:119], v233 offset:4096
  v_mfma_f32_16x16x32_bf16 a[96:99], v[128:131], v[160:163], 0
  v_exp_f32 v154, v154
  ds_read_b64_tr_b16 v[120:121], v234 offset:0
  v_mfma_f32_16x16x32_bf16 a[100:103], v[132:135], v[160:163], 0
  ds_read_b64_tr_b16 v[122:123], v234 offset:4096
  s_add_u32 m0, s27, s28
  s_add_u32 s29, s26, 4096
  buffer_load_dwordx4 v240, s[12:15], s26 offen offset:0 nt lds
  v_mfma_f32_16x16x32_bf16 a[104:107], v[136:139], v[160:163], 0
  v_exp_f32 v155, v155
  ds_read_b64_tr_b16 v[124:125], v235 offset:0
  v_mfma_f32_16x16x32_bf16 a[108:111], v[140:143], v[160:163], 0
  v_cvt_pk_bf16_f32 v165, v154, v155
  ds_read_b64_tr_b16 v[126:127], v235 offset:4096
  v_mfma_f32_16x16x32_bf16 v[220:223], v[224:227], v[160:163], 0
  v_exp_f32 v156, v156
  ds_read_b64_tr_b16 v[128:129], v236 offset:0
  v_mfma_f32_16x16x32_bf16 v[144:147], a[224:227], a[128:131], v[172:175]
  ds_read_b64_tr_b16 v[130:131], v236 offset:4096
  buffer_load_dwordx4 v241, s[12:15], s26 offen offset:1024 nt lds
  v_mfma_f32_16x16x32_bf16 v[144:147], a[228:231], a[132:135], v[144:147]
  v_exp_f32 v157, v157
  ds_read_b64_tr_b16 v[132:133], v237 offset:0
  v_mfma_f32_16x16x32_bf16 v[144:147], a[232:235], a[136:139], v[144:147]
  v_cvt_pk_bf16_f32 v166, v156, v157
  ds_read_b64_tr_b16 v[134:135], v237 offset:4096
  v_mfma_f32_16x16x32_bf16 v[144:147], a[236:239], a[140:143], v[144:147]
  v_exp_f32 v158, v158
  ds_read_b64_tr_b16 v[136:137], v238 offset:0
  v_mfma_f32_16x16x32_bf16 v[148:151], a[240:243], a[128:131], v[172:175]
  v_exp_f32 v159, v159
  ds_read_b64_tr_b16 v[138:139], v238 offset:4096
  v_mfma_f32_16x16x32_bf16 v[148:151], a[244:247], a[132:135], v[148:151]
  v_cvt_pk_bf16_f32 v167, v158, v159
  ds_read_b64_tr_b16 v[140:141], v239 offset:0
  v_mfma_f32_16x16x32_bf16 v[148:151], a[248:251], a[136:139], v[148:151]
  ds_read_b64_tr_b16 v[142:143], v239 offset:4096
  v_mfma_f32_16x16x32_bf16 v[148:151], a[252:255], a[140:143], v[148:151]
  s_waitcnt lgkmcnt(8)
  v_mfma_f32_16x16x32_bf16 v[0:3], v[112:115], v[164:167], v[0:3]
  v_exp_f32 v144, v144
  v_mfma_f32_16x16x32_bf16 v[4:7], v[116:119], v[164:167], v[4:7]
  buffer_load_dwordx4 v240, s[12:15], s26 offen offset:2048 nt lds
  v_mfma_f32_16x16x32_bf16 v[8:11], v[120:123], v[164:167], v[8:11]
  v_exp_f32 v145, v145
  v_mfma_f32_16x16x32_bf16 v[12:15], v[124:127], v[164:167], v[12:15]
  v_cvt_pk_bf16_f32 v160, v144, v145
  s_waitcnt lgkmcnt(0)
  v_mfma_f32_16x16x32_bf16 a[0:3], v[128:131], v[164:167], a[0:3]
  v_exp_f32 v146, v146
  v_mfma_f32_16x16x32_bf16 a[4:7], v[132:135], v[164:167], a[4:7]
  v_mfma_f32_16x16x32_bf16 a[8:11], v[136:139], v[164:167], a[8:11]
  v_exp_f32 v147, v147
  v_mfma_f32_16x16x32_bf16 a[12:15], v[140:143], v[164:167], a[12:15]
  v_cvt_pk_bf16_f32 v161, v146, v147
  v_mfma_f32_16x16x32_bf16 v[196:199], v[224:227], v[164:167], v[196:199]
  v_exp_f32 v148, v148
  v_mfma_f32_16x16x32_bf16 v[152:155], a[224:227], a[144:147], v[176:179]
  buffer_load_dwordx4 v241, s[12:15], s26 offen offset:3072 nt lds
  v_mfma_f32_16x16x32_bf16 v[152:155], a[228:231], a[148:151], v[152:155]
  v_exp_f32 v149, v149
  v_mfma_f32_16x16x32_bf16 v[152:155], a[232:235], a[152:155], v[152:155]
  v_cvt_pk_bf16_f32 v162, v148, v149
  v_mfma_f32_16x16x32_bf16 v[152:155], a[236:239], a[156:159], v[152:155]
  v_exp_f32 v150, v150
  v_mfma_f32_16x16x32_bf16 v[156:159], a[240:243], a[144:147], v[176:179]
  v_exp_f32 v151, v151
  v_mfma_f32_16x16x32_bf16 v[156:159], a[244:247], a[148:151], v[156:159]
  v_cvt_pk_bf16_f32 v163, v150, v151
  v_mfma_f32_16x16x32_bf16 v[156:159], a[248:251], a[152:155], v[156:159]
  v_mfma_f32_16x16x32_bf16 v[156:159], a[252:255], a[156:159], v[156:159]
  v_xor_b32 v232, 0x10000, v232
  v_xor_b32 v233, 0x10000, v233
  v_mfma_f32_16x16x32_bf16 v[16:19], v[112:115], v[160:163], v[16:19]
  v_exp_f32 v152, v152
  v_mfma_f32_16x16x32_bf16 v[20:23], v[116:119], v[160:163], v[20:23]
  s_add_u32 m0, m0, 4096
  s_xor_b32 s27, s27, 0x10000
  buffer_load_dwordx4 v240, s[12:15], s29 offen offset:0 nt lds
  v_mfma_f32_16x16x32_bf16 v[24:27], v[120:123], v[160:163], v[24:27]
  v_exp_f32 v153, v153
  v_mfma_f32_16x16x32_bf16 v[28:31], v[124:127], v[160:163], v[28:31]
  v_cvt_pk_bf16_f32 v164, v152, v153
  v_mfma_f32_16x16x32_bf16 a[16:19], v[128:131], v[160:163], a[16:19]
  v_exp_f32 v154, v154
  v_mfma_f32_16x16x32_bf16 a[20:23], v[132:135], v[160:163], a[20:23]
  v_mfma_f32_16x16x32_bf16 a[24:27], v[136:139], v[160:163], a[24:27]
  v_exp_f32 v155, v155
  v_mfma_f32_16x16x32_bf16 a[28:31], v[140:143], v[160:163], a[28:31]
  v_cvt_pk_bf16_f32 v165, v154, v155
  v_mfma_f32_16x16x32_bf16 v[200:203], v[224:227], v[160:163], v[200:203]
  v_exp_f32 v156, v156
  v_mfma_f32_16x16x32_bf16 v[144:147], a[224:227], a[160:163], v[180:183]
  buffer_load_dwordx4 v241, s[12:15], s29 offen offset:1024 nt lds
  v_mfma_f32_16x16x32_bf16 v[144:147], a[228:231], a[164:167], v[144:147]
  v_exp_f32 v157, v157
  v_mfma_f32_16x16x32_bf16 v[144:147], a[232:235], a[168:171], v[144:147]
  v_cvt_pk_bf16_f32 v166, v156, v157
  v_mfma_f32_16x16x32_bf16 v[144:147], a[236:239], a[172:175], v[144:147]
  v_exp_f32 v158, v158
  v_mfma_f32_16x16x32_bf16 v[148:151], a[240:243], a[160:163], v[180:183]
  v_exp_f32 v159, v159
  v_mfma_f32_16x16x32_bf16 v[148:151], a[244:247], a[164:167], v[148:151]
  v_cvt_pk_bf16_f32 v167, v158, v159
  v_mfma_f32_16x16x32_bf16 v[148:151], a[248:251], a[168:171], v[148:151]
  buffer_load_dwordx4 v240, s[12:15], s29 offen offset:2048 nt lds
  v_mfma_f32_16x16x32_bf16 v[148:151], a[252:255], a[172:175], v[148:151]
  v_xor_b32 v234, 0x10000, v234
  v_xor_b32 v235, 0x10000, v235
  v_mfma_f32_16x16x32_bf16 v[32:35], v[112:115], v[164:167], v[32:35]
  v_exp_f32 v144, v144
  v_mfma_f32_16x16x32_bf16 v[36:39], v[116:119], v[164:167], v[36:39]
  v_mfma_f32_16x16x32_bf16 v[40:43], v[120:123], v[164:167], v[40:43]
  v_exp_f32 v145, v145
  v_mfma_f32_16x16x32_bf16 v[44:47], v[124:127], v[164:167], v[44:47]
  v_cvt_pk_bf16_f32 v160, v144, v145
  v_mfma_f32_16x16x32_bf16 a[32:35], v[128:131], v[164:167], a[32:35]
  v_exp_f32 v146, v146
  v_mfma_f32_16x16x32_bf16 a[36:39], v[132:135], v[164:167], a[36:39]
  buffer_load_dwordx4 v241, s[12:15], s29 offen offset:3072 nt lds
  v_mfma_f32_16x16x32_bf16 a[40:43], v[136:139], v[164:167], a[40:43]
  v_exp_f32 v147, v147
  v_mfma_f32_16x16x32_bf16 a[44:47], v[140:143], v[164:167], a[44:47]
  v_cvt_pk_bf16_f32 v161, v146, v147
  v_mfma_f32_16x16x32_bf16 v[204:207], v[224:227], v[164:167], v[204:207]
  v_exp_f32 v148, v148
  v_mfma_f32_16x16x32_bf16 v[152:155], a[224:227], a[176:179], v[184:187]
  v_mfma_f32_16x16x32_bf16 v[152:155], a[228:231], a[180:183], v[152:155]
  v_exp_f32 v149, v149
  v_mfma_f32_16x16x32_bf16 v[152:155], a[232:235], a[184:187], v[152:155]
  v_cvt_pk_bf16_f32 v162, v148, v149
  v_mfma_f32_16x16x32_bf16 v[152:155], a[236:239], a[188:191], v[152:155]
  v_exp_f32 v150, v150
  v_mfma_f32_16x16x32_bf16 v[156:159], a[240:243], a[176:179], v[184:187]
  v_exp_f32 v151, v151
  v_mfma_f32_16x16x32_bf16 v[156:159], a[244:247], a[180:183], v[156:159]
  v_cvt_pk_bf16_f32 v163, v150, v151
  v_mfma_f32_16x16x32_bf16 v[156:159], a[248:251], a[184:187], v[156:159]
  s_add_u32 m0, m0, 4096
  s_nop 0
  buffer_load_dwordx4 v240, s[32:35], s26 offen offset:0 nt lds
  v_mfma_f32_16x16x32_bf16 v[156:159], a[252:255], a[188:191], v[156:159]
  v_xor_b32 v236, 0x10000, v236
  v_xor_b32 v237, 0x10000, v237
  v_mfma_f32_16x16x32_bf16 v[48:51], v[112:115], v[160:163], v[48:51]
  v_exp_f32 v152, v152
  v_mfma_f32_16x16x32_bf16 v[52:55], v[116:119], v[160:163], v[52:55]
  v_mfma_f32_16x16x32_bf16 v[56:59], v[120:123], v[160:163], v[56:59]
  v_exp_f32 v153, v153
  v_mfma_f32_16x16x32_bf16 v[60:63], v[124:127], v[160:163], v[60:63]
  v_cvt_pk_bf16_f32 v164, v152, v153
  v_mfma_f32_16x16x32_bf16 a[48:51], v[128:131], v[160:163], a[48:51]
  v_exp_f32 v154, v154
  v_mfma_f32_16x16x32_bf16 a[52:55], v[132:135], v[160:163], a[52:55]
  buffer_load_dwordx4 v241, s[32:35], s26 offen offset:1024 nt lds
  v_mfma_f32_16x16x32_bf16 a[56:59], v[136:139], v[160:163], a[56:59]
  v_exp_f32 v155, v155
  v_mfma_f32_16x16x32_bf16 a[60:63], v[140:143], v[160:163], a[60:63]
  v_cvt_pk_bf16_f32 v165, v154, v155
  v_mfma_f32_16x16x32_bf16 v[208:211], v[224:227], v[160:163], v[208:211]
  v_exp_f32 v156, v156
  v_mfma_f32_16x16x32_bf16 v[144:147], a[224:227], a[192:195], v[188:191]
  buffer_load_dwordx4 v240, s[32:35], s26 offen offset:2048 nt lds
  v_mfma_f32_16x16x32_bf16 v[144:147], a[228:231], a[196:199], v[144:147]
  v_exp_f32 v157, v157
  v_mfma_f32_16x16x32_bf16 v[144:147], a[232:235], a[200:203], v[144:147]
  v_cvt_pk_bf16_f32 v166, v156, v157
  v_mfma_f32_16x16x32_bf16 v[144:147], a[236:239], a[204:207], v[144:147]
  v_exp_f32 v158, v158
  v_mfma_f32_16x16x32_bf16 v[148:151], a[240:243], a[192:195], v[188:191]
  v_exp_f32 v159, v159
  v_mfma_f32_16x16x32_bf16 v[148:151], a[244:247], a[196:199], v[148:151]
  v_cvt_pk_bf16_f32 v167, v158, v159
  v_mfma_f32_16x16x32_bf16 v[148:151], a[248:251], a[200:203], v[148:151]
  v_mfma_f32_16x16x32_bf16 v[148:151], a[252:255], a[204:207], v[148:151]
  v_xor_b32 v238, 0x10000, v238
  v_xor_b32 v239, 0x10000, v239
  v_mfma_f32_16x16x32_bf16 v[64:67], v[112:115], v[164:167], v[64:67]
  v_exp_f32 v144, v144
  v_mfma_f32_16x16x32_bf16 v[68:71], v[116:119], v[164:167], v[68:71]
  buffer_load_dwordx4 v241, s[32:35], s26 offen offset:3072 nt lds
  v_mfma_f32_16x16x32_bf16 v[72:75], v[120:123], v[164:167], v[72:75]
  v_exp_f32 v145, v145
  v_mfma_f32_16x16x32_bf16 v[76:79], v[124:127], v[164:167], v[76:79]
  v_cvt_pk_bf16_f32 v160, v144, v145
  v_mfma_f32_16x16x32_bf16 a[64:67], v[128:131], v[164:167], a[64:67]
  v_exp_f32 v146, v146
  v_mfma_f32_16x16x32_bf16 a[68:71], v[132:135], v[164:167], a[68:71]
  v_mfma_f32_16x16x32_bf16 a[72:75], v[136:139], v[164:167], a[72:75]
  v_exp_f32 v147, v147
  v_mfma_f32_16x16x32_bf16 a[76:79], v[140:143], v[164:167], a[76:79]
  v_cvt_pk_bf16_f32 v161, v146, v147
  v_mfma_f32_16x16x32_bf16 v[212:215], v[224:227], v[164:167], v[212:215]
  v_exp_f32 v148, v148
  v_mfma_f32_16x16x32_bf16 v[152:155], a[224:227], a[208:211], v[192:195]
  s_add_u32 m0, m0, 4096
  s_nop 0
  buffer_load_dwordx4 v240, s[32:35], s29 offen offset:0 nt lds
  v_mfma_f32_16x16x32_bf16 v[152:155], a[228:231], a[212:215], v[152:155]
  v_exp_f32 v149, v149
  s_waitcnt vmcnt(21)
  v_mfma_f32_16x16x32_bf16 v[152:155], a[232:235], a[216:219], v[152:155]
  v_cvt_pk_bf16_f32 v162, v148, v149
  ds_read_b128 a[224:227], v228 offset:0
  v_mfma_f32_16x16x32_bf16 v[152:155], a[236:239], a[220:223], v[152:155]
  v_exp_f32 v150, v150
  v_mfma_f32_16x16x32_bf16 v[156:159], a[240:243], a[208:211], v[192:195]
  v_exp_f32 v151, v151
  v_mfma_f32_16x16x32_bf16 v[156:159], a[244:247], a[212:215], v[156:159]
  v_cvt_pk_bf16_f32 v163, v150, v151
  ds_read_b128 a[228:231], v229 offset:0
  v_mfma_f32_16x16x32_bf16 v[156:159], a[248:251], a[216:219], v[156:159]
  ds_read_b128 a[232:235], v230 offset:0
  ds_read_b128 a[236:239], v231 offset:0
  v_mfma_f32_16x16x32_bf16 v[156:159], a[252:255], a[220:223], v[156:159]
  ds_read_b128 a[240:243], v228 offset:4096
  ds_read_b128 a[244:247], v229 offset:4096
  v_mfma_f32_16x16x32_bf16 v[80:83], v[112:115], v[160:163], v[80:83]
  v_exp_f32 v152, v152
  v_mfma_f32_16x16x32_bf16 v[84:87], v[116:119], v[160:163], v[84:87]
  ds_read_b128 a[248:251], v230 offset:4096
  ds_read_b128 a[252:255], v231 offset:4096
  v_mfma_f32_16x16x32_bf16 v[88:91], v[120:123], v[160:163], v[88:91]
  v_exp_f32 v153, v153
  v_mfma_f32_16x16x32_bf16 v[92:95], v[124:127], v[160:163], v[92:95]
  v_cvt_pk_bf16_f32 v164, v152, v153
  v_mfma_f32_16x16x32_bf16 a[80:83], v[128:131], v[160:163], a[80:83]
  v_exp_f32 v154, v154
  v_mfma_f32_16x16x32_bf16 a[84:87], v[132:135], v[160:163], a[84:87]
  buffer_load_dwordx4 v241, s[32:35], s29 offen offset:1024 nt lds
  v_mfma_f32_16x16x32_bf16 a[88:91], v[136:139], v[160:163], a[88:91]
  v_exp_f32 v155, v155
  v_mfma_f32_16x16x32_bf16 a[92:95], v[140:143], v[160:163], a[92:95]
  v_cvt_pk_bf16_f32 v165, v154, v155
  v_mfma_f32_16x16x32_bf16 v[216:219], v[224:227], v[160:163], v[216:219]
  v_exp_f32 v156, v156
  s_waitcnt lgkmcnt(0)
  v_mfma_f32_16x16x32_bf16 v[144:147], a[224:227], a[112:115], v[168:171]
  buffer_load_dwordx4 v240, s[32:35], s29 offen offset:2048 nt lds
  v_mfma_f32_16x16x32_bf16 v[144:147], a[228:231], a[116:119], v[144:147]
  v_exp_f32 v157, v157
  v_mfma_f32_16x16x32_bf16 v[144:147], a[232:235], a[120:123], v[144:147]
  v_cvt_pk_bf16_f32 v166, v156, v157
  v_mfma_f32_16x16x32_bf16 v[144:147], a[236:239], a[124:127], v[144:147]
  v_exp_f32 v158, v158
  v_mfma_f32_16x16x32_bf16 v[148:151], a[240:243], a[112:115], v[168:171]
  v_exp_f32 v159, v159
  v_mfma_f32_16x16x32_bf16 v[148:151], a[244:247], a[116:119], v[148:151]
  v_cvt_pk_bf16_f32 v167, v158, v159
  v_mfma_f32_16x16x32_bf16 v[148:151], a[248:251], a[120:123], v[148:151]
  buffer_load_dwordx4 v241, s[32:35], s29 offen offset:3072 nt lds
  s_add_u32 s26, s26, 8192
  v_xor_b32 v228, 0x10000, v228
  v_xor_b32 v229, 0x10000, v229
  v_mfma_f32_16x16x32_bf16 v[148:151], a[252:255], a[124:127], v[148:151]
  v_xor_b32 v230, 0x10000, v230
  v_xor_b32 v231, 0x10000, v231
L1_B_loop:
  s_waitcnt vmcnt(16)
  v_mfma_f32_16x16x32_bf16 v[96:99], v[112:115], v[164:167], v[96:99]
  v_exp_f32 v144, v144
  ds_read_b64_tr_b16 v[112:113], v232 offset:0
  v_mfma_f32_16x16x32_bf16 v[100:103], v[116:119], v[164:167], v[100:103]
  ds_read_b64_tr_b16 v[114:115], v232 offset:4096
  v_mfma_f32_16x16x32_bf16 v[104:107], v[120:123], v[164:167], v[104:107]
  v_exp_f32 v145, v145
  ds_read_b64_tr_b16 v[116:117], v233 offset:0
  v_mfma_f32_16x16x32_bf16 v[108:111], v[124:127], v[164:167], v[108:111]
  v_cvt_pk_bf16_f32 v160, v144, v145
  ds_read_b64_tr_b16 v[118:119], v233 offset:4096
  v_mfma_f32_16x16x32_bf16 a[96:99], v[128:131], v[164:167], a[96:99]
  v_exp_f32 v146, v146
  ds_read_b64_tr_b16 v[120:121], v234 offset:0
  v_mfma_f32_16x16x32_bf16 a[100:103], v[132:135], v[164:167], a[100:103]
  ds_read_b64_tr_b16 v[122:123], v234 offset:4096
  s_add_u32 m0, s27, s28
  s_add_u32 s29, s26, 4096
  buffer_load_dwordx4 v240, s[12:15], s26 offen offset:0 nt lds
  v_mfma_f32_16x16x32_bf16 a[104:107], v[136:139], v[164:167], a[104:107]
  v_exp_f32 v147, v147
  ds_read_b64_tr_b16 v[124:125], v235 offset:0
  v_mfma_f32_16x16x32_bf16 a[108:111], v[140:143], v[164:167], a[108:111]
  v_cvt_pk_bf16_f32 v161, v146, v147
  ds_read_b64_tr_b16 v[126:127], v235 offset:4096
  v_mfma_f32_16x16x32_bf16 v[220:223], v[224:227], v[164:167], v[220:223]
  v_exp_f32 v148, v148
  ds_read_b64_tr_b16 v[128:129], v236 offset:0
  v_mfma_f32_16x16x32_bf16 v[152:155], a[224:227], a[128:131], v[172:175]
  ds_read_b64_tr_b16 v[130:131], v236 offset:4096
  buffer_load_dwordx4 v241, s[12:15], s26 offen offset:1024 nt lds
  v_mfma_f32_16x16x32_bf16 v[152:155], a[228:231], a[132:135], v[152:155]
  v_exp_f32 v149, v149
  ds_read_b64_tr_b16 v[132:133], v237 offset:0
  v_mfma_f32_16x16x32_bf16 v[152:155], a[232:235], a[136:139], v[152:155]
  v_cvt_pk_bf16_f32 v162, v148, v149
  ds_read_b64_tr_b16 v[134:135], v237 offset:4096
  v_mfma_f32_16x16x32_bf16 v[152:155], a[236:239], a[140:143], v[152:155]
  v_exp_f32 v150, v150
  ds_read_b64_tr_b16 v[136:137], v238 offset:0
  v_mfma_f32_16x16x32_bf16 v[156:159], a[240:243], a[128:131], v[172:175]
  v_exp_f32 v151, v151
  ds_read_b64_tr_b16 v[138:139], v238 offset:4096
  v_mfma_f32_16x16x32_bf16 v[156:159], a[244:247], a[132:135], v[156:159]
  v_cvt_pk_bf16_f32 v163, v150, v151
  ds_read_b64_tr_b16 v[140:141], v239 offset:0
  v_mfma_f32_16x16x32_bf16 v[156:159], a[248:251], a[136:139], v[156:159]
  ds_read_b64_tr_b16 v[142:143], v239 offset:4096
  v_mfma_f32_16x16x32_bf16 v[156:159], a[252:255], a[140:143], v[156:159]
  s_waitcnt lgkmcnt(8)
  v_mfma_f32_16x16x32_bf16 v[0:3], v[112:115], v[160:163], v[0:3]
  v_exp_f32 v152, v152
  v_mfma_f32_16x16x32_bf16 v[4:7], v[116:119], v[160:163], v[4:7]
  buffer_load_dwordx4 v240, s[12:15], s26 offen offset:2048 nt lds
  v_mfma_f32_16x16x32_bf16 v[8:11], v[120:123], v[160:163], v[8:11]
  v_exp_f32 v153, v153
  v_mfma_f32_16x16x32_bf16 v[12:15], v[124:127], v[160:163], v[12:15]
  v_cvt_pk_bf16_f32 v164, v152, v153
  s_waitcnt lgkmcnt(0)
  v_mfma_f32_16x16x32_bf16 a[0:3], v[128:131], v[160:163], a[0:3]
  v_exp_f32 v154, v154
  v_mfma_f32_16x16x32_bf16 a[4:7], v[132:135], v[160:163], a[4:7]
  v_mfma_f32_16x16x32_bf16 a[8:11], v[136:139], v[160:163], a[8:11]
  v_exp_f32 v155, v155
  v_mfma_f32_16x16x32_bf16 a[12:15], v[140:143], v[160:163], a[12:15]
  v_cvt_pk_bf16_f32 v165, v154, v155
  v_mfma_f32_16x16x32_bf16 v[196:199], v[224:227], v[160:163], v[196:199]
  v_exp_f32 v156, v156
  v_mfma_f32_16x16x32_bf16 v[144:147], a[224:227], a[144:147], v[176:179]
  buffer_load_dwordx4 v241, s[12:15], s26 offen offset:3072 nt lds
  v_mfma_f32_16x16x32_bf16 v[144:147], a[228:231], a[148:151], v[144:147]
  v_exp_f32 v157, v157
  v_mfma_f32_16x16x32_bf16 v[144:147], a[232:235], a[152:155], v[144:147]
  v_cvt_pk_bf16_f32 v166, v156, v157
  v_mfma_f32_16x16x32_bf16 v[144:147], a[236:239], a[156:159], v[144:147]
  v_exp_f32 v158, v158
  v_mfma_f32_16x16x32_bf16 v[148:151], a[240:243], a[144:147], v[176:179]
  v_exp_f32 v159, v159
  v_mfma_f32_16x16x32_bf16 v[148:151], a[244:247], a[148:151], v[148:151]
  v_cvt_pk_bf16_f32 v167, v158, v159
  v_mfma_f32_16x16x32_bf16 v[148:151], a[248:251], a[152:155], v[148:151]
  v_mfma_f32_16x16x32_bf16 v[148:151], a[252:255], a[156:159], v[148:151]
  v_xor_b32 v232, 0x10000, v232
  v_xor_b32 v233, 0x10000, v233
  v_mfma_f32_16x16x32_bf16 v[16:19], v[112:115], v[164:167], v[16:19]
  v_exp_f32 v144, v144
  v_mfma_f32_16x16x32_bf16 v[20:23], v[116:119], v[164:167], v[20:23]
  s_add_u32 m0, m0, 4096
  s_xor_b32 s27, s27, 0x10000
  buffer_load_dwordx4 v240, s[12:15], s29 offen offset:0 nt lds
  v_mfma_f32_16x16x32_bf16 v[24:27], v[120:123], v[164:167], v[24:27]
  v_exp_f32 v145, v145
  v_mfma_f32_16x16x32_bf16 v[28:31], v[124:127], v[164:167], v[28:31]
  v_cvt_pk_bf16_f32 v160, v144, v145
  v_mfma_f32_16x16x32_bf16 a[16:19], v[128:131], v[164:167], a[16:19]
  v_exp_f32 v146, v146
  v_mfma_f32_16x16x32_bf16 a[20:23], v[132:135], v[164:167], a[20:23]
  v_mfma_f32_16x16x32_bf16 a[24:27], v[136:139], v[164:167], a[24:27]
  v_exp_f32 v147, v147
  v_mfma_f32_16x16x32_bf16 a[28:31], v[140:143], v[164:167], a[28:31]
  v_cvt_pk_bf16_f32 v161, v146, v147
  v_mfma_f32_16x16x32_bf16 v[200:203], v[224:227], v[164:167], v[200:203]
  v_exp_f32 v148, v148
  v_mfma_f32_16x16x32_bf16 v[152:155], a[224:227], a[160:163], v[180:183]
  buffer_load_dwordx4 v241, s[12:15], s29 offen offset:1024 nt lds
  v_mfma_f32_16x16x32_bf16 v[152:155], a[228:231], a[164:167], v[152:155]
  v_exp_f32 v149, v149
  v_mfma_f32_16x16x32_bf16 v[152:155], a[232:235], a[168:171], v[152:155]
  v_cvt_pk_bf16_f32 v162, v148, v149
  v_mfma_f32_16x16x32_bf16 v[152:155], a[236:239], a[172:175], v[152:155]
  v_exp_f32 v150, v150
  v_mfma_f32_16x16x32_bf16 v[156:159], a[240:243], a[160:163], v[180:183]
  v_exp_f32 v151, v151
  v_mfma_f32_16x16x32_bf16 v[156:159], a[244:247], a[164:167], v[156:159]
  v_cvt_pk_bf16_f32 v163, v150, v151
  v_mfma_f32_16x16x32_bf16 v[156:159], a[248:251], a[168:171], v[156:159]
  buffer_load_dwordx4 v240, s[12:15], s29 offen offset:2048 nt lds
  v_mfma_f32_16x16x32_bf16 v[156:159], a[252:255], a[172:175], v[156:159]
  v_xor_b32 v234, 0x10000, v234
  v_xor_b32 v235, 0x10000, v235
  v_mfma_f32_16x16x32_bf16 v[32:35], v[112:115], v[160:163], v[32:35]
  v_exp_f32 v152, v152
  v_mfma_f32_16x16x32_bf16 v[36:39], v[116:119], v[160:163], v[36:39]
  v_mfma_f32_16x16x32_bf16 v[40:43], v[120:123], v[160:163], v[40:43]
  v_exp_f32 v153, v153
  v_mfma_f32_16x16x32_bf16 v[44:47], v[124:127], v[160:163], v[44:47]
  v_cvt_pk_bf16_f32 v164, v152, v153
  v_mfma_f32_16x16x32_bf16 a[32:35], v[128:131], v[160:163], a[32:35]
  v_exp_f32 v154, v154
  v_mfma_f32_16x16x32_bf16 a[36:39], v[132:135], v[160:163], a[36:39]
  buffer_load_dwordx4 v241, s[12:15], s29 offen offset:3072 nt lds
  v_mfma_f32_16x16x32_bf16 a[40:43], v[136:139], v[160:163], a[40:43]
  v_exp_f32 v155, v155
  v_mfma_f32_16x16x32_bf16 a[44:47], v[140:143], v[160:163], a[44:47]
  v_cvt_pk_bf16_f32 v165, v154, v155
  v_mfma_f32_16x16x32_bf16 v[204:207], v[224:227], v[160:163], v[204:207]
  v_exp_f32 v156, v156
  v_mfma_f32_16x16x32_bf16 v[144:147], a[224:227], a[176:179], v[184:187]
  v_mfma_f32_16x16x32_bf16 v[144:147], a[228:231], a[180:183], v[144:147]
  v_exp_f32 v157, v157
  v_mfma_f32_16x16x32_bf16 v[144:147], a[232:235], a[184:187], v[144:147]
  v_cvt_pk_bf16_f32 v166, v156, v157
  v_mfma_f32_16x16x32_bf16 v[144:147], a[236:239], a[188:191], v[144:147]
  v_exp_f32 v158, v158
  v_mfma_f32_16x16x32_bf16 v[148:151], a[240:243], a[176:179], v[184:187]
  v_exp_f32 v159, v159
  v_mfma_f32_16x16x32_bf16 v[148:151], a[244:247], a[180:183], v[148:151]
  v_cvt_pk_bf16_f32 v167, v158, v159
  v_mfma_f32_16x16x32_bf16 v[148:151], a[248:251], a[184:187], v[148:151]
  s_add_u32 m0, m0, 4096
  s_nop 0
  buffer_load_dwordx4 v240, s[32:35], s26 offen offset:0 nt lds
  v_mfma_f32_16x16x32_bf16 v[148:151], a[252:255], a[188:191], v[148:151]
  v_xor_b32 v236, 0x10000, v236
  v_xor_b32 v237, 0x10000, v237
  v_mfma_f32_16x16x32_bf16 v[48:51], v[112:115], v[164:167], v[48:51]
  v_exp_f32 v144, v144
  v_mfma_f32_16x16x32_bf16 v[52:55], v[116:119], v[164:167], v[52:55]
  v_mfma_f32_16x16x32_bf16 v[56:59], v[120:123], v[164:167], v[56:59]
  v_exp_f32 v145, v145
  v_mfma_f32_16x16x32_bf16 v[60:63], v[124:127], v[164:167], v[60:63]
  v_cvt_pk_bf16_f32 v160, v144, v145
  v_mfma_f32_16x16x32_bf16 a[48:51], v[128:131], v[164:167], a[48:51]
  v_exp_f32 v146, v146
  v_mfma_f32_16x16x32_bf16 a[52:55], v[132:135], v[164:167], a[52:55]
  buffer_load_dwordx4 v241, s[32:35], s26 offen offset:1024 nt lds
  v_mfma_f32_16x16x32_bf16 a[56:59], v[136:139], v[164:167], a[56:59]
  v_exp_f32 v147, v147
  v_mfma_f32_16x16x32_bf16 a[60:63], v[140:143], v[164:167], a[60:63]
  v_cvt_pk_bf16_f32 v161, v146, v147
  v_mfma_f32_16x16x32_bf16 v[208:211], v[224:227], v[164:167], v[208:211]
  v_exp_f32 v148, v148
  v_mfma_f32_16x16x32_bf16 v[152:155], a[224:227], a[192:195], v[188:191]
  buffer_load_dwordx4 v240, s[32:35], s26 offen offset:2048 nt lds
  v_mfma_f32_16x16x32_bf16 v[152:155], a[228:231], a[196:199], v[152:155]
  v_exp_f32 v149, v149
  v_mfma_f32_16x16x32_bf16 v[152:155], a[232:235], a[200:203], v[152:155]
  v_cvt_pk_bf16_f32 v162, v148, v149
  v_mfma_f32_16x16x32_bf16 v[152:155], a[236:239], a[204:207], v[152:155]
  v_exp_f32 v150, v150
  v_mfma_f32_16x16x32_bf16 v[156:159], a[240:243], a[192:195], v[188:191]
  v_exp_f32 v151, v151
  v_mfma_f32_16x16x32_bf16 v[156:159], a[244:247], a[196:199], v[156:159]
  v_cvt_pk_bf16_f32 v163, v150, v151
  v_mfma_f32_16x16x32_bf16 v[156:159], a[248:251], a[200:203], v[156:159]
  v_mfma_f32_16x16x32_bf16 v[156:159], a[252:255], a[204:207], v[156:159]
  v_xor_b32 v238, 0x10000, v238
  v_xor_b32 v239, 0x10000, v239
  v_mfma_f32_16x16x32_bf16 v[64:67], v[112:115], v[160:163], v[64:67]
  v_exp_f32 v152, v152
  v_mfma_f32_16x16x32_bf16 v[68:71], v[116:119], v[160:163], v[68:71]
  buffer_load_dwordx4 v241, s[32:35], s26 offen offset:3072 nt lds
  v_mfma_f32_16x16x32_bf16 v[72:75], v[120:123], v[160:163], v[72:75]
  v_exp_f32 v153, v153
  v_mfma_f32_16x16x32_bf16 v[76:79], v[124:127], v[160:163], v[76:79]
  v_cvt_pk_bf16_f32 v164, v152, v153
  v_mfma_f32_16x16x32_bf16 a[64:67], v[128:131], v[160:163], a[64:67]
  v_exp_f32 v154, v154
  v_mfma_f32_16x16x32_bf16 a[68:71], v[132:135], v[160:163], a[68:71]
  v_mfma_f32_16x16x32_bf16 a[72:75], v[136:139], v[160:163], a[72:75]
  v_exp_f32 v155, v155
  v_mfma_f32_16x16x32_bf16 a[76:79], v[140:143], v[160:163], a[76:79]
  v_cvt_pk_bf16_f32 v165, v154, v155
  v_mfma_f32_16x16x32_bf16 v[212:215], v[224:227], v[160:163], v[212:215]
  v_exp_f32 v156, v156
  v_mfma_f32_16x16x32_bf16 v[144:147], a[224:227], a[208:211], v[192:195]
  s_add_u32 m0, m0, 4096
  s_nop 0
  buffer_load_dwordx4 v240, s[32:35], s29 offen offset:0 nt lds
  v_mfma_f32_16x16x32_bf16 v[144:147], a[228:231], a[212:215], v[144:147]
  v_exp_f32 v157, v157
  s_waitcnt vmcnt(21)
  v_mfma_f32_16x16x32_bf16 v[144:147], a[232:235], a[216:219], v[144:147]
  v_cvt_pk_bf16_f32 v166, v156, v157
  ds_read_b128 a[224:227], v228 offset:0
  v_mfma_f32_16x16x32_bf16 v[144:147], a[236:239], a[220:223], v[144:147]
  v_exp_f32 v158, v158
  v_mfma_f32_16x16x32_bf16 v[148:151], a[240:243], a[208:211], v[192:195]
  v_exp_f32 v159, v159
  v_mfma_f32_16x16x32_bf16 v[148:151], a[244:247], a[212:215], v[148:151]
  v_cvt_pk_bf16_f32 v167, v158, v159
  ds_read_b128 a[228:231], v229 offset:0
  v_mfma_f32_16x16x32_bf16 v[148:151], a[248:251], a[216:219], v[148:151]
  ds_read_b128 a[232:235], v230 offset:0
  ds_read_b128 a[236:239], v231 offset:0
  v_mfma_f32_16x16x32_bf16 v[148:151], a[252:255], a[220:223], v[148:151]
  ds_read_b128 a[240:243], v228 offset:4096
  ds_read_b128 a[244:247], v229 offset:4096
  v_mfma_f32_16x16x32_bf16 v[80:83], v[112:115], v[164:167], v[80:83]
  v_exp_f32 v144, v144
  v_mfma_f32_16x16x32_bf16 v[84:87], v[116:119], v[164:167], v[84:87]
  ds_read_b128 a[248:251], v230 offset:4096
  ds_read_b128 a[252:255], v231 offset:4096
  v_mfma_f32_16x16x32_bf16 v[88:91], v[120:123], v[164:167], v[88:91]
  v_exp_f32 v145, v145
  v_mfma_f32_16x16x32_bf16 v[92:95], v[124:127], v[164:167], v[92:95]
  v_cvt_pk_bf16_f32 v160, v144, v145
  v_mfma_f32_16x16x32_bf16 a[80:83], v[128:131], v[164:167], a[80:83]
  v_exp_f32 v146, v146
  v_mfma_f32_16x16x32_bf16 a[84:87], v[132:135], v[164:167], a[84:87]
  buffer_load_dwordx4 v241, s[32:35], s29 offen offset:1024 nt lds
  v_mfma_f32_16x16x32_bf16 a[88:91], v[136:139], v[164:167], a[88:91]
  v_exp_f32 v147, v147
  v_mfma_f32_16x16x32_bf16 a[92:95], v[140:143], v[164:167], a[92:95]
  v_cvt_pk_bf16_f32 v161, v146, v147
  v_mfma_f32_16x16x32_bf16 v[216:219], v[224:227], v[164:167], v[216:219]
  v_exp_f32 v148, v148
  s_waitcnt lgkmcnt(0)
  v_mfma_f32_16x16x32_bf16 v[152:155], a[224:227], a[112:115], v[168:171]
  buffer_load_dwordx4 v240, s[32:35], s29 offen offset:2048 nt lds
  v_mfma_f32_16x16x32_bf16 v[152:155], a[228:231], a[116:119], v[152:155]
  v_exp_f32 v149, v149
  v_mfma_f32_16x16x32_bf16 v[152:155], a[232:235], a[120:123], v[152:155]
  v_cvt_pk_bf16_f32 v162, v148, v149
  v_mfma_f32_16x16x32_bf16 v[152:155], a[236:239], a[124:127], v[152:155]
  v_exp_f32 v150, v150
  v_mfma_f32_16x16x32_bf16 v[156:159], a[240:243], a[112:115], v[168:171]
  v_exp_f32 v151, v151
  v_mfma_f32_16x16x32_bf16 v[156:159], a[244:247], a[116:119], v[156:159]
  v_cvt_pk_bf16_f32 v163, v150, v151
  v_mfma_f32_16x16x32_bf16 v[156:159], a[248:251], a[120:123], v[156:159]
  buffer_load_dwordx4 v241, s[32:35], s29 offen offset:3072 nt lds
  s_add_u32 s26, s26, 8192
  v_xor_b32 v228, 0x10000, v228
  v_xor_b32 v229, 0x10000, v229
  v_mfma_f32_16x16x32_bf16 v[156:159], a[252:255], a[124:127], v[156:159]
  v_xor_b32 v230, 0x10000, v230
  v_xor_b32 v231, 0x10000, v231
  s_waitcnt vmcnt(16)
  v_mfma_f32_16x16x32_bf16 v[96:99], v[112:115], v[160:163], v[96:99]
  v_exp_f32 v152, v152
  ds_read_b64_tr_b16 v[112:113], v232 offset:0
  v_mfma_f32_16x16x32_bf16 v[100:103], v[116:119], v[160:163], v[100:103]
  ds_read_b64_tr_b16 v[114:115], v232 offset:4096
  v_mfma_f32_16x16x32_bf16 v[104:107], v[120:123], v[160:163], v[104:107]
  v_exp_f32 v153, v153
  ds_read_b64_tr_b16 v[116:117], v233 offset:0
  v_mfma_f32_16x16x32_bf16 v[108:111], v[124:127], v[160:163], v[108:111]
  v_cvt_pk_bf16_f32 v164, v152, v153
  ds_read_b64_tr_b16 v[118:119], v233 offset:4096
  v_mfma_f32_16x16x32_bf16 a[96:99], v[128:131], v[160:163], a[96:99]
  v_exp_f32 v154, v154
  ds_read_b64_tr_b16 v[120:121], v234 offset:0
  v_mfma_f32_16x16x32_bf16 a[100:103], v[132:135], v[160:163], a[100:103]
  ds_read_b64_tr_b16 v[122:123], v234 offset:4096
  s_add_u32 m0, s27, s28
  s_add_u32 s29, s26, 4096
  buffer_load_dwordx4 v240, s[12:15], s26 offen offset:0 nt lds
  v_mfma_f32_16x16x32_bf16 a[104:107], v[136:139], v[160:163], a[104:107]
  v_exp_f32 v155, v155
  ds_read_b64_tr_b16 v[124:125], v235 offset:0
  v_mfma_f32_16x16x32_bf16 a[108:111], v[140:143], v[160:163], a[108:111]
  v_cvt_pk_bf16_f32 v165, v154, v155
  ds_read_b64_tr_b16 v[126:127], v235 offset:4096
  v_mfma_f32_16x16x32_bf16 v[220:223], v[224:227], v[160:163], v[220:223]
  v_exp_f32 v156, v156
  ds_read_b64_tr_b16 v[128:129], v236 offset:0
  v_mfma_f32_16x16x32_bf16 v[144:147], a[224:227], a[128:131], v[172:175]
  ds_read_b64_tr_b16 v[130:131], v236 offset:4096
  buffer_load_dwordx4 v241, s[12:15], s26 offen offset:1024 nt lds
  v_mfma_f32_16x16x32_bf16 v[144:147], a[228:231], a[132:135], v[144:147]
  v_exp_f32 v157, v157
  ds_read_b64_tr_b16 v[132:133], v237 offset:0
  v_mfma_f32_16x16x32_bf16 v[144:147], a[232:235], a[136:139], v[144:147]
  v_cvt_pk_bf16_f32 v166, v156, v157
  ds_read_b64_tr_b16 v[134:135], v237 offset:4096
  v_mfma_f32_16x16x32_bf16 v[144:147], a[236:239], a[140:143], v[144:147]
  v_exp_f32 v158, v158
  ds_read_b64_tr_b16 v[136:137], v238 offset:0
  v_mfma_f32_16x16x32_bf16 v[148:151], a[240:243], a[128:131], v[172:175]
  v_exp_f32 v159, v159
  ds_read_b64_tr_b16 v[138:139], v238 offset:4096
  v_mfma_f32_16x16x32_bf16 v[148:151], a[244:247], a[132:135], v[148:151]
  v_cvt_pk_bf16_f32 v167, v158, v159
  ds_read_b64_tr_b16 v[140:141], v239 offset:0
  v_mfma_f32_16x16x32_bf16 v[148:151], a[248:251], a[136:139], v[148:151]
  ds_read_b64_tr_b16 v[142:143], v239 offset:4096
  v_mfma_f32_16x16x32_bf16 v[148:151], a[252:255], a[140:143], v[148:151]
  s_waitcnt lgkmcnt(8)
  v_mfma_f32_16x16x32_bf16 v[0:3], v[112:115], v[164:167], v[0:3]
  v_exp_f32 v144, v144
  v_mfma_f32_16x16x32_bf16 v[4:7], v[116:119], v[164:167], v[4:7]
  buffer_load_dwordx4 v240, s[12:15], s26 offen offset:2048 nt lds
  v_mfma_f32_16x16x32_bf16 v[8:11], v[120:123], v[164:167], v[8:11]
  v_exp_f32 v145, v145
  v_mfma_f32_16x16x32_bf16 v[12:15], v[124:127], v[164:167], v[12:15]
  v_cvt_pk_bf16_f32 v160, v144, v145
  s_waitcnt lgkmcnt(0)
  v_mfma_f32_16x16x32_bf16 a[0:3], v[128:131], v[164:167], a[0:3]
  v_exp_f32 v146, v146
  v_mfma_f32_16x16x32_bf16 a[4:7], v[132:135], v[164:167], a[4:7]
  v_mfma_f32_16x16x32_bf16 a[8:11], v[136:139], v[164:167], a[8:11]
  v_exp_f32 v147, v147
  v_mfma_f32_16x16x32_bf16 a[12:15], v[140:143], v[164:167], a[12:15]
  v_cvt_pk_bf16_f32 v161, v146, v147
  v_mfma_f32_16x16x32_bf16 v[196:199], v[224:227], v[164:167], v[196:199]
  v_exp_f32 v148, v148
  v_mfma_f32_16x16x32_bf16 v[152:155], a[224:227], a[144:147], v[176:179]
  buffer_load_dwordx4 v241, s[12:15], s26 offen offset:3072 nt lds
  v_mfma_f32_16x16x32_bf16 v[152:155], a[228:231], a[148:151], v[152:155]
  v_exp_f32 v149, v149
  v_mfma_f32_16x16x32_bf16 v[152:155], a[232:235], a[152:155], v[152:155]
  v_cvt_pk_bf16_f32 v162, v148, v149
  v_mfma_f32_16x16x32_bf16 v[152:155], a[236:239], a[156:159], v[152:155]
  v_exp_f32 v150, v150
  v_mfma_f32_16x16x32_bf16 v[156:159], a[240:243], a[144:147], v[176:179]
  v_exp_f32 v151, v151
  v_mfma_f32_16x16x32_bf16 v[156:159], a[244:247], a[148:151], v[156:159]
  v_cvt_pk_bf16_f32 v163, v150, v151
  v_mfma_f32_16x16x32_bf16 v[156:159], a[248:251], a[152:155], v[156:159]
  v_mfma_f32_16x16x32_bf16 v[156:159], a[252:255], a[156:159], v[156:159]
  v_xor_b32 v232, 0x10000, v232
  v_xor_b32 v233, 0x10000, v233
  v_mfma_f32_16x16x32_bf16 v[16:19], v[112:115], v[160:163], v[16:19]
  v_exp_f32 v152, v152
  v_mfma_f32_16x16x32_bf16 v[20:23], v[116:119], v[160:163], v[20:23]
  s_add_u32 m0, m0, 4096
  s_xor_b32 s27, s27, 0x10000
  buffer_load_dwordx4 v240, s[12:15], s29 offen offset:0 nt lds
  v_mfma_f32_16x16x32_bf16 v[24:27], v[120:123], v[160:163], v[24:27]
  v_exp_f32 v153, v153
  v_mfma_f32_16x16x32_bf16 v[28:31], v[124:127], v[160:163], v[28:31]
  v_cvt_pk_bf16_f32 v164, v152, v153
  v_mfma_f32_16x16x32_bf16 a[16:19], v[128:131], v[160:163], a[16:19]
  v_exp_f32 v154, v154
  v_mfma_f32_16x16x32_bf16 a[20:23], v[132:135], v[160:163], a[20:23]
  v_mfma_f32_16x16x32_bf16 a[24:27], v[136:139], v[160:163], a[24:27]
  v_exp_f32 v155, v155
  v_mfma_f32_16x16x32_bf16 a[28:31], v[140:143], v[160:163], a[28:31]
  v_cvt_pk_bf16_f32 v165, v154, v155
  v_mfma_f32_16x16x32_bf16 v[200:203], v[224:227], v[160:163], v[200:203]
  v_exp_f32 v156, v156
  v_mfma_f32_16x16x32_bf16 v[144:147], a[224:227], a[160:163], v[180:183]
  buffer_load_dwordx4 v241, s[12:15], s29 offen offset:1024 nt lds
  v_mfma_f32_16x16x32_bf16 v[144:147], a[228:231], a[164:167], v[144:147]
  v_exp_f32 v157, v157
  v_mfma_f32_16x16x32_bf16 v[144:147], a[232:235], a[168:171], v[144:147]
  v_cvt_pk_bf16_f32 v166, v156, v157
  v_mfma_f32_16x16x32_bf16 v[144:147], a[236:239], a[172:175], v[144:147]
  v_exp_f32 v158, v158
  v_mfma_f32_16x16x32_bf16 v[148:151], a[240:243], a[160:163], v[180:183]
  v_exp_f32 v159, v159
  v_mfma_f32_16x16x32_bf16 v[148:151], a[244:247], a[164:167], v[148:151]
  v_cvt_pk_bf16_f32 v167, v158, v159
  v_mfma_f32_16x16x32_bf16 v[148:151], a[248:251], a[168:171], v[148:151]
  buffer_load_dwordx4 v240, s[12:15], s29 offen offset:2048 nt lds
  v_mfma_f32_16x16x32_bf16 v[148:151], a[252:255], a[172:175], v[148:151]
  v_xor_b32 v234, 0x10000, v234
  v_xor_b32 v235, 0x10000, v235
  v_mfma_f32_16x16x32_bf16 v[32:35], v[112:115], v[164:167], v[32:35]
  v_exp_f32 v144, v144
  v_mfma_f32_16x16x32_bf16 v[36:39], v[116:119], v[164:167], v[36:39]
  v_mfma_f32_16x16x32_bf16 v[40:43], v[120:123], v[164:167], v[40:43]
  v_exp_f32 v145, v145
  v_mfma_f32_16x16x32_bf16 v[44:47], v[124:127], v[164:167], v[44:47]
  v_cvt_pk_bf16_f32 v160, v144, v145
  v_mfma_f32_16x16x32_bf16 a[32:35], v[128:131], v[164:167], a[32:35]
  v_exp_f32 v146, v146
  v_mfma_f32_16x16x32_bf16 a[36:39], v[132:135], v[164:167], a[36:39]
  buffer_load_dwordx4 v241, s[12:15], s29 offen offset:3072 nt lds
  v_mfma_f32_16x16x32_bf16 a[40:43], v[136:139], v[164:167], a[40:43]
  v_exp_f32 v147, v147
  v_mfma_f32_16x16x32_bf16 a[44:47], v[140:143], v[164:167], a[44:47]
  v_cvt_pk_bf16_f32 v161, v146, v147
  v_mfma_f32_16x16x32_bf16 v[204:207], v[224:227], v[164:167], v[204:207]
  v_exp_f32 v148, v148
  v_mfma_f32_16x16x32_bf16 v[152:155], a[224:227], a[176:179], v[184:187]
  v_mfma_f32_16x16x32_bf16 v[152:155], a[228:231], a[180:183], v[152:155]
  v_exp_f32 v149, v149
  v_mfma_f32_16x16x32_bf16 v[152:155], a[232:235], a[184:187], v[152:155]
  v_cvt_pk_bf16_f32 v162, v148, v149
  v_mfma_f32_16x16x32_bf16 v[152:155], a[236:239], a[188:191], v[152:155]
  v_exp_f32 v150, v150
  v_mfma_f32_16x16x32_bf16 v[156:159], a[240:243], a[176:179], v[184:187]
  v_exp_f32 v151, v151
  v_mfma_f32_16x16x32_bf16 v[156:159], a[244:247], a[180:183], v[156:159]
  v_cvt_pk_bf16_f32 v163, v150, v151
  v_mfma_f32_16x16x32_bf16 v[156:159], a[248:251], a[184:187], v[156:159]
  s_add_u32 m0, m0, 4096
  s_nop 0
  buffer_load_dwordx4 v240, s[32:35], s26 offen offset:0 nt lds
  v_mfma_f32_16x16x32_bf16 v[156:159], a[252:255], a[188:191], v[156:159]
  v_xor_b32 v236, 0x10000, v236
  v_xor_b32 v237, 0x10000, v237
  v_mfma_f32_16x16x32_bf16 v[48:51], v[112:115], v[160:163], v[48:51]
  v_exp_f32 v152, v152
  v_mfma_f32_16x16x32_bf16 v[52:55], v[116:119], v[160:163], v[52:55]
  v_mfma_f32_16x16x32_bf16 v[56:59], v[120:123], v[160:163], v[56:59]
  v_exp_f32 v153, v153
  v_mfma_f32_16x16x32_bf16 v[60:63], v[124:127], v[160:163], v[60:63]
  v_cvt_pk_bf16_f32 v164, v152, v153
  v_mfma_f32_16x16x32_bf16 a[48:51], v[128:131], v[160:163], a[48:51]
  v_exp_f32 v154, v154
  v_mfma_f32_16x16x32_bf16 a[52:55], v[132:135], v[160:163], a[52:55]
  buffer_load_dwordx4 v241, s[32:35], s26 offen offset:1024 nt lds
  v_mfma_f32_16x16x32_bf16 a[56:59], v[136:139], v[160:163], a[56:59]
  v_exp_f32 v155, v155
  v_mfma_f32_16x16x32_bf16 a[60:63], v[140:143], v[160:163], a[60:63]
  v_cvt_pk_bf16_f32 v165, v154, v155
  v_mfma_f32_16x16x32_bf16 v[208:211], v[224:227], v[160:163], v[208:211]
  v_exp_f32 v156, v156
  v_mfma_f32_16x16x32_bf16 v[144:147], a[224:227], a[192:195], v[188:191]
  buffer_load_dwordx4 v240, s[32:35], s26 offen offset:2048 nt lds
  v_mfma_f32_16x16x32_bf16 v[144:147], a[228:231], a[196:199], v[144:147]
  v_exp_f32 v157, v157
  v_mfma_f32_16x16x32_bf16 v[144:147], a[232:235], a[200:203], v[144:147]
  v_cvt_pk_bf16_f32 v166, v156, v157
  v_mfma_f32_16x16x32_bf16 v[144:147], a[236:239], a[204:207], v[144:147]
  v_exp_f32 v158, v158
  v_mfma_f32_16x16x32_bf16 v[148:151], a[240:243], a[192:195], v[188:191]
  v_exp_f32 v159, v159
  v_mfma_f32_16x16x32_bf16 v[148:151], a[244:247], a[196:199], v[148:151]
  v_cvt_pk_bf16_f32 v167, v158, v159
  v_mfma_f32_16x16x32_bf16 v[148:151], a[248:251], a[200:203], v[148:151]
  v_mfma_f32_16x16x32_bf16 v[148:151], a[252:255], a[204:207], v[148:151]
  v_xor_b32 v238, 0x10000, v238
  v_xor_b32 v239, 0x10000, v239
  v_mfma_f32_16x16x32_bf16 v[64:67], v[112:115], v[164:167], v[64:67]
  v_exp_f32 v144, v144
  v_mfma_f32_16x16x32_bf16 v[68:71], v[116:119], v[164:167], v[68:71]
  buffer_load_dwordx4 v241, s[32:35], s26 offen offset:3072 nt lds
  v_mfma_f32_16x16x32_bf16 v[72:75], v[120:123], v[164:167], v[72:75]
  v_exp_f32 v145, v145
  v_mfma_f32_16x16x32_bf16 v[76:79], v[124:127], v[164:167], v[76:79]
  v_cvt_pk_bf16_f32 v160, v144, v145
  v_mfma_f32_16x16x32_bf16 a[64:67], v[128:131], v[164:167], a[64:67]
  v_exp_f32 v146, v146
  v_mfma_f32_16x16x32_bf16 a[68:71], v[132:135], v[164:167], a[68:71]
  v_mfma_f32_16x16x32_bf16 a[72:75], v[136:139], v[164:167], a[72:75]
  v_exp_f32 v147, v147
  v_mfma_f32_16x16x32_bf16 a[76:79], v[140:143], v[164:167], a[76:79]
  v_cvt_pk_bf16_f32 v161, v146, v147
  v_mfma_f32_16x16x32_bf16 v[212:215], v[224:227], v[164:167], v[212:215]
  v_exp_f32 v148, v148
  v_mfma_f32_16x16x32_bf16 v[152:155], a[224:227], a[208:211], v[192:195]
  s_add_u32 m0, m0, 4096
  s_nop 0
  buffer_load_dwordx4 v240, s[32:35], s29 offen offset:0 nt lds
  v_mfma_f32_16x16x32_bf16 v[152:155], a[228:231], a[212:215], v[152:155]
  v_exp_f32 v149, v149
  s_waitcnt vmcnt(21)
  v_mfma_f32_16x16x32_bf16 v[152:155], a[232:235], a[216:219], v[152:155]
  v_cvt_pk_bf16_f32 v162, v148, v149
  ds_read_b128 a[224:227], v228 offset:0
  v_mfma_f32_16x16x32_bf16 v[152:155], a[236:239], a[220:223], v[152:155]
  v_exp_f32 v150, v150
  v_mfma_f32_16x16x32_bf16 v[156:159], a[240:243], a[208:211], v[192:195]
  v_exp_f32 v151, v151
  v_mfma_f32_16x16x32_bf16 v[156:159], a[244:247], a[212:215], v[156:159]
  v_cvt_pk_bf16_f32 v163, v150, v151
  ds_read_b128 a[228:231], v229 offset:0
  v_mfma_f32_16x16x32_bf16 v[156:159], a[248:251], a[216:219], v[156:159]
  ds_read_b128 a[232:235], v230 offset:0
  ds_read_b128 a[236:239], v231 offset:0
  v_mfma_f32_16x16x32_bf16 v[156:159], a[252:255], a[220:223], v[156:159]
  ds_read_b128 a[240:243], v228 offset:4096
  ds_read_b128 a[244:247], v229 offset:4096
  v_mfma_f32_16x16x32_bf16 v[80:83], v[112:115], v[160:163], v[80:83]
  v_exp_f32 v152, v152
  v_mfma_f32_16x16x32_bf16 v[84:87], v[116:119], v[160:163], v[84:87]
  ds_read_b128 a[248:251], v230 offset:4096
  ds_read_b128 a[252:255], v231 offset:4096
  v_mfma_f32_16x16x32_bf16 v[88:91], v[120:123], v[160:163], v[88:91]
  v_exp_f32 v153, v153
  v_mfma_f32_16x16x32_bf16 v[92:95], v[124:127], v[160:163], v[92:95]
  v_cvt_pk_bf16_f32 v164, v152, v153
  v_mfma_f32_16x16x32_bf16 a[80:83], v[128:131], v[160:163], a[80:83]
  v_exp_f32 v154, v154
  v_mfma_f32_16x16x32_bf16 a[84:87], v[132:135], v[160:163], a[84:87]
  buffer_load_dwordx4 v241, s[32:35], s29 offen offset:1024 nt lds
  v_mfma_f32_16x16x32_bf16 a[88:91], v[136:139], v[160:163], a[88:91]
  v_exp_f32 v155, v155
  v_mfma_f32_16x16x32_bf16 a[92:95], v[140:143], v[160:163], a[92:95]
  v_cvt_pk_bf16_f32 v165, v154, v155
  v_mfma_f32_16x16x32_bf16 v[216:219], v[224:227], v[160:163], v[216:219]
  v_exp_f32 v156, v156
  s_waitcnt lgkmcnt(0)
  v_mfma_f32_16x16x32_bf16 v[144:147], a[224:227], a[112:115], v[168:171]
  buffer_load_dwordx4 v240, s[32:35], s29 offen offset:2048 nt lds
  v_mfma_f32_16x16x32_bf16 v[144:147], a[228:231], a[116:119], v[144:147]
  v_exp_f32 v157, v157
  v_mfma_f32_16x16x32_bf16 v[144:147], a[232:235], a[120:123], v[144:147]
  v_cvt_pk_bf16_f32 v166, v156, v157
  v_mfma_f32_16x16x32_bf16 v[144:147], a[236:239], a[124:127], v[144:147]
  v_exp_f32 v158, v158
  v_mfma_f32_16x16x32_bf16 v[148:151], a[240:243], a[112:115], v[168:171]
  v_exp_f32 v159, v159
  v_mfma_f32_16x16x32_bf16 v[148:151], a[244:247], a[116:119], v[148:151]
  v_cvt_pk_bf16_f32 v167, v158, v159
  v_mfma_f32_16x16x32_bf16 v[148:151], a[248:251], a[120:123], v[148:151]
  buffer_load_dwordx4 v241, s[32:35], s29 offen offset:3072 nt lds
  s_add_u32 s26, s26, 8192
  v_xor_b32 v228, 0x10000, v228
  v_xor_b32 v229, 0x10000, v229
  v_mfma_f32_16x16x32_bf16 v[148:151], a[252:255], a[124:127], v[148:151]
  v_xor_b32 v230, 0x10000, v230
  v_xor_b32 v231, 0x10000, v231
  s_sub_u32 s30, s30, 1
  s_cmp_lg_u32 s30, 0
  s_cbranch_scc1 L1_B_loop
LP_B_s14:
  s_waitcnt vmcnt(16)
  v_mfma_f32_16x16x32_bf16 v[96:99], v[112:115], v[164:167], v[96:99]
  v_exp_f32 v144, v144
  ds_read_b64_tr_b16 v[112:113], v232 offset:0
  v_mfma_f32_16x16x32_bf16 v[100:103], v[116:119], v[164:167], v[100:103]
  ds_read_b64_tr_b16 v[114:115], v232 offset:4096
  v_mfma_f32_16x16x32_bf16 v[104:107], v[120:123], v[164:167], v[104:107]
  v_exp_f32 v145, v145
  ds_read_b64_tr_b16 v[116:117], v233 offset:0
  v_mfma_f32_16x16x32_bf16 v[108:111], v[124:127], v[164:167], v[108:111]
  v_cvt_pk_bf16_f32 v160, v144, v145
  ds_read_b64_tr_b16 v[118:119], v233 offset:4096
  v_mfma_f32_16x16x32_bf16 a[96:99], v[128:131], v[164:167], a[96:99]
  v_exp_f32 v146, v146
  ds_read_b64_tr_b16 v[120:121], v234 offset:0
  v_mfma_f32_16x16x32_bf16 a[100:103], v[132:135], v[164:167], a[100:103]
  ds_read_b64_tr_b16 v[122:123], v234 offset:4096
  v_mfma_f32_16x16x32_bf16 a[104:107], v[136:139], v[164:167], a[104:107]
  v_exp_f32 v147, v147
  ds_read_b64_tr_b16 v[124:125], v235 offset:0
  v_mfma_f32_16x16x32_bf16 a[108:111], v[140:143], v[164:167], a[108:111]
  v_cvt_pk_bf16_f32 v161, v146, v147
  ds_read_b64_tr_b16 v[126:127], v235 offset:4096
  v_mfma_f32_16x16x32_bf16 v[220:223], v[224:227], v[164:167], v[220:223]
  v_exp_f32 v148, v148
  ds_read_b64_tr_b16 v[128:129], v236 offset:0
  v_mfma_f32_16x16x32_bf16 v[152:155], a[224:227], a[128:131], v[172:175]
  ds_read_b64_tr_b16 v[130:131], v236 offset:4096
  v_mfma_f32_16x16x32_bf16 v[152:155], a[228:231], a[132:135], v[152:155]
  v_exp_f32 v149, v149
  ds_read_b64_tr_b16 v[132:133], v237 offset:0
  v_mfma_f32_16x16x32_bf16 v[152:155], a[232:235], a[136:139], v[152:155]
  v_cvt_pk_bf16_f32 v162, v148, v149
  ds_read_b64_tr_b16 v[134:135], v237 offset:4096
  v_mfma_f32_16x16x32_bf16 v[152:155], a[236:239], a[140:143], v[152:155]
  v_exp_f32 v150, v150
  ds_read_b64_tr_b16 v[136:137], v238 offset:0
  v_mfma_f32_16x16x32_bf16 v[156:159], a[240:243], a[128:131], v[172:175]
  v_exp_f32 v151, v151
  ds_read_b64_tr_b16 v[138:139], v238 offset:4096
  v_mfma_f32_16x16x32_bf16 v[156:159], a[244:247], a[132:135], v[156:159]
  v_cvt_pk_bf16_f32 v163, v150, v151
  ds_read_b64_tr_b16 v[140:141], v239 offset:0
  v_mfma_f32_16x16x32_bf16 v[156:159], a[248:251], a[136:139], v[156:159]
  ds_read_b64_tr_b16 v[142:143], v239 offset:4096
  v_mfma_f32_16x16x32_bf16 v[156:159], a[252:255], a[140:143], v[156:159]
  buffer_load_dword v248, off, s[80:83], 0 sc1
  v_lshlrev_b32 v249, 7, v242
  s_waitcnt lgkmcnt(8)
  v_mfma_f32_16x16x32_bf16 v[0:3], v[112:115], v[160:163], v[0:3]
  v_exp_f32 v152, v152
  v_mfma_f32_16x16x32_bf16 v[4:7], v[116:119], v[160:163], v[4:7]
  v_add_u32 v244, s59, v243
  v_mfma_f32_16x16x32_bf16 v[8:11], v[120:123], v[160:163], v[8:11]
  v_exp_f32 v153, v153
  v_mfma_f32_16x16x32_bf16 v[12:15], v[124:127], v[160:163], v[12:15]
  v_cvt_pk_bf16_f32 v164, v152, v153
  s_waitcnt lgkmcnt(0)
  v_mfma_f32_16x16x32_bf16 a[0:3], v[128:131], v[160:163], a[0:3]
  v_exp_f32 v154, v154
  v_mfma_f32_16x16x32_bf16 a[4:7], v[132:135], v[160:163], a[4:7]
  v_mfma_f32_16x16x32_bf16 a[8:11], v[136:139], v[160:163], a[8:11]
  v_exp_f32 v155, v155
  v_mfma_f32_16x16x32_bf16 a[12:15], v[140:143], v[160:163], a[12:15]
  v_cvt_pk_bf16_f32 v165, v154, v155
  v_mfma_f32_16x16x32_bf16 v[196:199], v[224:227], v[160:163], v[196:199]
  v_exp_f32 v156, v156
  v_mfma_f32_16x16x32_bf16 v[144:147], a[224:227], a[144:147], v[176:179]
  v_mfma_f32_16x16x32_bf16 v[144:147], a[228:231], a[148:151], v[144:147]
  v_exp_f32 v157, v157
  v_mfma_f32_16x16x32_bf16 v[144:147], a[232:235], a[152:155], v[144:147]
  v_cvt_pk_bf16_f32 v166, v156, v157
  v_mfma_f32_16x16x32_bf16 v[144:147], a[236:239], a[156:159], v[144:147]
  v_exp_f32 v158, v158
  v_mfma_f32_16x16x32_bf16 v[148:151], a[240:243], a[144:147], v[176:179]
  v_exp_f32 v159, v159
  v_mfma_f32_16x16x32_bf16 v[148:151], a[244:247], a[148:151], v[148:151]
  v_cvt_pk_bf16_f32 v167, v158, v159
  v_mfma_f32_16x16x32_bf16 v[148:151], a[248:251], a[152:155], v[148:151]
  v_mfma_f32_16x16x32_bf16 v[148:151], a[252:255], a[156:159], v[148:151]
  v_xor_b32 v232, 0x10000, v232
  v_xor_b32 v233, 0x10000, v233
  v_mfma_f32_16x16x32_bf16 v[16:19], v[112:115], v[164:167], v[16:19]
  v_exp_f32 v144, v144
  v_mfma_f32_16x16x32_bf16 v[20:23], v[116:119], v[164:167], v[20:23]
  v_add_u32 v245, 0x10000, v244
  v_mfma_f32_16x16x32_bf16 v[24:27], v[120:123], v[164:167], v[24:27]
  v_exp_f32 v145, v145
  v_mfma_f32_16x16x32_bf16 v[28:31], v[124:127], v[164:167], v[28:31]
  v_cvt_pk_bf16_f32 v160, v144, v145
  v_mfma_f32_16x16x32_bf16 a[16:19], v[128:131], v[164:167], a[16:19]
  v_exp_f32 v146, v146
  v_mfma_f32_16x16x32_bf16 a[20:23], v[132:135], v[164:167], a[20:23]
  v_mfma_f32_16x16x32_bf16 a[24:27], v[136:139], v[164:167], a[24:27]
  v_exp_f32 v147, v147
  v_mfma_f32_16x16x32_bf16 a[28:31], v[140:143], v[164:167], a[28:31]
  v_cvt_pk_bf16_f32 v161, v146, v147
  v_mfma_f32_16x16x32_bf16 v[200:203], v[224:227], v[164:167], v[200:203]
  v_exp_f32 v148, v148
  v_mfma_f32_16x16x32_bf16 v[152:155], a[224:227], a[160:163], v[180:183]
  v_mfma_f32_16x16x32_bf16 v[152:155], a[228:231], a[164:167], v[152:155]
  v_exp_f32 v149, v149
  v_mfma_f32_16x16x32_bf16 v[152:155], a[232:235], a[168:171], v[152:155]
  v_cvt_pk_bf16_f32 v162, v148, v149
  v_mfma_f32_16x16x32_bf16 v[152:155], a[236:239], a[172:175], v[152:155]
  v_exp_f32 v150, v150
  v_mfma_f32_16x16x32_bf16 v[156:159], a[240:243], a[160:163], v[180:183]
  v_exp_f32 v151, v151
  v_mfma_f32_16x16x32_bf16 v[156:159], a[244:247], a[164:167], v[156:159]
  v_cvt_pk_bf16_f32 v163, v150, v151
  v_mfma_f32_16x16x32_bf16 v[156:159], a[248:251], a[168:171], v[156:159]
  v_mfma_f32_16x16x32_bf16 v[156:159], a[252:255], a[172:175], v[156:159]
  v_xor_b32 v234, 0x10000, v234
  v_xor_b32 v235, 0x10000, v235
  v_mfma_f32_16x16x32_bf16 v[32:35], v[112:115], v[160:163], v[32:35]
  v_exp_f32 v152, v152
  v_mfma_f32_16x16x32_bf16 v[36:39], v[116:119], v[160:163], v[36:39]
  v_xor_b32 v246, 0x4000, v244
  v_mfma_f32_16x16x32_bf16 v[40:43], v[120:123], v[160:163], v[40:43]
  v_exp_f32 v153, v153
  v_mfma_f32_16x16x32_bf16 v[44:47], v[124:127], v[160:163], v[44:47]
  v_cvt_pk_bf16_f32 v164, v152, v153
  v_mfma_f32_16x16x32_bf16 a[32:35], v[128:131], v[160:163], a[32:35]
  v_exp_f32 v154, v154
  v_mfma_f32_16x16x32_bf16 a[36:39], v[132:135], v[160:163], a[36:39]
  v_mfma_f32_16x16x32_bf16 a[40:43], v[136:139], v[160:163], a[40:43]
  v_exp_f32 v155, v155
  v_mfma_f32_16x16x32_bf16 a[44:47], v[140:143], v[160:163], a[44:47]
  v_cvt_pk_bf16_f32 v165, v154, v155
  v_mfma_f32_16x16x32_bf16 v[204:207], v[224:227], v[160:163], v[204:207]
  v_exp_f32 v156, v156
  v_mfma_f32_16x16x32_bf16 v[144:147], a[224:227], a[176:179], v[184:187]
  v_mfma_f32_16x16x32_bf16 v[144:147], a[228:231], a[180:183], v[144:147]
  v_exp_f32 v157, v157
  v_mfma_f32_16x16x32_bf16 v[144:147], a[232:235], a[184:187], v[144:147]
  v_cvt_pk_bf16_f32 v166, v156, v157
  v_mfma_f32_16x16x32_bf16 v[144:147], a[236:239], a[188:191], v[144:147]
  v_exp_f32 v158, v158
  v_mfma_f32_16x16x32_bf16 v[148:151], a[240:243], a[176:179], v[184:187]
  v_exp_f32 v159, v159
  v_mfma_f32_16x16x32_bf16 v[148:151], a[244:247], a[180:183], v[148:151]
  v_cvt_pk_bf16_f32 v167, v158, v159
  v_mfma_f32_16x16x32_bf16 v[148:151], a[248:251], a[184:187], v[148:151]
  v_mfma_f32_16x16x32_bf16 v[148:151], a[252:255], a[188:191], v[148:151]
  v_xor_b32 v236, 0x10000, v236
  v_xor_b32 v237, 0x10000, v237
  v_mfma_f32_16x16x32_bf16 v[48:51], v[112:115], v[164:167], v[48:51]
  v_exp_f32 v144, v144
  v_mfma_f32_16x16x32_bf16 v[52:55], v[116:119], v[164:167], v[52:55]
  v_xor_b32 v247, 0x4000, v245
  v_mfma_f32_16x16x32_bf16 v[56:59], v[120:123], v[164:167], v[56:59]
  v_exp_f32 v145, v145
  v_mfma_f32_16x16x32_bf16 v[60:63], v[124:127], v[164:167], v[60:63]
  v_cvt_pk_bf16_f32 v160, v144, v145
  v_mfma_f32_16x16x32_bf16 a[48:51], v[128:131], v[164:167], a[48:51]
  v_exp_f32 v146, v146
  v_mfma_f32_16x16x32_bf16 a[52:55], v[132:135], v[164:167], a[52:55]
  v_mfma_f32_16x16x32_bf16 a[56:59], v[136:139], v[164:167], a[56:59]
  v_exp_f32 v147, v147
  v_mfma_f32_16x16x32_bf16 a[60:63], v[140:143], v[164:167], a[60:63]
  v_cvt_pk_bf16_f32 v161, v146, v147
  v_mfma_f32_16x16x32_bf16 v[208:211], v[224:227], v[164:167], v[208:211]
  v_exp_f32 v148, v148
  v_mfma_f32_16x16x32_bf16 v[152:155], a[224:227], a[192:195], v[188:191]
  v_mfma_f32_16x16x32_bf16 v[152:155], a[228:231], a[196:199], v[152:155]
  v_exp_f32 v149, v149
  v_mfma_f32_16x16x32_bf16 v[152:155], a[232:235], a[200:203], v[152:155]
  v_cvt_pk_bf16_f32 v162, v148, v149
  v_mfma_f32_16x16x32_bf16 v[152:155], a[236:239], a[204:207], v[152:155]
  v_exp_f32 v150, v150
  v_mfma_f32_16x16x32_bf16 v[156:159], a[240:243], a[192:195], v[188:191]
  v_exp_f32 v151, v151
  v_mfma_f32_16x16x32_bf16 v[156:159], a[244:247], a[196:199], v[156:159]
  v_cvt_pk_bf16_f32 v163, v150, v151
  v_mfma_f32_16x16x32_bf16 v[156:159], a[248:251], a[200:203], v[156:159]
  v_mfma_f32_16x16x32_bf16 v[156:159], a[252:255], a[204:207], v[156:159]
  v_xor_b32 v238, 0x10000, v238
  v_xor_b32 v239, 0x10000, v239
  v_mfma_f32_16x16x32_bf16 v[64:67], v[112:115], v[160:163], v[64:67]
  v_exp_f32 v152, v152
  v_mfma_f32_16x16x32_bf16 v[68:71], v[116:119], v[160:163], v[68:71]
  v_mfma_f32_16x16x32_bf16 v[72:75], v[120:123], v[160:163], v[72:75]
  v_exp_f32 v153, v153
  v_mfma_f32_16x16x32_bf16 v[76:79], v[124:127], v[160:163], v[76:79]
  v_cvt_pk_bf16_f32 v164, v152, v153
  v_mfma_f32_16x16x32_bf16 a[64:67], v[128:131], v[160:163], a[64:67]
  v_exp_f32 v154, v154
  v_mfma_f32_16x16x32_bf16 a[68:71], v[132:135], v[160:163], a[68:71]
  v_mfma_f32_16x16x32_bf16 a[72:75], v[136:139], v[160:163], a[72:75]
  v_exp_f32 v155, v155
  v_mfma_f32_16x16x32_bf16 a[76:79], v[140:143], v[160:163], a[76:79]
  v_cvt_pk_bf16_f32 v165, v154, v155
  v_mfma_f32_16x16x32_bf16 v[212:215], v[224:227], v[160:163], v[212:215]
  v_exp_f32 v156, v156
  v_mfma_f32_16x16x32_bf16 v[144:147], a[224:227], a[208:211], v[192:195]
  v_mfma_f32_16x16x32_bf16 v[144:147], a[228:231], a[212:215], v[144:147]
  v_exp_f32 v157, v157
  s_waitcnt vmcnt(9)
  v_mfma_f32_16x16x32_bf16 v[144:147], a[232:235], a[216:219], v[144:147]
  v_cvt_pk_bf16_f32 v166, v156, v157
  ds_read_b128 a[224:227], v228 offset:0
  v_mfma_f32_16x16x32_bf16 v[144:147], a[236:239], a[220:223], v[144:147]
  v_exp_f32 v158, v158
  v_mfma_f32_16x16x32_bf16 v[148:151], a[240:243], a[208:211], v[192:195]
  v_exp_f32 v159, v159
  v_mfma_f32_16x16x32_bf16 v[148:151], a[244:247], a[212:215], v[148:151]
  v_cvt_pk_bf16_f32 v167, v158, v159
  ds_read_b128 a[228:231], v229 offset:0
  v_mfma_f32_16x16x32_bf16 v[148:151], a[248:251], a[216:219], v[148:151]
  ds_read_b128 a[232:235], v230 offset:0
  ds_read_b128 a[236:239], v231 offset:0
  v_mfma_f32_16x16x32_bf16 v[148:151], a[252:255], a[220:223], v[148:151]
  ds_read_b128 a[240:243], v228 offset:4096
  ds_read_b128 a[244:247], v229 offset:4096
  v_mfma_f32_16x16x32_bf16 v[80:83], v[112:115], v[164:167], v[80:83]
  v_exp_f32 v144, v144
  v_mfma_f32_16x16x32_bf16 v[84:87], v[116:119], v[164:167], v[84:87]
  ds_read_b128 a[248:251], v230 offset:4096
  ds_read_b128 a[252:255], v231 offset:4096
  v_mfma_f32_16x16x32_bf16 v[88:91], v[120:123], v[164:167], v[88:91]
  v_exp_f32 v145, v145
  v_mfma_f32_16x16x32_bf16 v[92:95], v[124:127], v[164:167], v[92:95]
  v_cvt_pk_bf16_f32 v160, v144, v145
  v_mfma_f32_16x16x32_bf16 a[80:83], v[128:131], v[164:167], a[80:83]
  v_exp_f32 v146, v146
  v_mfma_f32_16x16x32_bf16 a[84:87], v[132:135], v[164:167], a[84:87]
  v_mfma_f32_16x16x32_bf16 a[88:91], v[136:139], v[164:167], a[88:91]
  v_exp_f32 v147, v147
  v_mfma_f32_16x16x32_bf16 a[92:95], v[140:143], v[164:167], a[92:95]
  v_cvt_pk_bf16_f32 v161, v146, v147
  v_mfma_f32_16x16x32_bf16 v[216:219], v[224:227], v[164:167], v[216:219]
  v_exp_f32 v148, v148
  s_waitcnt lgkmcnt(0)
  v_mfma_f32_16x16x32_bf16 v[152:155], a[224:227], a[112:115], v[168:171]
  v_mfma_f32_16x16x32_bf16 v[152:155], a[228:231], a[116:119], v[152:155]
  v_exp_f32 v149, v149
  v_mfma_f32_16x16x32_bf16 v[152:155], a[232:235], a[120:123], v[152:155]
  v_cvt_pk_bf16_f32 v162, v148, v149
  v_mfma_f32_16x16x32_bf16 v[152:155], a[236:239], a[124:127], v[152:155]
  v_exp_f32 v150, v150
  v_mfma_f32_16x16x32_bf16 v[156:159], a[240:243], a[112:115], v[168:171]
  v_exp_f32 v151, v151
  v_mfma_f32_16x16x32_bf16 v[156:159], a[244:247], a[116:119], v[156:159]
  v_cvt_pk_bf16_f32 v163, v150, v151
  v_mfma_f32_16x16x32_bf16 v[156:159], a[248:251], a[120:123], v[156:159]
  v_mfma_f32_16x16x32_bf16 v[156:159], a[252:255], a[124:127], v[156:159]
LP_B_s15:
  s_waitcnt vmcnt(0)
  v_mfma_f32_16x16x32_bf16 v[96:99], v[112:115], v[160:163], v[96:99]
  v_exp_f32 v152, v152
  ds_read_b64_tr_b16 v[112:113], v232 offset:0
  v_mfma_f32_16x16x32_bf16 v[100:103], v[116:119], v[160:163], v[100:103]
  ds_read_b64_tr_b16 v[114:115], v232 offset:4096
  v_mfma_f32_16x16x32_bf16 v[104:107], v[120:123], v[160:163], v[104:107]
  v_exp_f32 v153, v153
  ds_read_b64_tr_b16 v[116:117], v233 offset:0
  v_mfma_f32_16x16x32_bf16 v[108:111], v[124:127], v[160:163], v[108:111]
  v_cvt_pk_bf16_f32 v164, v152, v153
  ds_read_b64_tr_b16 v[118:119], v233 offset:4096
  v_mfma_f32_16x16x32_bf16 a[96:99], v[128:131], v[160:163], a[96:99]
  v_exp_f32 v154, v154
  ds_read_b64_tr_b16 v[120:121], v234 offset:0
  v_mfma_f32_16x16x32_bf16 a[100:103], v[132:135], v[160:163], a[100:103]
  ds_read_b64_tr_b16 v[122:123], v234 offset:4096
  v_mfma_f32_16x16x32_bf16 a[104:107], v[136:139], v[160:163], a[104:107]
  v_exp_f32 v155, v155
  ds_read_b64_tr_b16 v[124:125], v235 offset:0
  v_mfma_f32_16x16x32_bf16 a[108:111], v[140:143], v[160:163], a[108:111]
  v_cvt_pk_bf16_f32 v165, v154, v155
  ds_read_b64_tr_b16 v[126:127], v235 offset:4096
  v_mfma_f32_16x16x32_bf16 v[220:223], v[224:227], v[160:163], v[220:223]
  v_exp_f32 v156, v156
  ds_read_b64_tr_b16 v[128:129], v236 offset:0
  v_mfma_f32_16x16x32_bf16 v[144:147], a[224:227], a[128:131], v[172:175]
  ds_read_b64_tr_b16 v[130:131], v236 offset:4096
  v_mfma_f32_16x16x32_bf16 v[144:147], a[228:231], a[132:135], v[144:147]
  v_exp_f32 v157, v157
  ds_read_b64_tr_b16 v[132:133], v237 offset:0
  v_mfma_f32_16x16x32_bf16 v[144:147], a[232:235], a[136:139], v[144:147]
  v_cvt_pk_bf16_f32 v166, v156, v157
  ds_read_b64_tr_b16 v[134:135], v237 offset:4096
  v_mfma_f32_16x16x32_bf16 v[144:147], a[236:239], a[140:143], v[144:147]
  v_exp_f32 v158, v158
  ds_read_b64_tr_b16 v[136:137], v238 offset:0
  v_mfma_f32_16x16x32_bf16 v[148:151], a[240:243], a[128:131], v[172:175]
  v_exp_f32 v159, v159
  ds_read_b64_tr_b16 v[138:139], v238 offset:4096
  v_mfma_f32_16x16x32_bf16 v[148:151], a[244:247], a[132:135], v[148:151]
  v_cvt_pk_bf16_f32 v167, v158, v159
  ds_read_b64_tr_b16 v[140:141], v239 offset:0
  v_mfma_f32_16x16x32_bf16 v[148:151], a[248:251], a[136:139], v[148:151]
  ds_read_b64_tr_b16 v[142:143], v239 offset:4096
  v_mfma_f32_16x16x32_bf16 v[148:151], a[252:255], a[140:143], v[148:151]
  v_readfirstlane_b32 s66, v248
  s_waitcnt lgkmcnt(8)
  v_mfma_f32_16x16x32_bf16 v[0:3], v[112:115], v[164:167], v[0:3]
  v_exp_f32 v144, v144
  v_mfma_f32_16x16x32_bf16 v[4:7], v[116:119], v[164:167], v[4:7]
  s_add_u32 m0, s67, 145408
  s_add_u32 s30, s96, 0
  s_and_b32 s30, s30, 3
  s_lshl2_add_u32 s29, s89, s30
  s_mul_i32 s64, s29, 73728
  buffer_load_dwordx4 v251, s[68:71], s64 offen offset:0  lds
  v_mfma_f32_16x16x32_bf16 v[8:11], v[120:123], v[164:167], v[8:11]
  v_exp_f32 v145, v145
  v_mfma_f32_16x16x32_bf16 v[12:15], v[124:127], v[164:167], v[12:15]
  v_cvt_pk_bf16_f32 v160, v144, v145
  s_waitcnt lgkmcnt(0)
  v_mfma_f32_16x16x32_bf16 a[0:3], v[128:131], v[164:167], a[0:3]
  v_exp_f32 v146, v146
  v_mfma_f32_16x16x32_bf16 a[4:7], v[132:135], v[164:167], a[4:7]
  buffer_load_dwordx4 v252, s[68:71], s64 offen offset:1024  lds
  v_mfma_f32_16x16x32_bf16 a[8:11], v[136:139], v[164:167], a[8:11]
  v_exp_f32 v147, v147
  v_mfma_f32_16x16x32_bf16 a[12:15], v[140:143], v[164:167], a[12:15]
  v_cvt_pk_bf16_f32 v161, v146, v147
  v_mfma_f32_16x16x32_bf16 v[196:199], v[224:227], v[164:167], v[196:199]
  v_exp_f32 v148, v148
  v_mfma_f32_16x16x32_bf16 v[152:155], a[224:227], a[144:147], v[176:179]
  buffer_load_dwordx4 v253, s[68:71], s64 offen offset:2048  lds
  v_mfma_f32_16x16x32_bf16 v[152:155], a[228:231], a[148:151], v[152:155]
  v_exp_f32 v149, v149
  v_mfma_f32_16x16x32_bf16 v[152:155], a[232:235], a[152:155], v[152:155]
  v_cvt_pk_bf16_f32 v162, v148, v149
  v_mfma_f32_16x16x32_bf16 v[152:155], a[236:239], a[156:159], v[152:155]
  v_exp_f32 v150, v150
  v_mfma_f32_16x16x32_bf16 v[156:159], a[240:243], a[144:147], v[176:179]
  v_exp_f32 v151, v151
  v_mfma_f32_16x16x32_bf16 v[156:159], a[244:247], a[148:151], v[156:159]
  v_cvt_pk_bf16_f32 v163, v150, v151
  v_mfma_f32_16x16x32_bf16 v[156:159], a[248:251], a[152:155], v[156:159]
  buffer_load_dwordx4 v254, s[68:71], s64 offen offset:3072  lds
  v_mfma_f32_16x16x32_bf16 v[156:159], a[252:255], a[156:159], v[156:159]
  s_add_u32 m0, m0, 4096
  s_nop 0
  buffer_load_dwordx4 v255, s[68:71], s64 offen offset:0  lds
  v_mfma_f32_16x16x32_bf16 v[16:19], v[112:115], v[160:163], v[16:19]
  v_exp_f32 v152, v152
  v_mfma_f32_16x16x32_bf16 v[20:23], v[116:119], v[160:163], v[20:23]
  ds_write_b128 v244, a[0:3] offset:0
  v_mfma_f32_16x16x32_bf16 v[24:27], v[120:123], v[160:163], v[24:27]
  v_exp_f32 v153, v153
  v_mfma_f32_16x16x32_bf16 v[28:31], v[124:127], v[160:163], v[28:31]
  v_cvt_pk_bf16_f32 v164, v152, v153
  v_mfma_f32_16x16x32_bf16 a[16:19], v[128:131], v[160:163], a[16:19]
  v_exp_f32 v154, v154
  v_mfma_f32_16x16x32_bf16 a[20:23], v[132:135], v[160:163], a[20:23]
  ds_write_b128 v244, a[4:7] offset:1024
  v_mfma_f32_16x16x32_bf16 a[24:27], v[136:139], v[160:163], a[24:27]
  v_exp_f32 v155, v155
  v_mfma_f32_16x16x32_bf16 a[28:31], v[140:143], v[160:163], a[28:31]
  v_cvt_pk_bf16_f32 v165, v154, v155
  v_mfma_f32_16x16x32_bf16 v[200:203], v[224:227], v[160:163], v[200:203]
  v_exp_f32 v156, v156
  v_mfma_f32_16x16x32_bf16 v[144:147], a[224:227], a[160:163], v[180:183]
  ds_write_b128 v244, a[8:11] offset:2048
  v_mfma_f32_16x16x32_bf16 v[144:147], a[228:231], a[164:167], v[144:147]
  v_exp_f32 v157, v157
  v_mfma_f32_16x16x32_bf16 v[144:147], a[232:235], a[168:171], v[144:147]
  v_cvt_pk_bf16_f32 v166, v156, v157
  v_mfma_f32_16x16x32_bf16 v[144:147], a[236:239], a[172:175], v[144:147]
  v_exp_f32 v158, v158
  v_mfma_f32_16x16x32_bf16 v[148:151], a[240:243], a[160:163], v[180:183]
  v_exp_f32 v159, v159
  v_mfma_f32_16x16x32_bf16 v[148:151], a[244:247], a[164:167], v[148:151]
  v_cvt_pk_bf16_f32 v167, v158, v159
  v_mfma_f32_16x16x32_bf16 v[148:151], a[248:251], a[168:171], v[148:151]
  ds_write_b128 v244, a[12:15] offset:3072
  v_mfma_f32_16x16x32_bf16 v[148:151], a[252:255], a[172:175], v[148:151]
  v_mfma_f32_16x16x32_bf16 v[32:35], v[112:115], v[164:167], v[32:35]
  v_exp_f32 v144, v144
  v_mfma_f32_16x16x32_bf16 v[36:39], v[116:119], v[164:167], v[36:39]
  ds_write_b128 v244, a[16:19] offset:4096
  v_mfma_f32_16x16x32_bf16 v[40:43], v[120:123], v[164:167], v[40:43]
  v_exp_f32 v145, v145
  v_mfma_f32_16x16x32_bf16 v[44:47], v[124:127], v[164:167], v[44:47]
  v_cvt_pk_bf16_f32 v160, v144, v145
  v_mfma_f32_16x16x32_bf16 a[32:35], v[128:131], v[164:167], a[32:35]
  v_exp_f32 v146, v146
  v_mfma_f32_16x16x32_bf16 a[36:39], v[132:135], v[164:167], a[36:39]
  ds_write_b128 v244, a[20:23] offset:5120
  v_mfma_f32_16x16x32_bf16 a[40:43], v[136:139], v[164:167], a[40:43]
  v_exp_f32 v147, v147
  v_mfma_f32_16x16x32_bf16 a[44:47], v[140:143], v[164:167], a[44:47]
  v_cvt_pk_bf16_f32 v161, v146, v147
  v_mfma_f32_16x16x32_bf16 v[204:207], v[224:227], v[164:167], v[204:207]
  v_exp_f32 v148, v148
  v_mfma_f32_16x16x32_bf16 v[152:155], a[224:227], a[176:179], v[184:187]
  ds_write_b128 v244, a[24:27] offset:6144
  v_mfma_f32_16x16x32_bf16 v[152:155], a[228:231], a[180:183], v[152:155]
  v_exp_f32 v149, v149
  v_mfma_f32_16x16x32_bf16 v[152:155], a[232:235], a[184:187], v[152:155]
  v_cvt_pk_bf16_f32 v162, v148, v149
  v_mfma_f32_16x16x32_bf16 v[152:155], a[236:239], a[188:191], v[152:155]
  v_exp_f32 v150, v150
  v_mfma_f32_16x16x32_bf16 v[156:159], a[240:243], a[176:179], v[184:187]
  v_exp_f32 v151, v151
  v_mfma_f32_16x16x32_bf16 v[156:159], a[244:247], a[180:183], v[156:159]
  v_cvt_pk_bf16_f32 v163, v150, v151
  v_mfma_f32_16x16x32_bf16 v[156:159], a[248:251], a[184:187], v[156:159]
  ds_write_b128 v244, a[28:31] offset:7168
  v_mfma_f32_16x16x32_bf16 v[156:159], a[252:255], a[188:191], v[156:159]
  v_mfma_f32_16x16x32_bf16 v[48:51], v[112:115], v[160:163], v[48:51]
  v_exp_f32 v152, v152
  v_mfma_f32_16x16x32_bf16 v[52:55], v[116:119], v[160:163], v[52:55]
  ds_write_b128 v244, a[32:35] offset:8192
  v_mfma_f32_16x16x32_bf16 v[56:59], v[120:123], v[160:163], v[56:59]
  v_exp_f32 v153, v153
  v_mfma_f32_16x16x32_bf16 v[60:63], v[124:127], v[160:163], v[60:63]
  v_cvt_pk_bf16_f32 v164, v152, v153
  v_mfma_f32_16x16x32_bf16 a[48:51], v[128:131], v[160:163], a[48:51]
  v_exp_f32 v154, v154
  v_mfma_f32_16x16x32_bf16 a[52:55], v[132:135], v[160:163], a[52:55]
  ds_write_b128 v244, a[36:39] offset:9216
  v_mfma_f32_16x16x32_bf16 a[56:59], v[136:139], v[160:163], a[56:59]
  v_exp_f32 v155, v155
  v_mfma_f32_16x16x32_bf16 a[60:63], v[140:143], v[160:163], a[60:63]
  v_cvt_pk_bf16_f32 v165, v154, v155
  v_mfma_f32_16x16x32_bf16 v[208:211], v[224:227], v[160:163], v[208:211]
  v_exp_f32 v156, v156
  v_mfma_f32_16x16x32_bf16 v[144:147], a[224:227], a[192:195], v[188:191]
  ds_write_b128 v244, a[40:43] offset:10240
  v_mfma_f32_16x16x32_bf16 v[144:147], a[228:231], a[196:199], v[144:147]
  v_exp_f32 v157, v157
  v_mfma_f32_16x16x32_bf16 v[144:147], a[232:235], a[200:203], v[144:147]
  v_cvt_pk_bf16_f32 v166, v156, v157
  v_mfma_f32_16x16x32_bf16 v[144:147], a[236:239], a[204:207], v[144:147]
  v_exp_f32 v158, v158
  v_mfma_f32_16x16x32_bf16 v[148:151], a[240:243], a[192:195], v[188:191]
  v_exp_f32 v159, v159
  v_mfma_f32_16x16x32_bf16 v[148:151], a[244:247], a[196:199], v[148:151]
  v_cvt_pk_bf16_f32 v167, v158, v159
  v_mfma_f32_16x16x32_bf16 v[148:151], a[248:251], a[200:203], v[148:151]
  ds_write_b128 v244, a[44:47] offset:11264
  v_mfma_f32_16x16x32_bf16 v[148:151], a[252:255], a[204:207], v[148:151]
  v_mfma_f32_16x16x32_bf16 v[64:67], v[112:115], v[164:167], v[64:67]
  v_exp_f32 v144, v144
  v_mfma_f32_16x16x32_bf16 v[68:71], v[116:119], v[164:167], v[68:71]
  ds_write_b128 v244, a[48:51] offset:12288
  v_mfma_f32_16x16x32_bf16 v[72:75], v[120:123], v[164:167], v[72:75]
  v_exp_f32 v145, v145
  v_mfma_f32_16x16x32_bf16 v[76:79], v[124:127], v[164:167], v[76:79]
  v_cvt_pk_bf16_f32 v160, v144, v145
  v_mfma_f32_16x16x32_bf16 a[64:67], v[128:131], v[164:167], a[64:67]
  v_exp_f32 v146, v146
  v_mfma_f32_16x16x32_bf16 a[68:71], v[132:135], v[164:167], a[68:71]
  ds_write_b128 v244, a[52:55] offset:13312
  v_mfma_f32_16x16x32_bf16 a[72:75], v[136:139], v[164:167], a[72:75]
  v_exp_f32 v147, v147
  v_mfma_f32_16x16x32_bf16 a[76:79], v[140:143], v[164:167], a[76:79]
  v_cvt_pk_bf16_f32 v161, v146, v147
  v_mfma_f32_16x16x32_bf16 v[212:215], v[224:227], v[164:167], v[212:215]
  v_exp_f32 v148, v148
  v_mfma_f32_16x16x32_bf16 v[152:155], a[224:227], a[208:211], v[192:195]
  ds_write_b128 v244, a[56:59] offset:14336
  v_mfma_f32_16x16x32_bf16 v[152:155], a[228:231], a[212:215], v[152:155]
  v_exp_f32 v149, v149
  v_mfma_f32_16x16x32_bf16 v[152:155], a[232:235], a[216:219], v[152:155]
  v_cvt_pk_bf16_f32 v162, v148, v149
  v_mfma_f32_16x16x32_bf16 v[152:155], a[236:239], a[220:223], v[152:155]
  v_exp_f32 v150, v150
  v_mfma_f32_16x16x32_bf16 v[156:159], a[240:243], a[208:211], v[192:195]
  v_exp_f32 v151, v151
  v_mfma_f32_16x16x32_bf16 v[156:159], a[244:247], a[212:215], v[156:159]
  v_cvt_pk_bf16_f32 v163, v150, v151
  v_mfma_f32_16x16x32_bf16 v[156:159], a[248:251], a[216:219], v[156:159]
  ds_write_b128 v244, a[60:63] offset:15360
  v_mfma_f32_16x16x32_bf16 v[156:159], a[252:255], a[220:223], v[156:159]
  v_mfma_f32_16x16x32_bf16 v[80:83], v[112:115], v[160:163], v[80:83]
  v_exp_f32 v152, v152
  v_mfma_f32_16x16x32_bf16 v[84:87], v[116:119], v[160:163], v[84:87]
  ds_write_b128 v245, a[64:67] offset:0
  v_mfma_f32_16x16x32_bf16 v[88:91], v[120:123], v[160:163], v[88:91]
  v_exp_f32 v153, v153
  v_mfma_f32_16x16x32_bf16 v[92:95], v[124:127], v[160:163], v[92:95]
  v_cvt_pk_bf16_f32 v164, v152, v153
  buffer_load_dword v250, v249, s[44:47], 0 offen
  v_add_u32 v249, 8192, v249
  v_mfma_f32_16x16x32_bf16 a[80:83], v[128:131], v[160:163], a[80:83]
  v_exp_f32 v154, v154
  v_mfma_f32_16x16x32_bf16 a[84:87], v[132:135], v[160:163], a[84:87]
  ds_write_b128 v245, a[68:71] offset:1024
  v_mfma_f32_16x16x32_bf16 a[88:91], v[136:139], v[160:163], a[88:91]
  v_exp_f32 v155, v155
  v_mfma_f32_16x16x32_bf16 a[92:95], v[140:143], v[160:163], a[92:95]
  v_cvt_pk_bf16_f32 v165, v154, v155
  v_mfma_f32_16x16x32_bf16 v[216:219], v[224:227], v[160:163], v[216:219]
  v_exp_f32 v156, v156
  ds_write_b128 v245, a[72:75] offset:2048
  v_exp_f32 v157, v157
  s_nop 0
  v_cvt_pk_bf16_f32 v166, v156, v157
  v_exp_f32 v158, v158
  v_exp_f32 v159, v159
  buffer_load_dword v250, v249, s[44:47], 0 offen
  v_add_u32 v249, 8192, v249
  s_nop 0
  v_cvt_pk_bf16_f32 v167, v158, v159
  ds_write_b128 v245, a[76:79] offset:3072
LP_B_e:
  s_branch L1_tail
L1_A_go:
  v_mfma_f32_16x16x32_bf16 v[144:147], a[224:227], a[112:115], v[168:171]
  s_add_u32 m0, s27, s28
  s_add_u32 s29, s26, 4096
  buffer_load_dwordx4 v240, s[12:15], s26 offen offset:0 nt lds
  v_mfma_f32_16x16x32_bf16 v[144:147], a[228:231], a[116:119], v[144:147]
  buffer_load_dwordx4 v241, s[12:15], s26 offen offset:1024 nt lds
  v_mfma_f32_16x16x32_bf16 v[144:147], a[232:235], a[120:123], v[144:147]
  buffer_load_dwordx4 v240, s[12:15], s26 offen offset:2048 nt lds
  v_mfma_f32_16x16x32_bf16 v[144:147], a[236:239], a[124:127], v[144:147]
  buffer_load_dwordx4 v241, s[12:15], s26 offen offset:3072 nt lds
  v_mfma_f32_16x16x32_bf16 v[148:151], a[240:243], a[112:115], v[168:171]
  s_add_u32 m0, m0, 4096
  s_add_u32 s27, s27, 0x8000
  buffer_load_dwordx4 v240, s[12:15], s29 offen offset:0 nt lds
  v_mfma_f32_16x16x32_bf16 v[148:151], a[244:247], a[116:119], v[148:151]
  buffer_load_dwordx4 v241, s[12:15], s29 offen offset:1024 nt lds
  v_mfma_f32_16x16x32_bf16 v[148:151], a[248:251], a[120:123], v[148:151]
  buffer_load_dwordx4 v240, s[12:15], s29 offen offset:2048 nt lds
  v_mfma_f32_16x16x32_bf16 v[148:151], a[252:255], a[124:127], v[148:151]
  buffer_load_dwordx4 v241, s[12:15], s29 offen offset:3072 nt lds
  s_add_u32 s26, s26, 8192
  s_and_b32 s27, s27, 0x1ffff
  s_cmp_lg_u32 s21, 0
  s_cbranch_scc1 L1_A_nok3
  s_add_u32 m0, s27, s28
  s_add_u32 s29, s26, 4096
  buffer_load_dwordx4 v240, s[12:15], s26 offen offset:0 nt lds
  buffer_load_dwordx4 v241, s[12:15], s26 offen offset:1024 nt lds
  buffer_load_dwordx4 v240, s[12:15], s26 offen offset:2048 nt lds
  buffer_load_dwordx4 v241, s[12:15], s26 offen offset:3072 nt lds
  s_add_u32 m0, m0, 4096
  s_add_u32 s27, s27, 0x8000
  buffer_load_dwordx4 v240, s[12:15], s29 offen offset:0 nt lds
  buffer_load_dwordx4 v241, s[12:15], s29 offen offset:1024 nt lds
  buffer_load_dwordx4 v240, s[12:15], s29 offen offset:2048 nt lds
  buffer_load_dwordx4 v241, s[12:15], s29 offen offset:3072 nt lds
  s_add_u32 s26, s26, 8192
  s_and_b32 s27, s27, 0x1ffff
L1_A_nok3:
  s_mov_b32 s30, 6
  v_lshlrev_b32 v243, 4, v242
  s_add_u32 s61, s20, s31
  s_sub_u32 s90, 6, s89
  v_add_lshl_u32 v248, v242, s61, 2
  v_mov_b32 v249, 1
  s_waitcnt vmcnt(16)
  s_barrier
  v_exp_f32 v144, v144
  ds_read_b64_tr_b16 v[112:113], v232 offset:0
  ds_read_b64_tr_b16 v[114:115], v232 offset:4096
  v_exp_f32 v145, v145
  ds_read_b64_tr_b16 v[116:117], v233 offset:0
  v_cvt_pk_bf16_f32 v160, v144, v145
  ds_read_b64_tr_b16 v[118:119], v233 offset:4096
  v_exp_f32 v146, v146
  ds_read_b64_tr_b16 v[120:121], v234 offset:0
  ds_read_b64_tr_b16 v[122:123], v234 offset:4096
  v_exp_f32 v147, v147
  ds_read_b64_tr_b16 v[124:125], v235 offset:0
  v_cvt_pk_bf16_f32 v161, v146, v147
  ds_read_b64_tr_b16 v[126:127], v235 offset:4096
  v_exp_f32 v148, v148
  ds_read_b64_tr_b16 v[128:129], v236 offset:0
  v_mfma_f32_16x16x32_bf16 v[152:155], a[224:227], a[128:131], v[172:175]
  ds_read_b64_tr_b16 v[130:131], v236 offset:4096
  v_mfma_f32_16x16x32_bf16 v[152:155], a[228:231], a[132:135], v[152:155]
  v_exp_f32 v149, v149
  ds_read_b64_tr_b16 v[132:133], v237 offset:0
  v_mfma_f32_16x16x32_bf16 v[152:155], a[232:235], a[136:139], v[152:155]
  v_cvt_pk_bf16_f32 v162, v148, v149
  ds_read_b64_tr_b16 v[134:135], v237 offset:4096
  v_mfma_f32_16x16x32_bf16 v[152:155], a[236:239], a[140:143], v[152:155]
  v_exp_f32 v150, v150
  ds_read_b64_tr_b16 v[136:137], v238 offset:0
  v_mfma_f32_16x16x32_bf16 v[156:159], a[240:243], a[128:131], v[172:175]
  v_exp_f32 v151, v151
  ds_read_b64_tr_b16 v[138:139], v238 offset:4096
  v_mfma_f32_16x16x32_bf16 v[156:159], a[244:247], a[132:135], v[156:159]
  v_cvt_pk_bf16_f32 v163, v150, v151
  ds_read_b64_tr_b16 v[140:141], v239 offset:0
  v_mfma_f32_16x16x32_bf16 v[156:159], a[248:251], a[136:139], v[156:159]
  ds_read_b64_tr_b16 v[142:143], v239 offset:4096
  v_mfma_f32_16x16x32_bf16 v[156:159], a[252:255], a[140:143], v[156:159]
  s_waitcnt vmcnt(2)
  s_cmp_lt_u32 s26, 0x20000
  s_cselect_b32 s14, 131072, 0
  s_add_u32 m0, s27, s28
  s_add_u32 s29, s26, 4096
  buffer_load_dwordx4 v240, s[12:15], s26 offen offset:0 nt lds
  s_waitcnt lgkmcnt(8)
  v_mfma_f32_16x16x32_bf16 v[0:3], v[112:115], v[160:163], 0
  v_exp_f32 v152, v152
  v_mfma_f32_16x16x32_bf16 v[4:7], v[116:119], v[160:163], 0
  v_mfma_f32_16x16x32_bf16 v[8:11], v[120:123], v[160:163], 0
  v_exp_f32 v153, v153
  v_mfma_f32_16x16x32_bf16 v[12:15], v[124:127], v[160:163], 0
  v_cvt_pk_bf16_f32 v164, v152, v153
  s_waitcnt lgkmcnt(0)
  v_mfma_f32_16x16x32_bf16 a[0:3], v[128:131], v[160:163], 0
  v_exp_f32 v154, v154
  v_mfma_f32_16x16x32_bf16 a[4:7], v[132:135], v[160:163], 0
  v_mfma_f32_16x16x32_bf16 a[8:11], v[136:139], v[160:163], 0
  v_exp_f32 v155, v155
  v_mfma_f32_16x16x32_bf16 a[12:15], v[140:143], v[160:163], 0
  v_cvt_pk_bf16_f32 v165, v154, v155
  v_mfma_f32_16x16x32_bf16 v[196:199], v[224:227], v[160:163], 0
  v_exp_f32 v156, v156
  v_mfma_f32_16x16x32_bf16 v[144:147], a[224:227], a[144:147], v[176:179]
  s_waitcnt vmcnt(2)
  buffer_load_dwordx4 v241, s[12:15], s26 offen offset:1024 nt lds
  v_mfma_f32_16x16x32_bf16 v[144:147], a[228:231], a[148:151], v[144:147]
  v_exp_f32 v157, v157
  v_mfma_f32_16x16x32_bf16 v[144:147], a[232:235], a[152:155], v[144:147]
  v_cvt_pk_bf16_f32 v166, v156, v157
  v_mfma_f32_16x16x32_bf16 v[144:147], a[236:239], a[156:159], v[144:147]
  v_exp_f32 v158, v158
  v_mfma_f32_16x16x32_bf16 v[148:151], a[240:243], a[144:147], v[176:179]
  v_exp_f32 v159, v159
  v_mfma_f32_16x16x32_bf16 v[148:151], a[244:247], a[148:151], v[148:151]
  v_cvt_pk_bf16_f32 v167, v158, v159
  v_mfma_f32_16x16x32_bf16 v[148:151], a[248:251], a[152:155], v[148:151]
  v_mfma_f32_16x16x32_bf16 v[148:151], a[252:255], a[156:159], v[148:151]
  v_mfma_f32_16x16x32_bf16 v[16:19], v[112:115], v[164:167], 0
  v_exp_f32 v144, v144
  v_mfma_f32_16x16x32_bf16 v[20:23], v[116:119], v[164:167], 0
  v_mfma_f32_16x16x32_bf16 v[24:27], v[120:123], v[164:167], 0
  v_exp_f32 v145, v145
  v_mfma_f32_16x16x32_bf16 v[28:31], v[124:127], v[164:167], 0
  v_cvt_pk_bf16_f32 v160, v144, v145
  v_mfma_f32_16x16x32_bf16 a[16:19], v[128:131], v[164:167], 0
  v_exp_f32 v146, v146
  v_mfma_f32_16x16x32_bf16 a[20:23], v[132:135], v[164:167], 0
  s_waitcnt vmcnt(2)
  buffer_load_dwordx4 v240, s[12:15], s26 offen offset:2048 nt lds
  v_mfma_f32_16x16x32_bf16 a[24:27], v[136:139], v[164:167], 0
  v_exp_f32 v147, v147
  v_mfma_f32_16x16x32_bf16 a[28:31], v[140:143], v[164:167], 0
  v_cvt_pk_bf16_f32 v161, v146, v147
  v_mfma_f32_16x16x32_bf16 v[200:203], v[224:227], v[164:167], 0
  v_exp_f32 v148, v148
  v_mfma_f32_16x16x32_bf16 v[152:155], a[224:227], a[160:163], v[180:183]
  v_mfma_f32_16x16x32_bf16 v[152:155], a[228:231], a[164:167], v[152:155]
  v_exp_f32 v149, v149
  v_mfma_f32_16x16x32_bf16 v[152:155], a[232:235], a[168:171], v[152:155]
  v_cvt_pk_bf16_f32 v162, v148, v149
  v_mfma_f32_16x16x32_bf16 v[152:155], a[236:239], a[172:175], v[152:155]
  v_exp_f32 v150, v150
  v_mfma_f32_16x16x32_bf16 v[156:159], a[240:243], a[160:163], v[180:183]
  v_exp_f32 v151, v151
  v_mfma_f32_16x16x32_bf16 v[156:159], a[244:247], a[164:167], v[156:159]
  v_cvt_pk_bf16_f32 v163, v150, v151
  v_mfma_f32_16x16x32_bf16 v[156:159], a[248:251], a[168:171], v[156:159]
  v_mfma_f32_16x16x32_bf16 v[156:159], a[252:255], a[172:175], v[156:159]
  v_mfma_f32_16x16x32_bf16 v[32:35], v[112:115], v[160:163], 0
  v_exp_f32 v152, v152
  v_mfma_f32_16x16x32_bf16 v[36:39], v[116:119], v[160:163], 0
  s_waitcnt vmcnt(3)
  buffer_load_dwordx4 v241, s[12:15], s26 offen offset:3072 nt lds
  v_mfma_f32_16x16x32_bf16 v[40:43], v[120:123], v[160:163], 0
  v_exp_f32 v153, v153
  v_mfma_f32_16x16x32_bf16 v[44:47], v[124:127], v[160:163], 0
  v_cvt_pk_bf16_f32 v164, v152, v153
  v_mfma_f32_16x16x32_bf16 a[32:35], v[128:131], v[160:163], 0
  v_exp_f32 v154, v154
  v_mfma_f32_16x16x32_bf16 a[36:39], v[132:135], v[160:163], 0
  v_mfma_f32_16x16x32_bf16 a[40:43], v[136:139], v[160:163], 0
  v_exp_f32 v155, v155
  v_mfma_f32_16x16x32_bf16 a[44:47], v[140:143], v[160:163], 0
  v_cvt_pk_bf16_f32 v165, v154, v155
  v_mfma_f32_16x16x32_bf16 v[204:207], v[224:227], v[160:163], 0
  v_exp_f32 v156, v156
  v_mfma_f32_16x16x32_bf16 v[144:147], a[224:227], a[176:179], v[184:187]
  v_mfma_f32_16x16x32_bf16 v[144:147], a[228:231], a[180:183], v[144:147]
  v_exp_f32 v157, v157
  v_mfma_f32_16x16x32_bf16 v[144:147], a[232:235], a[184:187], v[144:147]
  v_cvt_pk_bf16_f32 v166, v156, v157
  v_mfma_f32_16x16x32_bf16 v[144:147], a[236:239], a[188:191], v[144:147]
  v_exp_f32 v158, v158
  v_mfma_f32_16x16x32_bf16 v[148:151], a[240:243], a[176:179], v[184:187]
  v_exp_f32 v159, v159
  v_mfma_f32_16x16x32_bf16 v[148:151], a[244:247], a[180:183], v[148:151]
  v_cvt_pk_bf16_f32 v167, v158, v159
  v_mfma_f32_16x16x32_bf16 v[148:151], a[248:251], a[184:187], v[148:151]
  s_waitcnt vmcnt(2)
  s_add_u32 m0, m0, 4096
  s_add_u32 s27, s27, 0x8000
  buffer_load_dwordx4 v240, s[12:15], s29 offen offset:0 nt lds
  v_mfma_f32_16x16x32_bf16 v[148:151], a[252:255], a[188:191], v[148:151]
  v_mfma_f32_16x16x32_bf16 v[48:51], v[112:115], v[164:167], 0
  v_exp_f32 v144, v144
  v_mfma_f32_16x16x32_bf16 v[52:55], v[116:119], v[164:167], 0
  v_mfma_f32_16x16x32_bf16 v[56:59], v[120:123], v[164:167], 0
  v_exp_f32 v145, v145
  v_mfma_f32_16x16x32_bf16 v[60:63], v[124:127], v[164:167], 0
  v_cvt_pk_bf16_f32 v160, v144, v145
  v_mfma_f32_16x16x32_bf16 a[48:51], v[128:131], v[164:167], 0
  v_exp_f32 v146, v146
  v_mfma_f32_16x16x32_bf16 a[52:55], v[132:135], v[164:167], 0
  v_mfma_f32_16x16x32_bf16 a[56:59], v[136:139], v[164:167], 0
  v_exp_f32 v147, v147
  v_mfma_f32_16x16x32_bf16 a[60:63], v[140:143], v[164:167], 0
  v_cvt_pk_bf16_f32 v161, v146, v147
  v_mfma_f32_16x16x32_bf16 v[208:211], v[224:227], v[164:167], 0
  v_exp_f32 v148, v148
  v_mfma_f32_16x16x32_bf16 v[152:155], a[224:227], a[192:195], v[188:191]
  s_waitcnt vmcnt(2)
  buffer_load_dwordx4 v241, s[12:15], s29 offen offset:1024 nt lds
  v_mfma_f32_16x16x32_bf16 v[152:155], a[228:231], a[196:199], v[152:155]
  v_exp_f32 v149, v149
  v_mfma_f32_16x16x32_bf16 v[152:155], a[232:235], a[200:203], v[152:155]
  v_cvt_pk_bf16_f32 v162, v148, v149
  v_mfma_f32_16x16x32_bf16 v[152:155], a[236:239], a[204:207], v[152:155]
  v_exp_f32 v150, v150
  v_mfma_f32_16x16x32_bf16 v[156:159], a[240:243], a[192:195], v[188:191]
  v_exp_f32 v151, v151
  v_mfma_f32_16x16x32_bf16 v[156:159], a[244:247], a[196:199], v[156:159]
  v_cvt_pk_bf16_f32 v163, v150, v151
  v_mfma_f32_16x16x32_bf16 v[156:159], a[248:251], a[200:203], v[156:159]
  v_mfma_f32_16x16x32_bf16 v[156:159], a[252:255], a[204:207], v[156:159]
  v_mfma_f32_16x16x32_bf16 v[64:67], v[112:115], v[160:163], 0
  v_exp_f32 v152, v152
  v_mfma_f32_16x16x32_bf16 v[68:71], v[116:119], v[160:163], 0
  v_mfma_f32_16x16x32_bf16 v[72:75], v[120:123], v[160:163], 0
  v_exp_f32 v153, v153
  v_mfma_f32_16x16x32_bf16 v[76:79], v[124:127], v[160:163], 0
  v_cvt_pk_bf16_f32 v164, v152, v153
  v_mfma_f32_16x16x32_bf16 a[64:67], v[128:131], v[160:163], 0
  v_exp_f32 v154, v154
  v_mfma_f32_16x16x32_bf16 a[68:71], v[132:135], v[160:163], 0
  s_waitcnt vmcnt(2)
  buffer_load_dwordx4 v240, s[12:15], s29 offen offset:2048 nt lds
  v_mfma_f32_16x16x32_bf16 a[72:75], v[136:139], v[160:163], 0
  v_exp_f32 v155, v155
  v_mfma_f32_16x16x32_bf16 a[76:79], v[140:143], v[160:163], 0
  v_cvt_pk_bf16_f32 v165, v154, v155
  v_mfma_f32_16x16x32_bf16 v[212:215], v[224:227], v[160:163], 0
  v_exp_f32 v156, v156
  v_mfma_f32_16x16x32_bf16 v[144:147], a[224:227], a[208:211], v[192:195]
  v_mfma_f32_16x16x32_bf16 v[144:147], a[228:231], a[212:215], v[144:147]
  v_exp_f32 v157, v157
  v_mfma_f32_16x16x32_bf16 v[144:147], a[232:235], a[216:219], v[144:147]
  v_cvt_pk_bf16_f32 v166, v156, v157
  ds_read_b128 a[224:227], v228 offset:32768
  v_mfma_f32_16x16x32_bf16 v[144:147], a[236:239], a[220:223], v[144:147]
  v_exp_f32 v158, v158
  v_mfma_f32_16x16x32_bf16 v[148:151], a[240:243], a[208:211], v[192:195]
  v_exp_f32 v159, v159
  v_mfma_f32_16x16x32_bf16 v[148:151], a[244:247], a[212:215], v[148:151]
  v_cvt_pk_bf16_f32 v167, v158, v159
  ds_read_b128 a[228:231], v229 offset:32768
  v_mfma_f32_16x16x32_bf16 v[148:151], a[248:251], a[216:219], v[148:151]
  ds_read_b128 a[232:235], v230 offset:32768
  ds_read_b128 a[236:239], v231 offset:32768
  v_mfma_f32_16x16x32_bf16 v[148:151], a[252:255], a[220:223], v[148:151]
  ds_read_b128 a[240:243], v228 offset:36864
  ds_read_b128 a[244:247], v229 offset:36864
  v_mfma_f32_16x16x32_bf16 v[80:83], v[112:115], v[164:167], 0
  v_exp_f32 v144, v144
  v_mfma_f32_16x16x32_bf16 v[84:87], v[116:119], v[164:167], 0
  ds_read_b128 a[248:251], v230 offset:36864
  ds_read_b128 a[252:255], v231 offset:36864
  v_mfma_f32_16x16x32_bf16 v[88:91], v[120:123], v[164:167], 0
  v_exp_f32 v145, v145
  v_mfma_f32_16x16x32_bf16 v[92:95], v[124:127], v[164:167], 0
  v_cvt_pk_bf16_f32 v160, v144, v145
  v_mfma_f32_16x16x32_bf16 a[80:83], v[128:131], v[164:167], 0
  v_exp_f32 v146, v146
  v_mfma_f32_16x16x32_bf16 a[84:87], v[132:135], v[164:167], 0
  s_waitcnt vmcnt(3)
  buffer_load_dwordx4 v241, s[12:15], s29 offen offset:3072 nt lds
  s_add_u32 s26, s26, 8192
  s_and_b32 s27, s27, 0x1ffff
  v_mfma_f32_16x16x32_bf16 a[88:91], v[136:139], v[164:167], 0
  v_exp_f32 v147, v147
  v_mfma_f32_16x16x32_bf16 a[92:95], v[140:143], v[164:167], 0
  v_cvt_pk_bf16_f32 v161, v146, v147
  v_mfma_f32_16x16x32_bf16 v[216:219], v[224:227], v[164:167], 0
  v_exp_f32 v148, v148
  s_waitcnt lgkmcnt(0)
  v_mfma_f32_16x16x32_bf16 v[152:155], a[224:227], a[112:115], v[168:171]
  v_mfma_f32_16x16x32_bf16 v[152:155], a[228:231], a[116:119], v[152:155]
  v_exp_f32 v149, v149
  v_mfma_f32_16x16x32_bf16 v[152:155], a[232:235], a[120:123], v[152:155]
  v_cvt_pk_bf16_f32 v162, v148, v149
  v_mfma_f32_16x16x32_bf16 v[152:155], a[236:239], a[124:127], v[152:155]
  v_exp_f32 v150, v150
  v_mfma_f32_16x16x32_bf16 v[156:159], a[240:243], a[112:115], v[168:171]
  v_exp_f32 v151, v151
  v_mfma_f32_16x16x32_bf16 v[156:159], a[244:247], a[116:119], v[156:159]
  v_cvt_pk_bf16_f32 v163, v150, v151
  v_mfma_f32_16x16x32_bf16 v[156:159], a[248:251], a[120:123], v[156:159]
  v_xor_b32 v228, 0x10000, v228
  v_xor_b32 v229, 0x10000, v229
  v_mfma_f32_16x16x32_bf16 v[156:159], a[252:255], a[124:127], v[156:159]
  v_xor_b32 v230, 0x10000, v230
  v_xor_b32 v231, 0x10000, v231
  s_waitcnt vmcnt(16)
  s_barrier
  v_mfma_f32_16x16x32_bf16 v[96:99], v[112:115], v[160:163], 0
  v_exp_f32 v152, v152
  ds_read_b64_tr_b16 v[112:113], v232 offset:32768
  v_mfma_f32_16x16x32_bf16 v[100:103], v[116:119], v[160:163], 0
  ds_read_b64_tr_b16 v[114:115], v232 offset:36864
  v_mfma_f32_16x16x32_bf16 v[104:107], v[120:123], v[160:163], 0
  v_exp_f32 v153, v153
  ds_read_b64_tr_b16 v[116:117], v233 offset:32768
  v_mfma_f32_16x16x32_bf16 v[108:111], v[124:127], v[160:163], 0
  v_cvt_pk_bf16_f32 v164, v152, v153
  ds_read_b64_tr_b16 v[118:119], v233 offset:36864
  v_mfma_f32_16x16x32_bf16 a[96:99], v[128:131], v[160:163], 0
  v_exp_f32 v154, v154
  ds_read_b64_tr_b16 v[120:121], v234 offset:32768
  v_mfma_f32_16x16x32_bf16 a[100:103], v[132:135], v[160:163], 0
  ds_read_b64_tr_b16 v[122:123], v234 offset:36864
  v_mfma_f32_16x16x32_bf16 a[104:107], v[136:139], v[160:163], 0
  v_exp_f32 v155, v155
  ds_read_b64_tr_b16 v[124:125], v235 offset:32768
  v_mfma_f32_16x16x32_bf16 a[108:111], v[140:143], v[160:163], 0
  v_cvt_pk_bf16_f32 v165, v154, v155
  ds_read_b64_tr_b16 v[126:127], v235 offset:36864
  v_mfma_f32_16x16x32_bf16 v[220:223], v[224:227], v[160:163], 0
  v_exp_f32 v156, v156
  ds_read_b64_tr_b16 v[128:129], v236 offset:32768
  v_mfma_f32_16x16x32_bf16 v[144:147], a[224:227], a[128:131], v[172:175]
  ds_read_b64_tr_b16 v[130:131], v236 offset:36864
  v_mfma_f32_16x16x32_bf16 v[144:147], a[228:231], a[132:135], v[144:147]
  v_exp_f32 v157, v157
  ds_read_b64_tr_b16 v[132:133], v237 offset:32768
  v_mfma_f32_16x16x32_bf16 v[144:147], a[232:235], a[136:139], v[144:147]
  v_cvt_pk_bf16_f32 v166, v156, v157
  ds_read_b64_tr_b16 v[134:135], v237 offset:36864
  v_mfma_f32_16x16x32_bf16 v[144:147], a[236:239], a[140:143], v[144:147]
  v_exp_f32 v158, v158
  ds_read_b64_tr_b16 v[136:137], v238 offset:32768
  v_mfma_f32_16x16x32_bf16 v[148:151], a[240:243], a[128:131], v[172:175]
  v_exp_f32 v159, v159
  ds_read_b64_tr_b16 v[138:139], v238 offset:36864
  v_mfma_f32_16x16x32_bf16 v[148:151], a[244:247], a[132:135], v[148:151]
  v_cvt_pk_bf16_f32 v167, v158, v159
  ds_read_b64_tr_b16 v[140:141], v239 offset:32768
  v_mfma_f32_16x16x32_bf16 v[148:151], a[248:251], a[136:139], v[148:151]
  ds_read_b64_tr_b16 v[142:143], v239 offset:36864
  v_mfma_f32_16x16x32_bf16 v[148:151], a[252:255], a[140:143], v[148:151]
  s_waitcnt vmcnt(2)
  s_cmp_lt_u32 s26, 0x20000
  s_cselect_b32 s14, 131072, 0
  s_add_u32 m0, s27, s28
  s_add_u32 s29, s26, 4096
  buffer_load_dwordx4 v240, s[12:15], s26 offen offset:0 nt lds
  s_waitcnt lgkmcnt(8)
  v_mfma_f32_16x16x32_bf16 v[0:3], v[112:115], v[164:167], v[0:3]
  v_exp_f32 v144, v144
  v_mfma_f32_16x16x32_bf16 v[4:7], v[116:119], v[164:167], v[4:7]
  v_mfma_f32_16x16x32_bf16 v[8:11], v[120:123], v[164:167], v[8:11]
  v_exp_f32 v145, v145
  v_mfma_f32_16x16x32_bf16 v[12:15], v[124:127], v[164:167], v[12:15]
  v_cvt_pk_bf16_f32 v160, v144, v145
  s_waitcnt lgkmcnt(0)
  v_mfma_f32_16x16x32_bf16 a[0:3], v[128:131], v[164:167], a[0:3]
  v_exp_f32 v146, v146
  v_mfma_f32_16x16x32_bf16 a[4:7], v[132:135], v[164:167], a[4:7]
  v_mfma_f32_16x16x32_bf16 a[8:11], v[136:139], v[164:167], a[8:11]
  v_exp_f32 v147, v147
  v_mfma_f32_16x16x32_bf16 a[12:15], v[140:143], v[164:167], a[12:15]
  v_cvt_pk_bf16_f32 v161, v146, v147
  v_mfma_f32_16x16x32_bf16 v[196:199], v[224:227], v[164:167], v[196:199]
  v_exp_f32 v148, v148
  v_mfma_f32_16x16x32_bf16 v[152:155], a[224:227], a[144:147], v[176:179]
  s_waitcnt vmcnt(2)
  buffer_load_dwordx4 v241, s[12:15], s26 offen offset:1024 nt lds
  v_mfma_f32_16x16x32_bf16 v[152:155], a[228:231], a[148:151], v[152:155]
  v_exp_f32 v149, v149
  v_mfma_f32_16x16x32_bf16 v[152:155], a[232:235], a[152:155], v[152:155]
  v_cvt_pk_bf16_f32 v162, v148, v149
  v_mfma_f32_16x16x32_bf16 v[152:155], a[236:239], a[156:159], v[152:155]
  v_exp_f32 v150, v150
  v_mfma_f32_16x16x32_bf16 v[156:159], a[240:243], a[144:147], v[176:179]
  v_exp_f32 v151, v151
  v_mfma_f32_16x16x32_bf16 v[156:159], a[244:247], a[148:151], v[156:159]
  v_cvt_pk_bf16_f32 v163, v150, v151
  v_mfma_f32_16x16x32_bf16 v[156:159], a[248:251], a[152:155], v[156:159]
  v_mfma_f32_16x16x32_bf16 v[156:159], a[252:255], a[156:159], v[156:159]
  v_xor_b32 v232, 0x10000, v232
  v_xor_b32 v233, 0x10000, v233
  v_mfma_f32_16x16x32_bf16 v[16:19], v[112:115], v[160:163], v[16:19]
  v_exp_f32 v152, v152
  v_mfma_f32_16x16x32_bf16 v[20:23], v[116:119], v[160:163], v[20:23]
  v_mfma_f32_16x16x32_bf16 v[24:27], v[120:123], v[160:163], v[24:27]
  v_exp_f32 v153, v153
  v_mfma_f32_16x16x32_bf16 v[28:31], v[124:127], v[160:163], v[28:31]
  v_cvt_pk_bf16_f32 v164, v152, v153
  v_mfma_f32_16x16x32_bf16 a[16:19], v[128:131], v[160:163], a[16:19]
  v_exp_f32 v154, v154
  v_mfma_f32_16x16x32_bf16 a[20:23], v[132:135], v[160:163], a[20:23]
  s_waitcnt vmcnt(2)
  buffer_load_dwordx4 v240, s[12:15], s26 offen offset:2048 nt lds
  v_mfma_f32_16x16x32_bf16 a[24:27], v[136:139], v[160:163], a[24:27]
  v_exp_f32 v155, v155
  v_mfma_f32_16x16x32_bf16 a[28:31], v[140:143], v[160:163], a[28:31]
  v_cvt_pk_bf16_f32 v165, v154, v155
  v_mfma_f32_16x16x32_bf16 v[200:203], v[224:227], v[160:163], v[200:203]
  v_exp_f32 v156, v156
  v_mfma_f32_16x16x32_bf16 v[144:147], a[224:227], a[160:163], v[180:183]
  v_mfma_f32_16x16x32_bf16 v[144:147], a[228:231], a[164:167], v[144:147]
  v_exp_f32 v157, v157
  v_mfma_f32_16x16x32_bf16 v[144:147], a[232:235], a[168:171], v[144:147]
  v_cvt_pk_bf16_f32 v166, v156, v157
  v_mfma_f32_16x16x32_bf16 v[144:147], a[236:239], a[172:175], v[144:147]
  v_exp_f32 v158, v158
  v_mfma_f32_16x16x32_bf16 v[148:151], a[240:243], a[160:163], v[180:183]
  v_exp_f32 v159, v159
  v_mfma_f32_16x16x32_bf16 v[148:151], a[244:247], a[164:167], v[148:151]
  v_cvt_pk_bf16_f32 v167, v158, v159
  v_mfma_f32_16x16x32_bf16 v[148:151], a[248:251], a[168:171], v[148:151]
  v_mfma_f32_16x16x32_bf16 v[148:151], a[252:255], a[172:175], v[148:151]
  v_xor_b32 v234, 0x10000, v234
  v_xor_b32 v235, 0x10000, v235
  v_mfma_f32_16x16x32_bf16 v[32:35], v[112:115], v[164:167], v[32:35]
  v_exp_f32 v144, v144
  v_mfma_f32_16x16x32_bf16 v[36:39], v[116:119], v[164:167], v[36:39]
  s_waitcnt vmcnt(3)
  buffer_load_dwordx4 v241, s[12:15], s26 offen offset:3072 nt lds
  v_mfma_f32_16x16x32_bf16 v[40:43], v[120:123], v[164:167], v[40:43]
  v_exp_f32 v145, v145
  v_mfma_f32_16x16x32_bf16 v[44:47], v[124:127], v[164:167], v[44:47]
  v_cvt_pk_bf16_f32 v160, v144, v145
  v_mfma_f32_16x16x32_bf16 a[32:35], v[128:131], v[164:167], a[32:35]
  v_exp_f32 v146, v146
  v_mfma_f32_16x16x32_bf16 a[36:39], v[132:135], v[164:167], a[36:39]
  v_mfma_f32_16x16x32_bf16 a[40:43], v[136:139], v[164:167], a[40:43]
  v_exp_f32 v147, v147
  v_mfma_f32_16x16x32_bf16 a[44:47], v[140:143], v[164:167], a[44:47]
  v_cvt_pk_bf16_f32 v161, v146, v147
  v_mfma_f32_16x16x32_bf16 v[204:207], v[224:227], v[164:167], v[204:207]
  v_exp_f32 v148, v148
  v_mfma_f32_16x16x32_bf16 v[152:155], a[224:227], a[176:179], v[184:187]
  v_mfma_f32_16x16x32_bf16 v[152:155], a[228:231], a[180:183], v[152:155]
  v_exp_f32 v149, v149
  v_mfma_f32_16x16x32_bf16 v[152:155], a[232:235], a[184:187], v[152:155]
  v_cvt_pk_bf16_f32 v162, v148, v149
  v_mfma_f32_16x16x32_bf16 v[152:155], a[236:239], a[188:191], v[152:155]
  v_exp_f32 v150, v150
  v_mfma_f32_16x16x32_bf16 v[156:159], a[240:243], a[176:179], v[184:187]
  v_exp_f32 v151, v151
  v_mfma_f32_16x16x32_bf16 v[156:159], a[244:247], a[180:183], v[156:159]
  v_cvt_pk_bf16_f32 v163, v150, v151
  v_mfma_f32_16x16x32_bf16 v[156:159], a[248:251], a[184:187], v[156:159]
  s_waitcnt vmcnt(2)
  s_add_u32 m0, m0, 4096
  s_add_u32 s27, s27, 0x8000
  buffer_load_dwordx4 v240, s[12:15], s29 offen offset:0 nt lds
  v_mfma_f32_16x16x32_bf16 v[156:159], a[252:255], a[188:191], v[156:159]
  v_xor_b32 v236, 0x10000, v236
  v_xor_b32 v237, 0x10000, v237
  v_mfma_f32_16x16x32_bf16 v[48:51], v[112:115], v[160:163], v[48:51]
  v_exp_f32 v152, v152
  v_mfma_f32_16x16x32_bf16 v[52:55], v[116:119], v[160:163], v[52:55]
  v_mfma_f32_16x16x32_bf16 v[56:59], v[120:123], v[160:163], v[56:59]
  v_exp_f32 v153, v153
  v_mfma_f32_16x16x32_bf16 v[60:63], v[124:127], v[160:163], v[60:63]
  v_cvt_pk_bf16_f32 v164, v152, v153
  v_mfma_f32_16x16x32_bf16 a[48:51], v[128:131], v[160:163], a[48:51]
  v_exp_f32 v154, v154
  v_mfma_f32_16x16x32_bf16 a[52:55], v[132:135], v[160:163], a[52:55]
  v_mfma_f32_16x16x32_bf16 a[56:59], v[136:139], v[160:163], a[56:59]
  v_exp_f32 v155, v155
  v_mfma_f32_16x16x32_bf16 a[60:63], v[140:143], v[160:163], a[60:63]
  v_cvt_pk_bf16_f32 v165, v154, v155
  v_mfma_f32_16x16x32_bf16 v[208:211], v[224:227], v[160:163], v[208:211]
  v_exp_f32 v156, v156
  v_mfma_f32_16x16x32_bf16 v[144:147], a[224:227], a[192:195], v[188:191]
  s_waitcnt vmcnt(2)
  buffer_load_dwordx4 v241, s[12:15], s29 offen offset:1024 nt lds
  v_mfma_f32_16x16x32_bf16 v[144:147], a[228:231], a[196:199], v[144:147]
  v_exp_f32 v157, v157
  v_mfma_f32_16x16x32_bf16 v[144:147], a[232:235], a[200:203], v[144:147]
  v_cvt_pk_bf16_f32 v166, v156, v157
  v_mfma_f32_16x16x32_bf16 v[144:147], a[236:239], a[204:207], v[144:147]
  v_exp_f32 v158, v158
  v_mfma_f32_16x16x32_bf16 v[148:151], a[240:243], a[192:195], v[188:191]
  v_exp_f32 v159, v159
  v_mfma_f32_16x16x32_bf16 v[148:151], a[244:247], a[196:199], v[148:151]
  v_cvt_pk_bf16_f32 v167, v158, v159
  v_mfma_f32_16x16x32_bf16 v[148:151], a[248:251], a[200:203], v[148:151]
  v_mfma_f32_16x16x32_bf16 v[148:151], a[252:255], a[204:207], v[148:151]
  v_xor_b32 v238, 0x10000, v238
  v_xor_b32 v239, 0x10000, v239
  v_mfma_f32_16x16x32_bf16 v[64:67], v[112:115], v[164:167], v[64:67]
  v_exp_f32 v144, v144
  v_mfma_f32_16x16x32_bf16 v[68:71], v[116:119], v[164:167], v[68:71]
  v_mfma_f32_16x16x32_bf16 v[72:75], v[120:123], v[164:167], v[72:75]
  v_exp_f32 v145, v145
  v_mfma_f32_16x16x32_bf16 v[76:79], v[124:127], v[164:167], v[76:79]
  v_cvt_pk_bf16_f32 v160, v144, v145
  v_mfma_f32_16x16x32_bf16 a[64:67], v[128:131], v[164:167], a[64:67]
  v_exp_f32 v146, v146
  v_mfma_f32_16x16x32_bf16 a[68:71], v[132:135], v[164:167], a[68:71]
  s_waitcnt vmcnt(2)
  buffer_load_dwordx4 v240, s[12:15], s29 offen offset:2048 nt lds
  v_mfma_f32_16x16x32_bf16 a[72:75], v[136:139], v[164:167], a[72:75]
  v_exp_f32 v147, v147
  v_mfma_f32_16x16x32_bf16 a[76:79], v[140:143], v[164:167], a[76:79]
  v_cvt_pk_bf16_f32 v161, v146, v147
  v_mfma_f32_16x16x32_bf16 v[212:215], v[224:227], v[164:167], v[212:215]
  v_exp_f32 v148, v148
  v_mfma_f32_16x16x32_bf16 v[152:155], a[224:227], a[208:211], v[192:195]
  v_mfma_f32_16x16x32_bf16 v[152:155], a[228:231], a[212:215], v[152:155]
  v_exp_f32 v149, v149
  v_mfma_f32_16x16x32_bf16 v[152:155], a[232:235], a[216:219], v[152:155]
  v_cvt_pk_bf16_f32 v162, v148, v149
  ds_read_b128 a[224:227], v228 offset:0
  v_mfma_f32_16x16x32_bf16 v[152:155], a[236:239], a[220:223], v[152:155]
  v_exp_f32 v150, v150
  v_mfma_f32_16x16x32_bf16 v[156:159], a[240:243], a[208:211], v[192:195]
  v_exp_f32 v151, v151
  v_mfma_f32_16x16x32_bf16 v[156:159], a[244:247], a[212:215], v[156:159]
  v_cvt_pk_bf16_f32 v163, v150, v151
  ds_read_b128 a[228:231], v229 offset:0
  v_mfma_f32_16x16x32_bf16 v[156:159], a[248:251], a[216:219], v[156:159]
  ds_read_b128 a[232:235], v230 offset:0
  ds_read_b128 a[236:239], v231 offset:0
  v_mfma_f32_16x16x32_bf16 v[156:159], a[252:255], a[220:223], v[156:159]
  ds_read_b128 a[240:243], v228 offset:4096
  ds_read_b128 a[244:247], v229 offset:4096
  v_mfma_f32_16x16x32_bf16 v[80:83], v[112:115], v[160:163], v[80:83]
  v_exp_f32 v152, v152
  v_mfma_f32_16x16x32_bf16 v[84:87], v[116:119], v[160:163], v[84:87]
  ds_read_b128 a[248:251], v230 offset:4096
  ds_read_b128 a[252:255], v231 offset:4096
  v_mfma_f32_16x16x32_bf16 v[88:91], v[120:123], v[160:163], v[88:91]
  v_exp_f32 v153, v153
  v_mfma_f32_16x16x32_bf16 v[92:95], v[124:127], v[160:163], v[92:95]
  v_cvt_pk_bf16_f32 v164, v152, v153
  v_mfma_f32_16x16x32_bf16 a[80:83], v[128:131], v[160:163], a[80:83]
  v_exp_f32 v154, v154
  v_mfma_f32_16x16x32_bf16 a[84:87], v[132:135], v[160:163], a[84:87]
  s_waitcnt vmcnt(3)
  buffer_load_dwordx4 v241, s[12:15], s29 offen offset:3072 nt lds
  s_add_u32 s26, s26, 8192
  s_and_b32 s27, s27, 0x1ffff
  v_mfma_f32_16x16x32_bf16 a[88:91], v[136:139], v[160:163], a[88:91]
  v_exp_f32 v155, v155
  v_mfma_f32_16x16x32_bf16 a[92:95], v[140:143], v[160:163], a[92:95]
  v_cvt_pk_bf16_f32 v165, v154, v155
  v_mfma_f32_16x16x32_bf16 v[216:219], v[224:227], v[160:163], v[216:219]
  v_exp_f32 v156, v156
  s_waitcnt lgkmcnt(0)
  v_mfma_f32_16x16x32_bf16 v[144:147], a[224:227], a[112:115], v[168:171]
  v_mfma_f32_16x16x32_bf16 v[144:147], a[228:231], a[116:119], v[144:147]
  v_exp_f32 v157, v157
  v_mfma_f32_16x16x32_bf16 v[144:147], a[232:235], a[120:123], v[144:147]
  v_cvt_pk_bf16_f32 v166, v156, v157
  v_mfma_f32_16x16x32_bf16 v[144:147], a[236:239], a[124:127], v[144:147]
  v_exp_f32 v158, v158
  v_mfma_f32_16x16x32_bf16 v[148:151], a[240:243], a[112:115], v[168:171]
  v_exp_f32 v159, v159
  v_mfma_f32_16x16x32_bf16 v[148:151], a[244:247], a[116:119], v[148:151]
  v_cvt_pk_bf16_f32 v167, v158, v159
  v_mfma_f32_16x16x32_bf16 v[148:151], a[248:251], a[120:123], v[148:151]
  v_mfma_f32_16x16x32_bf16 v[148:151], a[252:255], a[124:127], v[148:151]
L1_A_loop:
  s_waitcnt vmcnt(16)
  s_barrier
  v_mfma_f32_16x16x32_bf16 v[96:99], v[112:115], v[164:167], v[96:99]
  v_exp_f32 v144, v144
  ds_read_b64_tr_b16 v[112:113], v232 offset:0
  v_mfma_f32_16x16x32_bf16 v[100:103], v[116:119], v[164:167], v[100:103]
  ds_read_b64_tr_b16 v[114:115], v232 offset:4096
  v_mfma_f32_16x16x32_bf16 v[104:107], v[120:123], v[164:167], v[104:107]
  v_exp_f32 v145, v145
  ds_read_b64_tr_b16 v[116:117], v233 offset:0
  v_mfma_f32_16x16x32_bf16 v[108:111], v[124:127], v[164:167], v[108:111]
  v_cvt_pk_bf16_f32 v160, v144, v145
  ds_read_b64_tr_b16 v[118:119], v233 offset:4096
  v_mfma_f32_16x16x32_bf16 a[96:99], v[128:131], v[164:167], a[96:99]
  v_exp_f32 v146, v146
  ds_read_b64_tr_b16 v[120:121], v234 offset:0
  v_mfma_f32_16x16x32_bf16 a[100:103], v[132:135], v[164:167], a[100:103]
  ds_read_b64_tr_b16 v[122:123], v234 offset:4096
  v_mfma_f32_16x16x32_bf16 a[104:107], v[136:139], v[164:167], a[104:107]
  v_exp_f32 v147, v147
  ds_read_b64_tr_b16 v[124:125], v235 offset:0
  v_mfma_f32_16x16x32_bf16 a[108:111], v[140:143], v[164:167], a[108:111]
  v_cvt_pk_bf16_f32 v161, v146, v147
  ds_read_b64_tr_b16 v[126:127], v235 offset:4096
  v_mfma_f32_16x16x32_bf16 v[220:223], v[224:227], v[164:167], v[220:223]
  v_exp_f32 v148, v148
  ds_read_b64_tr_b16 v[128:129], v236 offset:0
  v_mfma_f32_16x16x32_bf16 v[152:155], a[224:227], a[128:131], v[172:175]
  ds_read_b64_tr_b16 v[130:131], v236 offset:4096
  v_mfma_f32_16x16x32_bf16 v[152:155], a[228:231], a[132:135], v[152:155]
  v_exp_f32 v149, v149
  ds_read_b64_tr_b16 v[132:133], v237 offset:0
  v_mfma_f32_16x16x32_bf16 v[152:155], a[232:235], a[136:139], v[152:155]
  v_cvt_pk_bf16_f32 v162, v148, v149
  ds_read_b64_tr_b16 v[134:135], v237 offset:4096
  v_mfma_f32_16x16x32_bf16 v[152:155], a[236:239], a[140:143], v[152:155]
  v_exp_f32 v150, v150
  ds_read_b64_tr_b16 v[136:137], v238 offset:0
  v_mfma_f32_16x16x32_bf16 v[156:159], a[240:243], a[128:131], v[172:175]
  v_exp_f32 v151, v151
  ds_read_b64_tr_b16 v[138:139], v238 offset:4096
  v_mfma_f32_16x16x32_bf16 v[156:159], a[244:247], a[132:135], v[156:159]
  v_cvt_pk_bf16_f32 v163, v150, v151
  ds_read_b64_tr_b16 v[140:141], v239 offset:0
  v_mfma_f32_16x16x32_bf16 v[156:159], a[248:251], a[136:139], v[156:159]
  ds_read_b64_tr_b16 v[142:143], v239 offset:4096
  v_mfma_f32_16x16x32_bf16 v[156:159], a[252:255], a[140:143], v[156:159]
  s_waitcnt vmcnt(2)
  s_cmp_lt_u32 s26, 0x20000
  s_cselect_b32 s14, 131072, 0
  s_add_u32 m0, s27, s28
  s_add_u32 s29, s26, 4096
  buffer_load_dwordx4 v240, s[12:15], s26 offen offset:0 nt lds
  s_waitcnt lgkmcnt(8)
  v_mfma_f32_16x16x32_bf16 v[0:3], v[112:115], v[160:163], v[0:3]
  v_exp_f32 v152, v152
  v_mfma_f32_16x16x32_bf16 v[4:7], v[116:119], v[160:163], v[4:7]
  v_mfma_f32_16x16x32_bf16 v[8:11], v[120:123], v[160:163], v[8:11]
  v_exp_f32 v153, v153
  v_mfma_f32_16x16x32_bf16 v[12:15], v[124:127], v[160:163], v[12:15]
  v_cvt_pk_bf16_f32 v164, v152, v153
  s_waitcnt lgkmcnt(0)
  v_mfma_f32_16x16x32_bf16 a[0:3], v[128:131], v[160:163], a[0:3]
  v_exp_f32 v154, v154
  v_mfma_f32_16x16x32_bf16 a[4:7], v[132:135], v[160:163], a[4:7]
  v_mfma_f32_16x16x32_bf16 a[8:11], v[136:139], v[160:163], a[8:11]
  v_exp_f32 v155, v155
  v_mfma_f32_16x16x32_bf16 a[12:15], v[140:143], v[160:163], a[12:15]
  v_cvt_pk_bf16_f32 v165, v154, v155
  v_mfma_f32_16x16x32_bf16 v[196:199], v[224:227], v[160:163], v[196:199]
  v_exp_f32 v156, v156
  v_mfma_f32_16x16x32_bf16 v[144:147], a[224:227], a[144:147], v[176:179]
  s_waitcnt vmcnt(2)
  buffer_load_dwordx4 v241, s[12:15], s26 offen offset:1024 nt lds
  v_mfma_f32_16x16x32_bf16 v[144:147], a[228:231], a[148:151], v[144:147]
  v_exp_f32 v157, v157
  v_mfma_f32_16x16x32_bf16 v[144:147], a[232:235], a[152:155], v[144:147]
  v_cvt_pk_bf16_f32 v166, v156, v157
  v_mfma_f32_16x16x32_bf16 v[144:147], a[236:239], a[156:159], v[144:147]
  v_exp_f32 v158, v158
  v_mfma_f32_16x16x32_bf16 v[148:151], a[240:243], a[144:147], v[176:179]
  v_exp_f32 v159, v159
  v_mfma_f32_16x16x32_bf16 v[148:151], a[244:247], a[148:151], v[148:151]
  v_cvt_pk_bf16_f32 v167, v158, v159
  v_mfma_f32_16x16x32_bf16 v[148:151], a[248:251], a[152:155], v[148:151]
  v_mfma_f32_16x16x32_bf16 v[148:151], a[252:255], a[156:159], v[148:151]
  v_mfma_f32_16x16x32_bf16 v[16:19], v[112:115], v[164:167], v[16:19]
  v_exp_f32 v144, v144
  v_mfma_f32_16x16x32_bf16 v[20:23], v[116:119], v[164:167], v[20:23]
  v_mfma_f32_16x16x32_bf16 v[24:27], v[120:123], v[164:167], v[24:27]
  v_exp_f32 v145, v145
  v_mfma_f32_16x16x32_bf16 v[28:31], v[124:127], v[164:167], v[28:31]
  v_cvt_pk_bf16_f32 v160, v144, v145
  v_mfma_f32_16x16x32_bf16 a[16:19], v[128:131], v[164:167], a[16:19]
  v_exp_f32 v146, v146
  v_mfma_f32_16x16x32_bf16 a[20:23], v[132:135], v[164:167], a[20:23]
  s_waitcnt vmcnt(2)
  buffer_load_dwordx4 v240, s[12:15], s26 offen offset:2048 nt lds
  v_mfma_f32_16x16x32_bf16 a[24:27], v[136:139], v[164:167], a[24:27]
  v_exp_f32 v147, v147
  v_mfma_f32_16x16x32_bf16 a[28:31], v[140:143], v[164:167], a[28:31]
  v_cvt_pk_bf16_f32 v161, v146, v147
  v_mfma_f32_16x16x32_bf16 v[200:203], v[224:227], v[164:167], v[200:203]
  v_exp_f32 v148, v148
  v_mfma_f32_16x16x32_bf16 v[152:155], a[224:227], a[160:163], v[180:183]
  v_mfma_f32_16x16x32_bf16 v[152:155], a[228:231], a[164:167], v[152:155]
  v_exp_f32 v149, v149
  v_mfma_f32_16x16x32_bf16 v[152:155], a[232:235], a[168:171], v[152:155]
  v_cvt_pk_bf16_f32 v162, v148, v149
  v_mfma_f32_16x16x32_bf16 v[152:155], a[236:239], a[172:175], v[152:155]
  v_exp_f32 v150, v150
  v_mfma_f32_16x16x32_bf16 v[156:159], a[240:243], a[160:163], v[180:183]
  v_exp_f32 v151, v151
  v_mfma_f32_16x16x32_bf16 v[156:159], a[244:247], a[164:167], v[156:159]
  v_cvt_pk_bf16_f32 v163, v150, v151
  v_mfma_f32_16x16x32_bf16 v[156:159], a[248:251], a[168:171], v[156:159]
  v_mfma_f32_16x16x32_bf16 v[156:159], a[252:255], a[172:175], v[156:159]
  v_mfma_f32_16x16x32_bf16 v[32:35], v[112:115], v[160:163], v[32:35]
  v_exp_f32 v152, v152
  v_mfma_f32_16x16x32_bf16 v[36:39], v[116:119], v[160:163], v[36:39]
  s_waitcnt vmcnt(3)
  buffer_load_dwordx4 v241, s[12:15], s26 offen offset:3072 nt lds
  v_mfma_f32_16x16x32_bf16 v[40:43], v[120:123], v[160:163], v[40:43]
  v_exp_f32 v153, v153
  v_mfma_f32_16x16x32_bf16 v[44:47], v[124:127], v[160:163], v[44:47]
  v_cvt_pk_bf16_f32 v164, v152, v153
  v_mfma_f32_16x16x32_bf16 a[32:35], v[128:131], v[160:163], a[32:35]
  v_exp_f32 v154, v154
  v_mfma_f32_16x16x32_bf16 a[36:39], v[132:135], v[160:163], a[36:39]
  v_mfma_f32_16x16x32_bf16 a[40:43], v[136:139], v[160:163], a[40:43]
  v_exp_f32 v155, v155
  v_mfma_f32_16x16x32_bf16 a[44:47], v[140:143], v[160:163], a[44:47]
  v_cvt_pk_bf16_f32 v165, v154, v155
  v_mfma_f32_16x16x32_bf16 v[204:207], v[224:227], v[160:163], v[204:207]
  v_exp_f32 v156, v156
  v_mfma_f32_16x16x32_bf16 v[144:147], a[224:227], a[176:179], v[184:187]
  v_mfma_f32_16x16x32_bf16 v[144:147], a[228:231], a[180:183], v[144:147]
  v_exp_f32 v157, v157
  v_mfma_f32_16x16x32_bf16 v[144:147], a[232:235], a[184:187], v[144:147]
  v_cvt_pk_bf16_f32 v166, v156, v157
  v_mfma_f32_16x16x32_bf16 v[144:147], a[236:239], a[188:191], v[144:147]
  v_exp_f32 v158, v158
  v_mfma_f32_16x16x32_bf16 v[148:151], a[240:243], a[176:179], v[184:187]
  v_exp_f32 v159, v159
  v_mfma_f32_16x16x32_bf16 v[148:151], a[244:247], a[180:183], v[148:151]
  v_cvt_pk_bf16_f32 v167, v158, v159
  v_mfma_f32_16x16x32_bf16 v[148:151], a[248:251], a[184:187], v[148:151]
  s_waitcnt vmcnt(2)
  s_add_u32 m0, m0, 4096
  s_add_u32 s27, s27, 0x8000
  buffer_load_dwordx4 v240, s[12:15], s29 offen offset:0 nt lds
  v_mfma_f32_16x16x32_bf16 v[148:151], a[252:255], a[188:191], v[148:151]
  v_mfma_f32_16x16x32_bf16 v[48:51], v[112:115], v[164:167], v[48:51]
  v_exp_f32 v144, v144
  v_mfma_f32_16x16x32_bf16 v[52:55], v[116:119], v[164:167], v[52:55]
  v_mfma_f32_16x16x32_bf16 v[56:59], v[120:123], v[164:167], v[56:59]
  v_exp_f32 v145, v145
  v_mfma_f32_16x16x32_bf16 v[60:63], v[124:127], v[164:167], v[60:63]
  v_cvt_pk_bf16_f32 v160, v144, v145
  v_mfma_f32_16x16x32_bf16 a[48:51], v[128:131], v[164:167], a[48:51]
  v_exp_f32 v146, v146
  v_mfma_f32_16x16x32_bf16 a[52:55], v[132:135], v[164:167], a[52:55]
  v_mfma_f32_16x16x32_bf16 a[56:59], v[136:139], v[164:167], a[56:59]
  v_exp_f32 v147, v147
  v_mfma_f32_16x16x32_bf16 a[60:63], v[140:143], v[164:167], a[60:63]
  v_cvt_pk_bf16_f32 v161, v146, v147
  v_mfma_f32_16x16x32_bf16 v[208:211], v[224:227], v[164:167], v[208:211]
  v_exp_f32 v148, v148
  v_mfma_f32_16x16x32_bf16 v[152:155], a[224:227], a[192:195], v[188:191]
  s_waitcnt vmcnt(2)
  buffer_load_dwordx4 v241, s[12:15], s29 offen offset:1024 nt lds
  v_mfma_f32_16x16x32_bf16 v[152:155], a[228:231], a[196:199], v[152:155]
  v_exp_f32 v149, v149
  v_mfma_f32_16x16x32_bf16 v[152:155], a[232:235], a[200:203], v[152:155]
  v_cvt_pk_bf16_f32 v162, v148, v149
  v_mfma_f32_16x16x32_bf16 v[152:155], a[236:239], a[204:207], v[152:155]
  v_exp_f32 v150, v150
  v_mfma_f32_16x16x32_bf16 v[156:159], a[240:243], a[192:195], v[188:191]
  v_exp_f32 v151, v151
  v_mfma_f32_16x16x32_bf16 v[156:159], a[244:247], a[196:199], v[156:159]
  v_cvt_pk_bf16_f32 v163, v150, v151
  v_mfma_f32_16x16x32_bf16 v[156:159], a[248:251], a[200:203], v[156:159]
  v_mfma_f32_16x16x32_bf16 v[156:159], a[252:255], a[204:207], v[156:159]
  v_mfma_f32_16x16x32_bf16 v[64:67], v[112:115], v[160:163], v[64:67]
  v_exp_f32 v152, v152
  v_mfma_f32_16x16x32_bf16 v[68:71], v[116:119], v[160:163], v[68:71]
  v_mfma_f32_16x16x32_bf16 v[72:75], v[120:123], v[160:163], v[72:75]
  v_exp_f32 v153, v153
  v_mfma_f32_16x16x32_bf16 v[76:79], v[124:127], v[160:163], v[76:79]
  v_cvt_pk_bf16_f32 v164, v152, v153
  v_mfma_f32_16x16x32_bf16 a[64:67], v[128:131], v[160:163], a[64:67]
  v_exp_f32 v154, v154
  v_mfma_f32_16x16x32_bf16 a[68:71], v[132:135], v[160:163], a[68:71]
  s_waitcnt vmcnt(2)
  buffer_load_dwordx4 v240, s[12:15], s29 offen offset:2048 nt lds
  v_mfma_f32_16x16x32_bf16 a[72:75], v[136:139], v[160:163], a[72:75]
  v_exp_f32 v155, v155
  v_mfma_f32_16x16x32_bf16 a[76:79], v[140:143], v[160:163], a[76:79]
  v_cvt_pk_bf16_f32 v165, v154, v155
  v_mfma_f32_16x16x32_bf16 v[212:215], v[224:227], v[160:163], v[212:215]
  v_exp_f32 v156, v156
  v_mfma_f32_16x16x32_bf16 v[144:147], a[224:227], a[208:211], v[192:195]
  v_mfma_f32_16x16x32_bf16 v[144:147], a[228:231], a[212:215], v[144:147]
  v_exp_f32 v157, v157
  v_mfma_f32_16x16x32_bf16 v[144:147], a[232:235], a[216:219], v[144:147]
  v_cvt_pk_bf16_f32 v166, v156, v157
  ds_read_b128 a[224:227], v228 offset:32768
  v_mfma_f32_16x16x32_bf16 v[144:147], a[236:239], a[220:223], v[144:147]
  v_exp_f32 v158, v158
  v_mfma_f32_16x16x32_bf16 v[148:151], a[240:243], a[208:211], v[192:195]
  v_exp_f32 v159, v159
  v_mfma_f32_16x16x32_bf16 v[148:151], a[244:247], a[212:215], v[148:151]
  v_cvt_pk_bf16_f32 v167, v158, v159
  ds_read_b128 a[228:231], v229 offset:32768
  v_mfma_f32_16x16x32_bf16 v[148:151], a[248:251], a[216:219], v[148:151]
  ds_read_b128 a[232:235], v230 offset:32768
  ds_read_b128 a[236:239], v231 offset:32768
  v_mfma_f32_16x16x32_bf16 v[148:151], a[252:255], a[220:223], v[148:151]
  ds_read_b128 a[240:243], v228 offset:36864
  ds_read_b128 a[244:247], v229 offset:36864
  v_mfma_f32_16x16x32_bf16 v[80:83], v[112:115], v[164:167], v[80:83]
  v_exp_f32 v144, v144
  v_mfma_f32_16x16x32_bf16 v[84:87], v[116:119], v[164:167], v[84:87]
  ds_read_b128 a[248:251], v230 offset:36864
  ds_read_b128 a[252:255], v231 offset:36864
  v_mfma_f32_16x16x32_bf16 v[88:91], v[120:123], v[164:167], v[88:91]
  v_exp_f32 v145, v145
  v_mfma_f32_16x16x32_bf16 v[92:95], v[124:127], v[164:167], v[92:95]
  v_cvt_pk_bf16_f32 v160, v144, v145
  v_mfma_f32_16x16x32_bf16 a[80:83], v[128:131], v[164:167], a[80:83]
  v_exp_f32 v146, v146
  v_mfma_f32_16x16x32_bf16 a[84:87], v[132:135], v[164:167], a[84:87]
  s_waitcnt vmcnt(3)
  buffer_load_dwordx4 v241, s[12:15], s29 offen offset:3072 nt lds
  s_add_u32 s26, s26, 8192
  s_and_b32 s27, s27, 0x1ffff
  v_mfma_f32_16x16x32_bf16 a[88:91], v[136:139], v[164:167], a[88:91]
  v_exp_f32 v147, v147
  v_mfma_f32_16x16x32_bf16 a[92:95], v[140:143], v[164:167], a[92:95]
  v_cvt_pk_bf16_f32 v161, v146, v147
  v_mfma_f32_16x16x32_bf16 v[216:219], v[224:227], v[164:167], v[216:219]
  v_exp_f32 v148, v148
  s_waitcnt lgkmcnt(0)
  v_mfma_f32_16x16x32_bf16 v[152:155], a[224:227], a[112:115], v[168:171]
  v_mfma_f32_16x16x32_bf16 v[152:155], a[228:231], a[116:119], v[152:155]
  v_exp_f32 v149, v149
  v_mfma_f32_16x16x32_bf16 v[152:155], a[232:235], a[120:123], v[152:155]
  v_cvt_pk_bf16_f32 v162, v148, v149
  v_mfma_f32_16x16x32_bf16 v[152:155], a[236:239], a[124:127], v[152:155]
  v_exp_f32 v150, v150
  v_mfma_f32_16x16x32_bf16 v[156:159], a[240:243], a[112:115], v[168:171]
  v_exp_f32 v151, v151
  v_mfma_f32_16x16x32_bf16 v[156:159], a[244:247], a[116:119], v[156:159]
  v_cvt_pk_bf16_f32 v163, v150, v151
  v_mfma_f32_16x16x32_bf16 v[156:159], a[248:251], a[120:123], v[156:159]
  v_xor_b32 v228, 0x10000, v228
  v_xor_b32 v229, 0x10000, v229
  v_mfma_f32_16x16x32_bf16 v[156:159], a[252:255], a[124:127], v[156:159]
  v_xor_b32 v230, 0x10000, v230
  v_xor_b32 v231, 0x10000, v231
  s_waitcnt vmcnt(16)
  s_barrier
  v_mfma_f32_16x16x32_bf16 v[96:99], v[112:115], v[160:163], v[96:99]
  v_exp_f32 v152, v152
  ds_read_b64_tr_b16 v[112:113], v232 offset:32768
  v_mfma_f32_16x16x32_bf16 v[100:103], v[116:119], v[160:163], v[100:103]
  ds_read_b64_tr_b16 v[114:115], v232 offset:36864
  v_mfma_f32_16x16x32_bf16 v[104:107], v[120:123], v[160:163], v[104:107]
  v_exp_f32 v153, v153
  ds_read_b64_tr_b16 v[116:117], v233 offset:32768
  v_mfma_f32_16x16x32_bf16 v[108:111], v[124:127], v[160:163], v[108:111]
  v_cvt_pk_bf16_f32 v164, v152, v153
  ds_read_b64_tr_b16 v[118:119], v233 offset:36864
  v_mfma_f32_16x16x32_bf16 a[96:99], v[128:131], v[160:163], a[96:99]
  v_exp_f32 v154, v154
  ds_read_b64_tr_b16 v[120:121], v234 offset:32768
  v_mfma_f32_16x16x32_bf16 a[100:103], v[132:135], v[160:163], a[100:103]
  ds_read_b64_tr_b16 v[122:123], v234 offset:36864
  v_mfma_f32_16x16x32_bf16 a[104:107], v[136:139], v[160:163], a[104:107]
  v_exp_f32 v155, v155
  ds_read_b64_tr_b16 v[124:125], v235 offset:32768
  v_mfma_f32_16x16x32_bf16 a[108:111], v[140:143], v[160:163], a[108:111]
  v_cvt_pk_bf16_f32 v165, v154, v155
  ds_read_b64_tr_b16 v[126:127], v235 offset:36864
  v_mfma_f32_16x16x32_bf16 v[220:223], v[224:227], v[160:163], v[220:223]
  v_exp_f32 v156, v156
  ds_read_b64_tr_b16 v[128:129], v236 offset:32768
  v_mfma_f32_16x16x32_bf16 v[144:147], a[224:227], a[128:131], v[172:175]
  ds_read_b64_tr_b16 v[130:131], v236 offset:36864
  v_mfma_f32_16x16x32_bf16 v[144:147], a[228:231], a[132:135], v[144:147]
  v_exp_f32 v157, v157
  ds_read_b64_tr_b16 v[132:133], v237 offset:32768
  v_mfma_f32_16x16x32_bf16 v[144:147], a[232:235], a[136:139], v[144:147]
  v_cvt_pk_bf16_f32 v166, v156, v157
  ds_read_b64_tr_b16 v[134:135], v237 offset:36864
  v_mfma_f32_16x16x32_bf16 v[144:147], a[236:239], a[140:143], v[144:147]
  v_exp_f32 v158, v158
  ds_read_b64_tr_b16 v[136:137], v238 offset:32768
  v_mfma_f32_16x16x32_bf16 v[148:151], a[240:243], a[128:131], v[172:175]
  v_exp_f32 v159, v159
  ds_read_b64_tr_b16 v[138:139], v238 offset:36864
  v_mfma_f32_16x16x32_bf16 v[148:151], a[244:247], a[132:135], v[148:151]
  v_cvt_pk_bf16_f32 v167, v158, v159
  ds_read_b64_tr_b16 v[140:141], v239 offset:32768
  v_mfma_f32_16x16x32_bf16 v[148:151], a[248:251], a[136:139], v[148:151]
  ds_read_b64_tr_b16 v[142:143], v239 offset:36864
  v_mfma_f32_16x16x32_bf16 v[148:151], a[252:255], a[140:143], v[148:151]
  s_waitcnt vmcnt(2)
  s_cmp_lt_u32 s26, 0x20000
  s_cselect_b32 s14, 131072, 0
  s_add_u32 m0, s27, s28
  s_add_u32 s29, s26, 4096
  buffer_load_dwordx4 v240, s[12:15], s26 offen offset:0 nt lds
  s_waitcnt lgkmcnt(8)
  v_mfma_f32_16x16x32_bf16 v[0:3], v[112:115], v[164:167], v[0:3]
  v_exp_f32 v144, v144
  v_mfma_f32_16x16x32_bf16 v[4:7], v[116:119], v[164:167], v[4:7]
  v_mfma_f32_16x16x32_bf16 v[8:11], v[120:123], v[164:167], v[8:11]
  v_exp_f32 v145, v145
  v_mfma_f32_16x16x32_bf16 v[12:15], v[124:127], v[164:167], v[12:15]
  v_cvt_pk_bf16_f32 v160, v144, v145
  s_waitcnt lgkmcnt(0)
  v_mfma_f32_16x16x32_bf16 a[0:3], v[128:131], v[164:167], a[0:3]
  v_exp_f32 v146, v146
  v_mfma_f32_16x16x32_bf16 a[4:7], v[132:135], v[164:167], a[4:7]
  v_mfma_f32_16x16x32_bf16 a[8:11], v[136:139], v[164:167], a[8:11]
  v_exp_f32 v147, v147
  v_mfma_f32_16x16x32_bf16 a[12:15], v[140:143], v[164:167], a[12:15]
  v_cvt_pk_bf16_f32 v161, v146, v147
  v_mfma_f32_16x16x32_bf16 v[196:199], v[224:227], v[164:167], v[196:199]
  v_exp_f32 v148, v148
  v_mfma_f32_16x16x32_bf16 v[152:155], a[224:227], a[144:147], v[176:179]
  s_waitcnt vmcnt(2)
  buffer_load_dwordx4 v241, s[12:15], s26 offen offset:1024 nt lds
  v_mfma_f32_16x16x32_bf16 v[152:155], a[228:231], a[148:151], v[152:155]
  v_exp_f32 v149, v149
  v_mfma_f32_16x16x32_bf16 v[152:155], a[232:235], a[152:155], v[152:155]
  v_cvt_pk_bf16_f32 v162, v148, v149
  v_mfma_f32_16x16x32_bf16 v[152:155], a[236:239], a[156:159], v[152:155]
  v_exp_f32 v150, v150
  v_mfma_f32_16x16x32_bf16 v[156:159], a[240:243], a[144:147], v[176:179]
  v_exp_f32 v151, v151
  v_mfma_f32_16x16x32_bf16 v[156:159], a[244:247], a[148:151], v[156:159]
  v_cvt_pk_bf16_f32 v163, v150, v151
  v_mfma_f32_16x16x32_bf16 v[156:159], a[248:251], a[152:155], v[156:159]
  v_mfma_f32_16x16x32_bf16 v[156:159], a[252:255], a[156:159], v[156:159]
  v_xor_b32 v232, 0x10000, v232
  v_xor_b32 v233, 0x10000, v233
  v_mfma_f32_16x16x32_bf16 v[16:19], v[112:115], v[160:163], v[16:19]
  v_exp_f32 v152, v152
  v_mfma_f32_16x16x32_bf16 v[20:23], v[116:119], v[160:163], v[20:23]
  v_mfma_f32_16x16x32_bf16 v[24:27], v[120:123], v[160:163], v[24:27]
  v_exp_f32 v153, v153
  v_mfma_f32_16x16x32_bf16 v[28:31], v[124:127], v[160:163], v[28:31]
  v_cvt_pk_bf16_f32 v164, v152, v153
  v_mfma_f32_16x16x32_bf16 a[16:19], v[128:131], v[160:163], a[16:19]
  v_exp_f32 v154, v154
  v_mfma_f32_16x16x32_bf16 a[20:23], v[132:135], v[160:163], a[20:23]
  s_waitcnt vmcnt(2)
  buffer_load_dwordx4 v240, s[12:15], s26 offen offset:2048 nt lds
  v_mfma_f32_16x16x32_bf16 a[24:27], v[136:139], v[160:163], a[24:27]
  v_exp_f32 v155, v155
  v_mfma_f32_16x16x32_bf16 a[28:31], v[140:143], v[160:163], a[28:31]
  v_cvt_pk_bf16_f32 v165, v154, v155
  v_mfma_f32_16x16x32_bf16 v[200:203], v[224:227], v[160:163], v[200:203]
  v_exp_f32 v156, v156
  v_mfma_f32_16x16x32_bf16 v[144:147], a[224:227], a[160:163], v[180:183]
  v_mfma_f32_16x16x32_bf16 v[144:147], a[228:231], a[164:167], v[144:147]
  v_exp_f32 v157, v157
  v_mfma_f32_16x16x32_bf16 v[144:147], a[232:235], a[168:171], v[144:147]
  v_cvt_pk_bf16_f32 v166, v156, v157
  v_mfma_f32_16x16x32_bf16 v[144:147], a[236:239], a[172:175], v[144:147]
  v_exp_f32 v158, v158
  v_mfma_f32_16x16x32_bf16 v[148:151], a[240:243], a[160:163], v[180:183]
  v_exp_f32 v159, v159
  v_mfma_f32_16x16x32_bf16 v[148:151], a[244:247], a[164:167], v[148:151]
  v_cvt_pk_bf16_f32 v167, v158, v159
  v_mfma_f32_16x16x32_bf16 v[148:151], a[248:251], a[168:171], v[148:151]
  v_mfma_f32_16x16x32_bf16 v[148:151], a[252:255], a[172:175], v[148:151]
  v_xor_b32 v234, 0x10000, v234
  v_xor_b32 v235, 0x10000, v235
  v_mfma_f32_16x16x32_bf16 v[32:35], v[112:115], v[164:167], v[32:35]
  v_exp_f32 v144, v144
  v_mfma_f32_16x16x32_bf16 v[36:39], v[116:119], v[164:167], v[36:39]
  s_waitcnt vmcnt(3)
  buffer_load_dwordx4 v241, s[12:15], s26 offen offset:3072 nt lds
  v_mfma_f32_16x16x32_bf16 v[40:43], v[120:123], v[164:167], v[40:43]
  v_exp_f32 v145, v145
  v_mfma_f32_16x16x32_bf16 v[44:47], v[124:127], v[164:167], v[44:47]
  v_cvt_pk_bf16_f32 v160, v144, v145
  v_mfma_f32_16x16x32_bf16 a[32:35], v[128:131], v[164:167], a[32:35]
  v_exp_f32 v146, v146
  v_mfma_f32_16x16x32_bf16 a[36:39], v[132:135], v[164:167], a[36:39]
  v_mfma_f32_16x16x32_bf16 a[40:43], v[136:139], v[164:167], a[40:43]
  v_exp_f32 v147, v147
  v_mfma_f32_16x16x32_bf16 a[44:47], v[140:143], v[164:167], a[44:47]
  v_cvt_pk_bf16_f32 v161, v146, v147
  v_mfma_f32_16x16x32_bf16 v[204:207], v[224:227], v[164:167], v[204:207]
  v_exp_f32 v148, v148
  v_mfma_f32_16x16x32_bf16 v[152:155], a[224:227], a[176:179], v[184:187]
  v_mfma_f32_16x16x32_bf16 v[152:155], a[228:231], a[180:183], v[152:155]
  v_exp_f32 v149, v149
  v_mfma_f32_16x16x32_bf16 v[152:155], a[232:235], a[184:187], v[152:155]
  v_cvt_pk_bf16_f32 v162, v148, v149
  v_mfma_f32_16x16x32_bf16 v[152:155], a[236:239], a[188:191], v[152:155]
  v_exp_f32 v150, v150
  v_mfma_f32_16x16x32_bf16 v[156:159], a[240:243], a[176:179], v[184:187]
  v_exp_f32 v151, v151
  v_mfma_f32_16x16x32_bf16 v[156:159], a[244:247], a[180:183], v[156:159]
  v_cvt_pk_bf16_f32 v163, v150, v151
  v_mfma_f32_16x16x32_bf16 v[156:159], a[248:251], a[184:187], v[156:159]
  s_waitcnt vmcnt(2)
  s_add_u32 m0, m0, 4096
  s_add_u32 s27, s27, 0x8000
  buffer_load_dwordx4 v240, s[12:15], s29 offen offset:0 nt lds
  v_mfma_f32_16x16x32_bf16 v[156:159], a[252:255], a[188:191], v[156:159]
  v_xor_b32 v236, 0x10000, v236
  v_xor_b32 v237, 0x10000, v237
  v_mfma_f32_16x16x32_bf16 v[48:51], v[112:115], v[160:163], v[48:51]
  v_exp_f32 v152, v152
  v_mfma_f32_16x16x32_bf16 v[52:55], v[116:119], v[160:163], v[52:55]
  v_mfma_f32_16x16x32_bf16 v[56:59], v[120:123], v[160:163], v[56:59]
  v_exp_f32 v153, v153
  v_mfma_f32_16x16x32_bf16 v[60:63], v[124:127], v[160:163], v[60:63]
  v_cvt_pk_bf16_f32 v164, v152, v153
  v_mfma_f32_16x16x32_bf16 a[48:51], v[128:131], v[160:163], a[48:51]
  v_exp_f32 v154, v154
  v_mfma_f32_16x16x32_bf16 a[52:55], v[132:135], v[160:163], a[52:55]
  v_mfma_f32_16x16x32_bf16 a[56:59], v[136:139], v[160:163], a[56:59]
  v_exp_f32 v155, v155
  v_mfma_f32_16x16x32_bf16 a[60:63], v[140:143], v[160:163], a[60:63]
  v_cvt_pk_bf16_f32 v165, v154, v155
  v_mfma_f32_16x16x32_bf16 v[208:211], v[224:227], v[160:163], v[208:211]
  v_exp_f32 v156, v156
  v_mfma_f32_16x16x32_bf16 v[144:147], a[224:227], a[192:195], v[188:191]
  s_waitcnt vmcnt(2)
  buffer_load_dwordx4 v241, s[12:15], s29 offen offset:1024 nt lds
  v_mfma_f32_16x16x32_bf16 v[144:147], a[228:231], a[196:199], v[144:147]
  v_exp_f32 v157, v157
  v_mfma_f32_16x16x32_bf16 v[144:147], a[232:235], a[200:203], v[144:147]
  v_cvt_pk_bf16_f32 v166, v156, v157
  v_mfma_f32_16x16x32_bf16 v[144:147], a[236:239], a[204:207], v[144:147]
  v_exp_f32 v158, v158
  v_mfma_f32_16x16x32_bf16 v[148:151], a[240:243], a[192:195], v[188:191]
  v_exp_f32 v159, v159
  v_mfma_f32_16x16x32_bf16 v[148:151], a[244:247], a[196:199], v[148:151]
  v_cvt_pk_bf16_f32 v167, v158, v159
  v_mfma_f32_16x16x32_bf16 v[148:151], a[248:251], a[200:203], v[148:151]
  v_mfma_f32_16x16x32_bf16 v[148:151], a[252:255], a[204:207], v[148:151]
  v_xor_b32 v238, 0x10000, v238
  v_xor_b32 v239, 0x10000, v239
  v_mfma_f32_16x16x32_bf16 v[64:67], v[112:115], v[164:167], v[64:67]
  v_exp_f32 v144, v144
  v_mfma_f32_16x16x32_bf16 v[68:71], v[116:119], v[164:167], v[68:71]
  v_mfma_f32_16x16x32_bf16 v[72:75], v[120:123], v[164:167], v[72:75]
  v_exp_f32 v145, v145
  v_mfma_f32_16x16x32_bf16 v[76:79], v[124:127], v[164:167], v[76:79]
  v_cvt_pk_bf16_f32 v160, v144, v145
  v_mfma_f32_16x16x32_bf16 a[64:67], v[128:131], v[164:167], a[64:67]
  v_exp_f32 v146, v146
  v_mfma_f32_16x16x32_bf16 a[68:71], v[132:135], v[164:167], a[68:71]
  s_waitcnt vmcnt(2)
  buffer_load_dwordx4 v240, s[12:15], s29 offen offset:2048 nt lds
  v_mfma_f32_16x16x32_bf16 a[72:75], v[136:139], v[164:167], a[72:75]
  v_exp_f32 v147, v147
  v_mfma_f32_16x16x32_bf16 a[76:79], v[140:143], v[164:167], a[76:79]
  v_cvt_pk_bf16_f32 v161, v146, v147
  v_mfma_f32_16x16x32_bf16 v[212:215], v[224:227], v[164:167], v[212:215]
  v_exp_f32 v148, v148
  v_mfma_f32_16x16x32_bf16 v[152:155], a[224:227], a[208:211], v[192:195]
  v_mfma_f32_16x16x32_bf16 v[152:155], a[228:231], a[212:215], v[152:155]
  v_exp_f32 v149, v149
  v_mfma_f32_16x16x32_bf16 v[152:155], a[232:235], a[216:219], v[152:155]
  v_cvt_pk_bf16_f32 v162, v148, v149
  ds_read_b128 a[224:227], v228 offset:0
  v_mfma_f32_16x16x32_bf16 v[152:155], a[236:239], a[220:223], v[152:155]
  v_exp_f32 v150, v150
  v_mfma_f32_16x16x32_bf16 v[156:159], a[240:243], a[208:211], v[192:195]
  v_exp_f32 v151, v151
  v_mfma_f32_16x16x32_bf16 v[156:159], a[244:247], a[212:215], v[156:159]
  v_cvt_pk_bf16_f32 v163, v150, v151
  ds_read_b128 a[228:231], v229 offset:0
  v_mfma_f32_16x16x32_bf16 v[156:159], a[248:251], a[216:219], v[156:159]
  ds_read_b128 a[232:235], v230 offset:0
  ds_read_b128 a[236:239], v231 offset:0
  v_mfma_f32_16x16x32_bf16 v[156:159], a[252:255], a[220:223], v[156:159]
  ds_read_b128 a[240:243], v228 offset:4096
  ds_read_b128 a[244:247], v229 offset:4096
  v_mfma_f32_16x16x32_bf16 v[80:83], v[112:115], v[160:163], v[80:83]
  v_exp_f32 v152, v152
  v_mfma_f32_16x16x32_bf16 v[84:87], v[116:119], v[160:163], v[84:87]
  ds_read_b128 a[248:251], v230 offset:4096
  ds_read_b128 a[252:255], v231 offset:4096
  v_mfma_f32_16x16x32_bf16 v[88:91], v[120:123], v[160:163], v[88:91]
  v_exp_f32 v153, v153
  v_mfma_f32_16x16x32_bf16 v[92:95], v[124:127], v[160:163], v[92:95]
  v_cvt_pk_bf16_f32 v164, v152, v153
  v_mfma_f32_16x16x32_bf16 a[80:83], v[128:131], v[160:163], a[80:83]
  v_exp_f32 v154, v154
  v_mfma_f32_16x16x32_bf16 a[84:87], v[132:135], v[160:163], a[84:87]
  s_waitcnt vmcnt(3)
  buffer_load_dwordx4 v241, s[12:15], s29 offen offset:3072 nt lds
  s_add_u32 s26, s26, 8192
  s_and_b32 s27, s27, 0x1ffff
  v_mfma_f32_16x16x32_bf16 a[88:91], v[136:139], v[160:163], a[88:91]
  v_exp_f32 v155, v155
  v_mfma_f32_16x16x32_bf16 a[92:95], v[140:143], v[160:163], a[92:95]
  v_cvt_pk_bf16_f32 v165, v154, v155
  v_mfma_f32_16x16x32_bf16 v[216:219], v[224:227], v[160:163], v[216:219]
  v_exp_f32 v156, v156
  s_waitcnt lgkmcnt(0)
  v_mfma_f32_16x16x32_bf16 v[144:147], a[224:227], a[112:115], v[168:171]
  v_mfma_f32_16x16x32_bf16 v[144:147], a[228:231], a[116:119], v[144:147]
  v_exp_f32 v157, v157
  v_mfma_f32_16x16x32_bf16 v[144:147], a[232:235], a[120:123], v[144:147]
  v_cvt_pk_bf16_f32 v166, v156, v157
  v_mfma_f32_16x16x32_bf16 v[144:147], a[236:239], a[124:127], v[144:147]
  v_exp_f32 v158, v158
  v_mfma_f32_16x16x32_bf16 v[148:151], a[240:243], a[112:115], v[168:171]
  v_exp_f32 v159, v159
  v_mfma_f32_16x16x32_bf16 v[148:151], a[244:247], a[116:119], v[148:151]
  v_cvt_pk_bf16_f32 v167, v158, v159
  v_mfma_f32_16x16x32_bf16 v[148:151], a[248:251], a[120:123], v[148:151]
  v_mfma_f32_16x16x32_bf16 v[148:151], a[252:255], a[124:127], v[148:151]
  s_sub_u32 s30, s30, 1
  s_cmp_lg_u32 s30, 0
  s_cbranch_scc1 L1_A_loop
LP_A_s14:
  s_waitcnt vmcnt(16)
  s_barrier
  v_mfma_f32_16x16x32_bf16 v[96:99], v[112:115], v[164:167], v[96:99]
  v_exp_f32 v144, v144
  ds_read_b64_tr_b16 v[112:113], v232 offset:0
  v_mfma_f32_16x16x32_bf16 v[100:103], v[116:119], v[164:167], v[100:103]
  ds_read_b64_tr_b16 v[114:115], v232 offset:4096
  v_mfma_f32_16x16x32_bf16 v[104:107], v[120:123], v[164:167], v[104:107]
  v_exp_f32 v145, v145
  ds_read_b64_tr_b16 v[116:117], v233 offset:0
  v_mfma_f32_16x16x32_bf16 v[108:111], v[124:127], v[164:167], v[108:111]
  v_cvt_pk_bf16_f32 v160, v144, v145
  ds_read_b64_tr_b16 v[118:119], v233 offset:4096
  v_mfma_f32_16x16x32_bf16 a[96:99], v[128:131], v[164:167], a[96:99]
  v_exp_f32 v146, v146
  ds_read_b64_tr_b16 v[120:121], v234 offset:0
  v_mfma_f32_16x16x32_bf16 a[100:103], v[132:135], v[164:167], a[100:103]
  ds_read_b64_tr_b16 v[122:123], v234 offset:4096
  v_mfma_f32_16x16x32_bf16 a[104:107], v[136:139], v[164:167], a[104:107]
  v_exp_f32 v147, v147
  ds_read_b64_tr_b16 v[124:125], v235 offset:0
  v_mfma_f32_16x16x32_bf16 a[108:111], v[140:143], v[164:167], a[108:111]
  v_cvt_pk_bf16_f32 v161, v146, v147
  ds_read_b64_tr_b16 v[126:127], v235 offset:4096
  v_mfma_f32_16x16x32_bf16 v[220:223], v[224:227], v[164:167], v[220:223]
  v_exp_f32 v148, v148
  ds_read_b64_tr_b16 v[128:129], v236 offset:0
  v_mfma_f32_16x16x32_bf16 v[152:155], a[224:227], a[128:131], v[172:175]
  ds_read_b64_tr_b16 v[130:131], v236 offset:4096
  v_mfma_f32_16x16x32_bf16 v[152:155], a[228:231], a[132:135], v[152:155]
  v_exp_f32 v149, v149
  ds_read_b64_tr_b16 v[132:133], v237 offset:0
  v_mfma_f32_16x16x32_bf16 v[152:155], a[232:235], a[136:139], v[152:155]
  v_cvt_pk_bf16_f32 v162, v148, v149
  ds_read_b64_tr_b16 v[134:135], v237 offset:4096
  v_mfma_f32_16x16x32_bf16 v[152:155], a[236:239], a[140:143], v[152:155]
  v_exp_f32 v150, v150
  ds_read_b64_tr_b16 v[136:137], v238 offset:0
  v_mfma_f32_16x16x32_bf16 v[156:159], a[240:243], a[128:131], v[172:175]
  v_exp_f32 v151, v151
  ds_read_b64_tr_b16 v[138:139], v238 offset:4096
  v_mfma_f32_16x16x32_bf16 v[156:159], a[244:247], a[132:135], v[156:159]
  v_cvt_pk_bf16_f32 v163, v150, v151
  ds_read_b64_tr_b16 v[140:141], v239 offset:0
  v_mfma_f32_16x16x32_bf16 v[156:159], a[248:251], a[136:139], v[156:159]
  ds_read_b64_tr_b16 v[142:143], v239 offset:4096
  v_mfma_f32_16x16x32_bf16 v[156:159], a[252:255], a[140:143], v[156:159]
  buffer_load_dword v248, off, s[80:83], 0 sc1
  v_lshlrev_b32 v249, 7, v242
  s_waitcnt lgkmcnt(8)
  v_mfma_f32_16x16x32_bf16 v[0:3], v[112:115], v[160:163], v[0:3]
  v_exp_f32 v152, v152
  v_mfma_f32_16x16x32_bf16 v[4:7], v[116:119], v[160:163], v[4:7]
  v_add_u32 v244, s59, v243
  v_mfma_f32_16x16x32_bf16 v[8:11], v[120:123], v[160:163], v[8:11]
  v_exp_f32 v153, v153
  v_mfma_f32_16x16x32_bf16 v[12:15], v[124:127], v[160:163], v[12:15]
  v_cvt_pk_bf16_f32 v164, v152, v153
  s_waitcnt lgkmcnt(0)
  v_mfma_f32_16x16x32_bf16 a[0:3], v[128:131], v[160:163], a[0:3]
  v_exp_f32 v154, v154
  v_mfma_f32_16x16x32_bf16 a[4:7], v[132:135], v[160:163], a[4:7]
  v_mfma_f32_16x16x32_bf16 a[8:11], v[136:139], v[160:163], a[8:11]
  v_exp_f32 v155, v155
  v_mfma_f32_16x16x32_bf16 a[12:15], v[140:143], v[160:163], a[12:15]
  v_cvt_pk_bf16_f32 v165, v154, v155
  v_mfma_f32_16x16x32_bf16 v[196:199], v[224:227], v[160:163], v[196:199]
  v_exp_f32 v156, v156
  v_mfma_f32_16x16x32_bf16 v[144:147], a[224:227], a[144:147], v[176:179]
  v_mfma_f32_16x16x32_bf16 v[144:147], a[228:231], a[148:151], v[144:147]
  v_exp_f32 v157, v157
  v_mfma_f32_16x16x32_bf16 v[144:147], a[232:235], a[152:155], v[144:147]
  v_cvt_pk_bf16_f32 v166, v156, v157
  v_mfma_f32_16x16x32_bf16 v[144:147], a[236:239], a[156:159], v[144:147]
  v_exp_f32 v158, v158
  v_mfma_f32_16x16x32_bf16 v[148:151], a[240:243], a[144:147], v[176:179]
  v_exp_f32 v159, v159
  v_mfma_f32_16x16x32_bf16 v[148:151], a[244:247], a[148:151], v[148:151]
  v_cvt_pk_bf16_f32 v167, v158, v159
  v_mfma_f32_16x16x32_bf16 v[148:151], a[248:251], a[152:155], v[148:151]
  v_mfma_f32_16x16x32_bf16 v[148:151], a[252:255], a[156:159], v[148:151]
  v_mfma_f32_16x16x32_bf16 v[16:19], v[112:115], v[164:167], v[16:19]
  v_exp_f32 v144, v144
  v_mfma_f32_16x16x32_bf16 v[20:23], v[116:119], v[164:167], v[20:23]
  v_add_u32 v245, 0x10000, v244
  v_mfma_f32_16x16x32_bf16 v[24:27], v[120:123], v[164:167], v[24:27]
  v_exp_f32 v145, v145
  v_mfma_f32_16x16x32_bf16 v[28:31], v[124:127], v[164:167], v[28:31]
  v_cvt_pk_bf16_f32 v160, v144, v145
  v_mfma_f32_16x16x32_bf16 a[16:19], v[128:131], v[164:167], a[16:19]
  v_exp_f32 v146, v146
  v_mfma_f32_16x16x32_bf16 a[20:23], v[132:135], v[164:167], a[20:23]
  v_mfma_f32_16x16x32_bf16 a[24:27], v[136:139], v[164:167], a[24:27]
  v_exp_f32 v147, v147
  v_mfma_f32_16x16x32_bf16 a[28:31], v[140:143], v[164:167], a[28:31]
  v_cvt_pk_bf16_f32 v161, v146, v147
  v_mfma_f32_16x16x32_bf16 v[200:203], v[224:227], v[164:167], v[200:203]
  v_exp_f32 v148, v148
  v_mfma_f32_16x16x32_bf16 v[152:155], a[224:227], a[160:163], v[180:183]
  v_mfma_f32_16x16x32_bf16 v[152:155], a[228:231], a[164:167], v[152:155]
  v_exp_f32 v149, v149
  v_mfma_f32_16x16x32_bf16 v[152:155], a[232:235], a[168:171], v[152:155]
  v_cvt_pk_bf16_f32 v162, v148, v149
  v_mfma_f32_16x16x32_bf16 v[152:155], a[236:239], a[172:175], v[152:155]
  v_exp_f32 v150, v150
  v_mfma_f32_16x16x32_bf16 v[156:159], a[240:243], a[160:163], v[180:183]
  v_exp_f32 v151, v151
  v_mfma_f32_16x16x32_bf16 v[156:159], a[244:247], a[164:167], v[156:159]
  v_cvt_pk_bf16_f32 v163, v150, v151
  v_mfma_f32_16x16x32_bf16 v[156:159], a[248:251], a[168:171], v[156:159]
  v_mfma_f32_16x16x32_bf16 v[156:159], a[252:255], a[172:175], v[156:159]
  v_mfma_f32_16x16x32_bf16 v[32:35], v[112:115], v[160:163], v[32:35]
  v_exp_f32 v152, v152
  v_mfma_f32_16x16x32_bf16 v[36:39], v[116:119], v[160:163], v[36:39]
  v_xor_b32 v246, 0x4000, v244
  v_mfma_f32_16x16x32_bf16 v[40:43], v[120:123], v[160:163], v[40:43]
  v_exp_f32 v153, v153
  v_mfma_f32_16x16x32_bf16 v[44:47], v[124:127], v[160:163], v[44:47]
  v_cvt_pk_bf16_f32 v164, v152, v153
  v_mfma_f32_16x16x32_bf16 a[32:35], v[128:131], v[160:163], a[32:35]
  v_exp_f32 v154, v154
  v_mfma_f32_16x16x32_bf16 a[36:39], v[132:135], v[160:163], a[36:39]
  v_mfma_f32_16x16x32_bf16 a[40:43], v[136:139], v[160:163], a[40:43]
  v_exp_f32 v155, v155
  v_mfma_f32_16x16x32_bf16 a[44:47], v[140:143], v[160:163], a[44:47]
  v_cvt_pk_bf16_f32 v165, v154, v155
  v_mfma_f32_16x16x32_bf16 v[204:207], v[224:227], v[160:163], v[204:207]
  v_exp_f32 v156, v156
  v_mfma_f32_16x16x32_bf16 v[144:147], a[224:227], a[176:179], v[184:187]
  v_mfma_f32_16x16x32_bf16 v[144:147], a[228:231], a[180:183], v[144:147]
  v_exp_f32 v157, v157
  v_mfma_f32_16x16x32_bf16 v[144:147], a[232:235], a[184:187], v[144:147]
  v_cvt_pk_bf16_f32 v166, v156, v157
  v_mfma_f32_16x16x32_bf16 v[144:147], a[236:239], a[188:191], v[144:147]
  v_exp_f32 v158, v158
  v_mfma_f32_16x16x32_bf16 v[148:151], a[240:243], a[176:179], v[184:187]
  v_exp_f32 v159, v159
  v_mfma_f32_16x16x32_bf16 v[148:151], a[244:247], a[180:183], v[148:151]
  v_cvt_pk_bf16_f32 v167, v158, v159
  v_mfma_f32_16x16x32_bf16 v[148:151], a[248:251], a[184:187], v[148:151]
  v_mfma_f32_16x16x32_bf16 v[148:151], a[252:255], a[188:191], v[148:151]
  v_mfma_f32_16x16x32_bf16 v[48:51], v[112:115], v[164:167], v[48:51]
  v_exp_f32 v144, v144
  v_mfma_f32_16x16x32_bf16 v[52:55], v[116:119], v[164:167], v[52:55]
  v_xor_b32 v247, 0x4000, v245
  v_mfma_f32_16x16x32_bf16 v[56:59], v[120:123], v[164:167], v[56:59]
  v_exp_f32 v145, v145
  v_mfma_f32_16x16x32_bf16 v[60:63], v[124:127], v[164:167], v[60:63]
  v_cvt_pk_bf16_f32 v160, v144, v145
  v_mfma_f32_16x16x32_bf16 a[48:51], v[128:131], v[164:167], a[48:51]
  v_exp_f32 v146, v146
  v_mfma_f32_16x16x32_bf16 a[52:55], v[132:135], v[164:167], a[52:55]
  v_mfma_f32_16x16x32_bf16 a[56:59], v[136:139], v[164:167], a[56:59]
  v_exp_f32 v147, v147
  v_mfma_f32_16x16x32_bf16 a[60:63], v[140:143], v[164:167], a[60:63]
  v_cvt_pk_bf16_f32 v161, v146, v147
  v_mfma_f32_16x16x32_bf16 v[208:211], v[224:227], v[164:167], v[208:211]
  v_exp_f32 v148, v148
  v_mfma_f32_16x16x32_bf16 v[152:155], a[224:227], a[192:195], v[188:191]
  v_mfma_f32_16x16x32_bf16 v[152:155], a[228:231], a[196:199], v[152:155]
  v_exp_f32 v149, v149
  v_mfma_f32_16x16x32_bf16 v[152:155], a[232:235], a[200:203], v[152:155]
  v_cvt_pk_bf16_f32 v162, v148, v149
  v_mfma_f32_16x16x32_bf16 v[152:155], a[236:239], a[204:207], v[152:155]
  v_exp_f32 v150, v150
  v_mfma_f32_16x16x32_bf16 v[156:159], a[240:243], a[192:195], v[188:191]
  v_exp_f32 v151, v151
  v_mfma_f32_16x16x32_bf16 v[156:159], a[244:247], a[196:199], v[156:159]
  v_cvt_pk_bf16_f32 v163, v150, v151
  v_mfma_f32_16x16x32_bf16 v[156:159], a[248:251], a[200:203], v[156:159]
  v_mfma_f32_16x16x32_bf16 v[156:159], a[252:255], a[204:207], v[156:159]
  v_mfma_f32_16x16x32_bf16 v[64:67], v[112:115], v[160:163], v[64:67]
  v_exp_f32 v152, v152
  v_mfma_f32_16x16x32_bf16 v[68:71], v[116:119], v[160:163], v[68:71]
  v_mfma_f32_16x16x32_bf16 v[72:75], v[120:123], v[160:163], v[72:75]
  v_exp_f32 v153, v153
  v_mfma_f32_16x16x32_bf16 v[76:79], v[124:127], v[160:163], v[76:79]
  v_cvt_pk_bf16_f32 v164, v152, v153
  v_mfma_f32_16x16x32_bf16 a[64:67], v[128:131], v[160:163], a[64:67]
  v_exp_f32 v154, v154
  v_mfma_f32_16x16x32_bf16 a[68:71], v[132:135], v[160:163], a[68:71]
  v_mfma_f32_16x16x32_bf16 a[72:75], v[136:139], v[160:163], a[72:75]
  v_exp_f32 v155, v155
  v_mfma_f32_16x16x32_bf16 a[76:79], v[140:143], v[160:163], a[76:79]
  v_cvt_pk_bf16_f32 v165, v154, v155
  v_mfma_f32_16x16x32_bf16 v[212:215], v[224:227], v[160:163], v[212:215]
  v_exp_f32 v156, v156
  v_mfma_f32_16x16x32_bf16 v[144:147], a[224:227], a[208:211], v[192:195]
  v_mfma_f32_16x16x32_bf16 v[144:147], a[228:231], a[212:215], v[144:147]
  v_exp_f32 v157, v157
  v_mfma_f32_16x16x32_bf16 v[144:147], a[232:235], a[216:219], v[144:147]
  v_cvt_pk_bf16_f32 v166, v156, v157
  ds_read_b128 a[224:227], v228 offset:32768
  v_mfma_f32_16x16x32_bf16 v[144:147], a[236:239], a[220:223], v[144:147]
  v_exp_f32 v158, v158
  v_mfma_f32_16x16x32_bf16 v[148:151], a[240:243], a[208:211], v[192:195]
  v_exp_f32 v159, v159
  v_mfma_f32_16x16x32_bf16 v[148:151], a[244:247], a[212:215], v[148:151]
  v_cvt_pk_bf16_f32 v167, v158, v159
  ds_read_b128 a[228:231], v229 offset:32768
  v_mfma_f32_16x16x32_bf16 v[148:151], a[248:251], a[216:219], v[148:151]
  ds_read_b128 a[232:235], v230 offset:32768
  ds_read_b128 a[236:239], v231 offset:32768
  v_mfma_f32_16x16x32_bf16 v[148:151], a[252:255], a[220:223], v[148:151]
  ds_read_b128 a[240:243], v228 offset:36864
  ds_read_b128 a[244:247], v229 offset:36864
  v_mfma_f32_16x16x32_bf16 v[80:83], v[112:115], v[164:167], v[80:83]
  v_exp_f32 v144, v144
  v_mfma_f32_16x16x32_bf16 v[84:87], v[116:119], v[164:167], v[84:87]
  ds_read_b128 a[248:251], v230 offset:36864
  ds_read_b128 a[252:255], v231 offset:36864
  v_mfma_f32_16x16x32_bf16 v[88:91], v[120:123], v[164:167], v[88:91]
  v_exp_f32 v145, v145
  v_mfma_f32_16x16x32_bf16 v[92:95], v[124:127], v[164:167], v[92:95]
  v_cvt_pk_bf16_f32 v160, v144, v145
  v_mfma_f32_16x16x32_bf16 a[80:83], v[128:131], v[164:167], a[80:83]
  v_exp_f32 v146, v146
  v_mfma_f32_16x16x32_bf16 a[84:87], v[132:135], v[164:167], a[84:87]
  v_mfma_f32_16x16x32_bf16 a[88:91], v[136:139], v[164:167], a[88:91]
  v_exp_f32 v147, v147
  v_mfma_f32_16x16x32_bf16 a[92:95], v[140:143], v[164:167], a[92:95]
  v_cvt_pk_bf16_f32 v161, v146, v147
  v_mfma_f32_16x16x32_bf16 v[216:219], v[224:227], v[164:167], v[216:219]
  v_exp_f32 v148, v148
  s_waitcnt lgkmcnt(0)
  v_mfma_f32_16x16x32_bf16 v[152:155], a[224:227], a[112:115], v[168:171]
  v_mfma_f32_16x16x32_bf16 v[152:155], a[228:231], a[116:119], v[152:155]
  v_exp_f32 v149, v149
  v_mfma_f32_16x16x32_bf16 v[152:155], a[232:235], a[120:123], v[152:155]
  v_cvt_pk_bf16_f32 v162, v148, v149
  v_mfma_f32_16x16x32_bf16 v[152:155], a[236:239], a[124:127], v[152:155]
  v_exp_f32 v150, v150
  v_mfma_f32_16x16x32_bf16 v[156:159], a[240:243], a[112:115], v[168:171]
  v_exp_f32 v151, v151
  v_mfma_f32_16x16x32_bf16 v[156:159], a[244:247], a[116:119], v[156:159]
  v_cvt_pk_bf16_f32 v163, v150, v151
  v_mfma_f32_16x16x32_bf16 v[156:159], a[248:251], a[120:123], v[156:159]
  v_mfma_f32_16x16x32_bf16 v[156:159], a[252:255], a[124:127], v[156:159]
LP_A_s15:
  s_waitcnt vmcnt(0)
  s_barrier
  v_mfma_f32_16x16x32_bf16 v[96:99], v[112:115], v[160:163], v[96:99]
  v_exp_f32 v152, v152
  ds_read_b64_tr_b16 v[112:113], v232 offset:32768
  v_mfma_f32_16x16x32_bf16 v[100:103], v[116:119], v[160:163], v[100:103]
  ds_read_b64_tr_b16 v[114:115], v232 offset:36864
  v_mfma_f32_16x16x32_bf16 v[104:107], v[120:123], v[160:163], v[104:107]
  v_exp_f32 v153, v153
  ds_read_b64_tr_b16 v[116:117], v233 offset:32768
  v_mfma_f32_16x16x32_bf16 v[108:111], v[124:127], v[160:163], v[108:111]
  v_cvt_pk_bf16_f32 v164, v152, v153
  ds_read_b64_tr_b16 v[118:119], v233 offset:36864
  v_mfma_f32_16x16x32_bf16 a[96:99], v[128:131], v[160:163], a[96:99]
  v_exp_f32 v154, v154
  ds_read_b64_tr_b16 v[120:121], v234 offset:32768
  v_mfma_f32_16x16x32_bf16 a[100:103], v[132:135], v[160:163], a[100:103]
  ds_read_b64_tr_b16 v[122:123], v234 offset:36864
  v_mfma_f32_16x16x32_bf16 a[104:107], v[136:139], v[160:163], a[104:107]
  v_exp_f32 v155, v155
  ds_read_b64_tr_b16 v[124:125], v235 offset:32768
  v_mfma_f32_16x16x32_bf16 a[108:111], v[140:143], v[160:163], a[108:111]
  v_cvt_pk_bf16_f32 v165, v154, v155
  ds_read_b64_tr_b16 v[126:127], v235 offset:36864
  v_mfma_f32_16x16x32_bf16 v[220:223], v[224:227], v[160:163], v[220:223]
  v_exp_f32 v156, v156
  ds_read_b64_tr_b16 v[128:129], v236 offset:32768
  v_mfma_f32_16x16x32_bf16 v[144:147], a[224:227], a[128:131], v[172:175]
  ds_read_b64_tr_b16 v[130:131], v236 offset:36864
  v_mfma_f32_16x16x32_bf16 v[144:147], a[228:231], a[132:135], v[144:147]
  v_exp_f32 v157, v157
  ds_read_b64_tr_b16 v[132:133], v237 offset:32768
  v_mfma_f32_16x16x32_bf16 v[144:147], a[232:235], a[136:139], v[144:147]
  v_cvt_pk_bf16_f32 v166, v156, v157
  ds_read_b64_tr_b16 v[134:135], v237 offset:36864
  v_mfma_f32_16x16x32_bf16 v[144:147], a[236:239], a[140:143], v[144:147]
  v_exp_f32 v158, v158
  ds_read_b64_tr_b16 v[136:137], v238 offset:32768
  v_mfma_f32_16x16x32_bf16 v[148:151], a[240:243], a[128:131], v[172:175]
  v_exp_f32 v159, v159
  ds_read_b64_tr_b16 v[138:139], v238 offset:36864
  v_mfma_f32_16x16x32_bf16 v[148:151], a[244:247], a[132:135], v[148:151]
  v_cvt_pk_bf16_f32 v167, v158, v159
  ds_read_b64_tr_b16 v[140:141], v239 offset:32768
  v_mfma_f32_16x16x32_bf16 v[148:151], a[248:251], a[136:139], v[148:151]
  ds_read_b64_tr_b16 v[142:143], v239 offset:36864
  v_mfma_f32_16x16x32_bf16 v[148:151], a[252:255], a[140:143], v[148:151]
  v_readfirstlane_b32 s66, v248
  s_waitcnt lgkmcnt(8)
  v_mfma_f32_16x16x32_bf16 v[0:3], v[112:115], v[164:167], v[0:3]
  v_exp_f32 v144, v144
  v_mfma_f32_16x16x32_bf16 v[4:7], v[116:119], v[164:167], v[4:7]
  s_add_u32 m0, s67, 145408
  s_add_u32 s30, s96, 0
  s_and_b32 s30, s30, 3
  s_lshl2_add_u32 s29, s89, s30
  s_mul_i32 s64, s29, 73728
  buffer_load_dwordx4 v251, s[68:71], s64 offen offset:0  lds
  v_mfma_f32_16x16x32_bf16 v[8:11], v[120:123], v[164:167], v[8:11]
  v_exp_f32 v145, v145
  v_mfma_f32_16x16x32_bf16 v[12:15], v[124:127], v[164:167], v[12:15]
  v_cvt_pk_bf16_f32 v160, v144, v145
  s_waitcnt lgkmcnt(0)
  v_mfma_f32_16x16x32_bf16 a[0:3], v[128:131], v[164:167], a[0:3]
  v_exp_f32 v146, v146
  v_mfma_f32_16x16x32_bf16 a[4:7], v[132:135], v[164:167], a[4:7]
  buffer_load_dwordx4 v252, s[68:71], s64 offen offset:1024  lds
  v_mfma_f32_16x16x32_bf16 a[8:11], v[136:139], v[164:167], a[8:11]
  v_exp_f32 v147, v147
  v_mfma_f32_16x16x32_bf16 a[12:15], v[140:143], v[164:167], a[12:15]
  v_cvt_pk_bf16_f32 v161, v146, v147
  v_mfma_f32_16x16x32_bf16 v[196:199], v[224:227], v[164:167], v[196:199]
  v_exp_f32 v148, v148
  v_mfma_f32_16x16x32_bf16 v[152:155], a[224:227], a[144:147], v[176:179]
  buffer_load_dwordx4 v253, s[68:71], s64 offen offset:2048  lds
  v_mfma_f32_16x16x32_bf16 v[152:155], a[228:231], a[148:151], v[152:155]
  v_exp_f32 v149, v149
  v_mfma_f32_16x16x32_bf16 v[152:155], a[232:235], a[152:155], v[152:155]
  v_cvt_pk_bf16_f32 v162, v148, v149
  v_mfma_f32_16x16x32_bf16 v[152:155], a[236:239], a[156:159], v[152:155]
  v_exp_f32 v150, v150
  v_mfma_f32_16x16x32_bf16 v[156:159], a[240:243], a[144:147], v[176:179]
  v_exp_f32 v151, v151
  v_mfma_f32_16x16x32_bf16 v[156:159], a[244:247], a[148:151], v[156:159]
  v_cvt_pk_bf16_f32 v163, v150, v151
  v_mfma_f32_16x16x32_bf16 v[156:159], a[248:251], a[152:155], v[156:159]
  buffer_load_dwordx4 v254, s[68:71], s64 offen offset:3072  lds
  v_mfma_f32_16x16x32_bf16 v[156:159], a[252:255], a[156:159], v[156:159]
  s_add_u32 m0, m0, 4096
  s_nop 0
  buffer_load_dwordx4 v255, s[68:71], s64 offen offset:0  lds
  v_mfma_f32_16x16x32_bf16 v[16:19], v[112:115], v[160:163], v[16:19]
  v_exp_f32 v152, v152
  v_mfma_f32_16x16x32_bf16 v[20:23], v[116:119], v[160:163], v[20:23]
  ds_write_b128 v244, a[0:3] offset:0
  v_mfma_f32_16x16x32_bf16 v[24:27], v[120:123], v[160:163], v[24:27]
  v_exp_f32 v153, v153
  v_mfma_f32_16x16x32_bf16 v[28:31], v[124:127], v[160:163], v[28:31]
  v_cvt_pk_bf16_f32 v164, v152, v153
  v_mfma_f32_16x16x32_bf16 a[16:19], v[128:131], v[160:163], a[16:19]
  v_exp_f32 v154, v154
  v_mfma_f32_16x16x32_bf16 a[20:23], v[132:135], v[160:163], a[20:23]
  ds_write_b128 v244, a[4:7] offset:1024
  v_mfma_f32_16x16x32_bf16 a[24:27], v[136:139], v[160:163], a[24:27]
  v_exp_f32 v155, v155
  v_mfma_f32_16x16x32_bf16 a[28:31], v[140:143], v[160:163], a[28:31]
  v_cvt_pk_bf16_f32 v165, v154, v155
  v_mfma_f32_16x16x32_bf16 v[200:203], v[224:227], v[160:163], v[200:203]
  v_exp_f32 v156, v156
  v_mfma_f32_16x16x32_bf16 v[144:147], a[224:227], a[160:163], v[180:183]
  ds_write_b128 v244, a[8:11] offset:2048
  v_mfma_f32_16x16x32_bf16 v[144:147], a[228:231], a[164:167], v[144:147]
  v_exp_f32 v157, v157
  v_mfma_f32_16x16x32_bf16 v[144:147], a[232:235], a[168:171], v[144:147]
  v_cvt_pk_bf16_f32 v166, v156, v157
  v_mfma_f32_16x16x32_bf16 v[144:147], a[236:239], a[172:175], v[144:147]
  v_exp_f32 v158, v158
  v_mfma_f32_16x16x32_bf16 v[148:151], a[240:243], a[160:163], v[180:183]
  v_exp_f32 v159, v159
  v_mfma_f32_16x16x32_bf16 v[148:151], a[244:247], a[164:167], v[148:151]
  v_cvt_pk_bf16_f32 v167, v158, v159
  v_mfma_f32_16x16x32_bf16 v[148:151], a[248:251], a[168:171], v[148:151]
  ds_write_b128 v244, a[12:15] offset:3072
  v_mfma_f32_16x16x32_bf16 v[148:151], a[252:255], a[172:175], v[148:151]
  s_barrier
  v_mfma_f32_16x16x32_bf16 v[32:35], v[112:115], v[164:167], v[32:35]
  v_exp_f32 v144, v144
  v_mfma_f32_16x16x32_bf16 v[36:39], v[116:119], v[164:167], v[36:39]
  ds_write_b128 v244, a[16:19] offset:4096
  v_mfma_f32_16x16x32_bf16 v[40:43], v[120:123], v[164:167], v[40:43]
  v_exp_f32 v145, v145
  v_mfma_f32_16x16x32_bf16 v[44:47], v[124:127], v[164:167], v[44:47]
  v_cvt_pk_bf16_f32 v160, v144, v145
  v_mfma_f32_16x16x32_bf16 a[32:35], v[128:131], v[164:167], a[32:35]
  v_exp_f32 v146, v146
  v_mfma_f32_16x16x32_bf16 a[36:39], v[132:135], v[164:167], a[36:39]
  ds_write_b128 v244, a[20:23] offset:5120
  v_mfma_f32_16x16x32_bf16 a[40:43], v[136:139], v[164:167], a[40:43]
  v_exp_f32 v147, v147
  v_mfma_f32_16x16x32_bf16 a[44:47], v[140:143], v[164:167], a[44:47]
  v_cvt_pk_bf16_f32 v161, v146, v147
  v_mfma_f32_16x16x32_bf16 v[204:207], v[224:227], v[164:167], v[204:207]
  v_exp_f32 v148, v148
  v_mfma_f32_16x16x32_bf16 v[152:155], a[224:227], a[176:179], v[184:187]
  ds_write_b128 v244, a[24:27] offset:6144
  v_mfma_f32_16x16x32_bf16 v[152:155], a[228:231], a[180:183], v[152:155]
  v_exp_f32 v149, v149
  v_mfma_f32_16x16x32_bf16 v[152:155], a[232:235], a[184:187], v[152:155]
  v_cvt_pk_bf16_f32 v162, v148, v149
  v_mfma_f32_16x16x32_bf16 v[152:155], a[236:239], a[188:191], v[152:155]
  v_exp_f32 v150, v150
  v_mfma_f32_16x16x32_bf16 v[156:159], a[240:243], a[176:179], v[184:187]
  v_exp_f32 v151, v151
  v_mfma_f32_16x16x32_bf16 v[156:159], a[244:247], a[180:183], v[156:159]
  v_cvt_pk_bf16_f32 v163, v150, v151
  v_mfma_f32_16x16x32_bf16 v[156:159], a[248:251], a[184:187], v[156:159]
  ds_write_b128 v244, a[28:31] offset:7168
  v_mfma_f32_16x16x32_bf16 v[156:159], a[252:255], a[188:191], v[156:159]
  v_mfma_f32_16x16x32_bf16 v[48:51], v[112:115], v[160:163], v[48:51]
  v_exp_f32 v152, v152
  v_mfma_f32_16x16x32_bf16 v[52:55], v[116:119], v[160:163], v[52:55]
  ds_write_b128 v244, a[32:35] offset:8192
  v_mfma_f32_16x16x32_bf16 v[56:59], v[120:123], v[160:163], v[56:59]
  v_exp_f32 v153, v153
  v_mfma_f32_16x16x32_bf16 v[60:63], v[124:127], v[160:163], v[60:63]
  v_cvt_pk_bf16_f32 v164, v152, v153
  v_mfma_f32_16x16x32_bf16 a[48:51], v[128:131], v[160:163], a[48:51]
  v_exp_f32 v154, v154
  v_mfma_f32_16x16x32_bf16 a[52:55], v[132:135], v[160:163], a[52:55]
  ds_write_b128 v244, a[36:39] offset:9216
  v_mfma_f32_16x16x32_bf16 a[56:59], v[136:139], v[160:163], a[56:59]
  v_exp_f32 v155, v155
  v_mfma_f32_16x16x32_bf16 a[60:63], v[140:143], v[160:163], a[60:63]
  v_cvt_pk_bf16_f32 v165, v154, v155
  v_mfma_f32_16x16x32_bf16 v[208:211], v[224:227], v[160:163], v[208:211]
  v_exp_f32 v156, v156
  v_mfma_f32_16x16x32_bf16 v[144:147], a[224:227], a[192:195], v[188:191]
  ds_write_b128 v244, a[40:43] offset:10240
  v_mfma_f32_16x16x32_bf16 v[144:147], a[228:231], a[196:199], v[144:147]
  v_exp_f32 v157, v157
  v_mfma_f32_16x16x32_bf16 v[144:147], a[232:235], a[200:203], v[144:147]
  v_cvt_pk_bf16_f32 v166, v156, v157
  v_mfma_f32_16x16x32_bf16 v[144:147], a[236:239], a[204:207], v[144:147]
  v_exp_f32 v158, v158
  v_mfma_f32_16x16x32_bf16 v[148:151], a[240:243], a[192:195], v[188:191]
  v_exp_f32 v159, v159
  v_mfma_f32_16x16x32_bf16 v[148:151], a[244:247], a[196:199], v[148:151]
  v_cvt_pk_bf16_f32 v167, v158, v159
  v_mfma_f32_16x16x32_bf16 v[148:151], a[248:251], a[200:203], v[148:151]
  ds_write_b128 v244, a[44:47] offset:11264
  v_mfma_f32_16x16x32_bf16 v[148:151], a[252:255], a[204:207], v[148:151]
  v_mfma_f32_16x16x32_bf16 v[64:67], v[112:115], v[164:167], v[64:67]
  v_exp_f32 v144, v144
  v_mfma_f32_16x16x32_bf16 v[68:71], v[116:119], v[164:167], v[68:71]
  ds_write_b128 v244, a[48:51] offset:12288
  v_mfma_f32_16x16x32_bf16 v[72:75], v[120:123], v[164:167], v[72:75]
  v_exp_f32 v145, v145
  v_mfma_f32_16x16x32_bf16 v[76:79], v[124:127], v[164:167], v[76:79]
  v_cvt_pk_bf16_f32 v160, v144, v145
  v_mfma_f32_16x16x32_bf16 a[64:67], v[128:131], v[164:167], a[64:67]
  v_exp_f32 v146, v146
  v_mfma_f32_16x16x32_bf16 a[68:71], v[132:135], v[164:167], a[68:71]
  ds_write_b128 v244, a[52:55] offset:13312
  v_mfma_f32_16x16x32_bf16 a[72:75], v[136:139], v[164:167], a[72:75]
  v_exp_f32 v147, v147
  v_mfma_f32_16x16x32_bf16 a[76:79], v[140:143], v[164:167], a[76:79]
  v_cvt_pk_bf16_f32 v161, v146, v147
  v_mfma_f32_16x16x32_bf16 v[212:215], v[224:227], v[164:167], v[212:215]
  v_exp_f32 v148, v148
  v_mfma_f32_16x16x32_bf16 v[152:155], a[224:227], a[208:211], v[192:195]
  ds_write_b128 v244, a[56:59] offset:14336
  v_mfma_f32_16x16x32_bf16 v[152:155], a[228:231], a[212:215], v[152:155]
  v_exp_f32 v149, v149
  v_mfma_f32_16x16x32_bf16 v[152:155], a[232:235], a[216:219], v[152:155]
  v_cvt_pk_bf16_f32 v162, v148, v149
  v_mfma_f32_16x16x32_bf16 v[152:155], a[236:239], a[220:223], v[152:155]
  v_exp_f32 v150, v150
  v_mfma_f32_16x16x32_bf16 v[156:159], a[240:243], a[208:211], v[192:195]
  v_exp_f32 v151, v151
  v_mfma_f32_16x16x32_bf16 v[156:159], a[244:247], a[212:215], v[156:159]
  v_cvt_pk_bf16_f32 v163, v150, v151
  v_mfma_f32_16x16x32_bf16 v[156:159], a[248:251], a[216:219], v[156:159]
  ds_write_b128 v244, a[60:63] offset:15360
  v_mfma_f32_16x16x32_bf16 v[156:159], a[252:255], a[220:223], v[156:159]
  v_mfma_f32_16x16x32_bf16 v[80:83], v[112:115], v[160:163], v[80:83]
  v_exp_f32 v152, v152
  v_mfma_f32_16x16x32_bf16 v[84:87], v[116:119], v[160:163], v[84:87]
  ds_write_b128 v245, a[64:67] offset:0
  v_mfma_f32_16x16x32_bf16 v[88:91], v[120:123], v[160:163], v[88:91]
  v_exp_f32 v153, v153
  v_mfma_f32_16x16x32_bf16 v[92:95], v[124:127], v[160:163], v[92:95]
  v_cvt_pk_bf16_f32 v164, v152, v153
  buffer_load_dword v250, v249, s[44:47], 0 offen
  v_add_u32 v249, 8192, v249
  v_mfma_f32_16x16x32_bf16 a[80:83], v[128:131], v[160:163], a[80:83]
  v_exp_f32 v154, v154
  v_mfma_f32_16x16x32_bf16 a[84:87], v[132:135], v[160:163], a[84:87]
  ds_write_b128 v245, a[68:71] offset:1024
  v_mfma_f32_16x16x32_bf16 a[88:91], v[136:139], v[160:163], a[88:91]
  v_exp_f32 v155, v155
  v_mfma_f32_16x16x32_bf16 a[92:95], v[140:143], v[160:163], a[92:95]
  v_cvt_pk_bf16_f32 v165, v154, v155
  v_mfma_f32_16x16x32_bf16 v[216:219], v[224:227], v[160:163], v[216:219]
  v_exp_f32 v156, v156
  ds_write_b128 v245, a[72:75] offset:2048
  v_exp_f32 v157, v157
  s_nop 0
  v_cvt_pk_bf16_f32 v166, v156, v157
  v_exp_f32 v158, v158
  v_exp_f32 v159, v159
  buffer_load_dword v250, v249, s[44:47], 0 offen
  v_add_u32 v249, 8192, v249
  s_nop 0
  v_cvt_pk_bf16_f32 v167, v158, v159
  ds_write_b128 v245, a[76:79] offset:3072
LP_A_e:
L1_tail:
  s_lshl_b32 s61, s20, 2
  s_add_u32 s61, s61, 131072
  s_mov_b32 s29, 0x5d800000
  v_mfma_f32_16x16x32_bf16 v[220:223], v[224:227], v[164:167], v[220:223]
  ds_write_b128 v245, a[80:83] offset:4096
  ds_write_b128 v245, a[84:87] offset:5120
  v_mfma_f32_16x16x32_bf16 a[96:99], v[128:131], v[164:167], a[96:99]
  ds_write_b128 v245, a[88:91] offset:6144
  ds_write_b128 v245, a[92:95] offset:7168
  v_mfma_f32_16x16x32_bf16 a[100:103], v[132:135], v[164:167], a[100:103]
  v_add_f32 v146, v196, v200
  v_add_f32 v147, v204, v208
  v_mfma_f32_16x16x32_bf16 a[104:107], v[136:139], v[164:167], a[104:107]
  v_add_f32 v148, v212, v216
  v_mov_b32 v197, v200
  v_mfma_f32_16x16x32_bf16 a[108:111], v[140:143], v[164:167], a[108:111]
  v_mov_b32 v198, v204
  v_mov_b32 v199, v208
  v_mfma_f32_16x16x32_bf16 v[96:99], v[112:115], v[164:167], v[96:99]
  v_mov_b32 v213, v216
  v_add_f32 v147, v147, v148
  v_mfma_f32_16x16x32_bf16 v[100:103], v[116:119], v[164:167], v[100:103]
  v_add_f32 v146, v146, v220
  v_mov_b32 v214, v220
  v_mfma_f32_16x16x32_bf16 v[104:107], v[120:123], v[164:167], v[104:107]
  v_add_f32 v146, v146, v147
  v_mov_b32 v145, s61
  v_mfma_f32_16x16x32_bf16 v[108:111], v[124:127], v[164:167], v[108:111]
  v_cmp_nge_f32 vcc, s29, v146
  v_mov_b32 v146, 131072
  ds_write_b128 v245, v[196:199] offset:12288
  ds_write_b128 v245, v[212:215] offset:13312
  s_cmp_lg_u64 vcc, 0
  s_cselect_b32 s29, 1, 0
  v_mov_b32 v144, s29
  ds_write_b128 v245, a[96:99] offset:8192
  ds_write_b128 v245, a[100:103] offset:9216
  ds_write_b128 v245, a[104:107] offset:10240
  ds_write_b128 v245, a[108:111] offset:11264
  ds_write_b32 v145, v144
  s_waitcnt lgkmcnt(0)
  s_barrier
  ds_read_b128 v[148:151], v146
  ds_read_b128 v[152:155], v247 offset:12288
  ds_read_b128 v[156:159], v247 offset:13312
  ds_read_b128 v[112:115], v246 offset:0
  ds_read_b128 v[116:119], v246 offset:1024
  ds_read_b128 v[120:123], v246 offset:2048
  ds_read_b128 v[124:127], v246 offset:3072
  ds_read_b128 v[128:131], v246 offset:4096
  ds_read_b128 v[132:135], v246 offset:5120
  ds_read_b128 v[136:139], v246 offset:6144
  ds_read_b128 v[140:143], v246 offset:7168
  ds_read_b128 v[168:171], v246 offset:8192
  ds_read_b128 v[172:175], v246 offset:9216
  ds_read_b128 v[176:179], v246 offset:10240
  ds_read_b128 v[180:183], v246 offset:11264
  s_waitcnt lgkmcnt(12)
  v_or3_b32 v148, v148, v149, v150
  v_or_b32 v148, v148, v151
  v_add_f32 v152, v152, v196
  v_add_f32 v153, v153, v197
  v_add_f32 v154, v154, v198
  v_add_f32 v155, v155, v199
  v_add_f32 v156, v156, v212
  v_add_f32 v157, v157, v213
  v_add_f32 v158, v158, v214
  v_readfirstlane_b32 s29, v148
  v_rcp_f32 v152, v152
  v_rcp_f32 v153, v153
  v_rcp_f32 v154, v154
  v_rcp_f32 v155, v155
  v_rcp_f32 v156, v156
  v_rcp_f32 v157, v157
  v_rcp_f32 v158, v158
  s_andn2_b32 s29, s29, s31
  s_cbranch_scc1 L1_fb
  s_mov_b32 s61, 0
  s_waitcnt lgkmcnt(8)
  v_pk_add_f32 v[0:1], v[0:1], v[112:113]
  v_pk_add_f32 v[2:3], v[2:3], v[114:115]
  v_pk_add_f32 v[4:5], v[4:5], v[116:117]
  v_pk_add_f32 v[6:7], v[6:7], v[118:119]
  v_pk_add_f32 v[8:9], v[8:9], v[120:121]
  v_pk_add_f32 v[10:11], v[10:11], v[122:123]
  v_pk_add_f32 v[12:13], v[12:13], v[124:125]
  v_pk_add_f32 v[14:15], v[14:15], v[126:127]
  ds_read_b128 v[112:115], v246 offset:12288
  ds_read_b128 v[116:119], v246 offset:13312
  ds_read_b128 v[120:123], v246 offset:14336
  ds_read_b128 v[124:127], v246 offset:15360
  v_pk_mul_f32 v[0:1], v[0:1], v[152:153] op_sel:[0,0] op_sel_hi:[1,0]
  v_pk_mul_f32 v[2:3], v[2:3], v[152:153] op_sel:[0,0] op_sel_hi:[1,0]
  v_pk_mul_f32 v[4:5], v[4:5], v[152:153] op_sel:[0,0] op_sel_hi:[1,0]
  v_pk_mul_f32 v[6:7], v[6:7], v[152:153] op_sel:[0,0] op_sel_hi:[1,0]
  v_pk_mul_f32 v[8:9], v[8:9], v[152:153] op_sel:[0,0] op_sel_hi:[1,0]
  v_pk_mul_f32 v[10:11], v[10:11], v[152:153] op_sel:[0,0] op_sel_hi:[1,0]
  v_pk_mul_f32 v[12:13], v[12:13], v[152:153] op_sel:[0,0] op_sel_hi:[1,0]
  v_pk_mul_f32 v[14:15], v[14:15], v[152:153] op_sel:[0,0] op_sel_hi:[1,0]
  v_cvt_pk_bf16_f32 v0, v0, v1
  v_cvt_pk_bf16_f32 v1, v2, v3
  v_cvt_pk_bf16_f32 v2, v4, v5
  v_cvt_pk_bf16_f32 v3, v6, v7
  v_cvt_pk_bf16_f32 v4, v8, v9
  v_cvt_pk_bf16_f32 v5, v10, v11
  v_cvt_pk_bf16_f32 v6, v12, v13
  v_cvt_pk_bf16_f32 v7, v14, v15
  ds_write_b128 v246, v[0:3] offset:0
  ds_write_b128 v246, v[4:7] offset:1024
  buffer_store_dwordx4 v[0:3], v243, s[16:19], s61 offen offset:0 sc1
  buffer_store_dwordx4 v[4:7], v243, s[16:19], s61 offen offset:1024 sc1
  s_add_u32 s61, s61, 131072
  s_waitcnt lgkmcnt(10)
  v_pk_add_f32 v[16:17], v[16:17], v[128:129]
  v_pk_add_f32 v[18:19], v[18:19], v[130:131]
  v_pk_add_f32 v[20:21], v[20:21], v[132:133]
  v_pk_add_f32 v[22:23], v[22:23], v[134:135]
  v_pk_add_f32 v[24:25], v[24:25], v[136:137]
  v_pk_add_f32 v[26:27], v[26:27], v[138:139]
  v_pk_add_f32 v[28:29], v[28:29], v[140:141]
  v_pk_add_f32 v[30:31], v[30:31], v[142:143]
  ds_read_b128 v[128:131], v247 offset:0
  ds_read_b128 v[132:135], v247 offset:1024
  ds_read_b128 v[136:139], v247 offset:2048
  ds_read_b128 v[140:143], v247 offset:3072
  v_pk_mul_f32 v[16:17], v[16:17], v[152:153] op_sel:[0,1] op_sel_hi:[1,1]
  v_pk_mul_f32 v[18:19], v[18:19], v[152:153] op_sel:[0,1] op_sel_hi:[1,1]
  v_pk_mul_f32 v[20:21], v[20:21], v[152:153] op_sel:[0,1] op_sel_hi:[1,1]
  v_pk_mul_f32 v[22:23], v[22:23], v[152:153] op_sel:[0,1] op_sel_hi:[1,1]
  v_pk_mul_f32 v[24:25], v[24:25], v[152:153] op_sel:[0,1] op_sel_hi:[1,1]
  v_pk_mul_f32 v[26:27], v[26:27], v[152:153] op_sel:[0,1] op_sel_hi:[1,1]
  v_pk_mul_f32 v[28:29], v[28:29], v[152:153] op_sel:[0,1] op_sel_hi:[1,1]
  v_pk_mul_f32 v[30:31], v[30:31], v[152:153] op_sel:[0,1] op_sel_hi:[1,1]
  v_cvt_pk_bf16_f32 v16, v16, v17
  v_cvt_pk_bf16_f32 v17, v18, v19
  v_cvt_pk_bf16_f32 v18, v20, v21
  v_cvt_pk_bf16_f32 v19, v22, v23
  v_cvt_pk_bf16_f32 v20, v24, v25
  v_cvt_pk_bf16_f32 v21, v26, v27
  v_cvt_pk_bf16_f32 v22, v28, v29
  v_cvt_pk_bf16_f32 v23, v30, v31
  ds_write_b128 v246, v[16:19] offset:2048
  ds_write_b128 v246, v[20:23] offset:3072
  buffer_store_dwordx4 v[16:19], v243, s[16:19], s61 offen offset:0 sc1
  buffer_store_dwordx4 v[20:23], v243, s[16:19], s61 offen offset:1024 sc1
  s_add_u32 s61, s61, 131072
  s_waitcnt lgkmcnt(12)
  v_pk_add_f32 v[32:33], v[32:33], v[168:169]
  v_pk_add_f32 v[34:35], v[34:35], v[170:171]
  v_pk_add_f32 v[36:37], v[36:37], v[172:173]
  v_pk_add_f32 v[38:39], v[38:39], v[174:175]
  v_pk_add_f32 v[40:41], v[40:41], v[176:177]
  v_pk_add_f32 v[42:43], v[42:43], v[178:179]
  v_pk_add_f32 v[44:45], v[44:45], v[180:181]
  v_pk_add_f32 v[46:47], v[46:47], v[182:183]
  ds_read_b128 v[168:171], v247 offset:4096
  ds_read_b128 v[172:175], v247 offset:5120
  ds_read_b128 v[176:179], v247 offset:6144
  ds_read_b128 v[180:183], v247 offset:7168
  v_pk_mul_f32 v[32:33], v[32:33], v[154:155] op_sel:[0,0] op_sel_hi:[1,0]
  v_pk_mul_f32 v[34:35], v[34:35], v[154:155] op_sel:[0,0] op_sel_hi:[1,0]
  v_pk_mul_f32 v[36:37], v[36:37], v[154:155] op_sel:[0,0] op_sel_hi:[1,0]
  v_pk_mul_f32 v[38:39], v[38:39], v[154:155] op_sel:[0,0] op_sel_hi:[1,0]
  v_pk_mul_f32 v[40:41], v[40:41], v[154:155] op_sel:[0,0] op_sel_hi:[1,0]
  v_pk_mul_f32 v[42:43], v[42:43], v[154:155] op_sel:[0,0] op_sel_hi:[1,0]
  v_pk_mul_f32 v[44:45], v[44:45], v[154:155] op_sel:[0,0] op_sel_hi:[1,0]
  v_pk_mul_f32 v[46:47], v[46:47], v[154:155] op_sel:[0,0] op_sel_hi:[1,0]
  v_cvt_pk_bf16_f32 v32, v32, v33
  v_cvt_pk_bf16_f32 v33, v34, v35
  v_cvt_pk_bf16_f32 v34, v36, v37
  v_cvt_pk_bf16_f32 v35, v38, v39
  v_cvt_pk_bf16_f32 v36, v40, v41
  v_cvt_pk_bf16_f32 v37, v42, v43
  v_cvt_pk_bf16_f32 v38, v44, v45
  v_cvt_pk_bf16_f32 v39, v46, v47
  ds_write_b128 v246, v[32:35] offset:4096
  ds_write_b128 v246, v[36:39] offset:5120
  buffer_store_dwordx4 v[32:35], v243, s[16:19], s61 offen offset:0 sc1
  buffer_store_dwordx4 v[36:39], v243, s[16:19], s61 offen offset:1024 sc1
  s_add_u32 s61, s61, 131072
  s_waitcnt lgkmcnt(12)
  v_pk_add_f32 v[48:49], v[48:49], v[112:113]
  v_pk_add_f32 v[50:51], v[50:51], v[114:115]
  v_pk_add_f32 v[52:53], v[52:53], v[116:117]
  v_pk_add_f32 v[54:55], v[54:55], v[118:119]
  v_pk_add_f32 v[56:57], v[56:57], v[120:121]
  v_pk_add_f32 v[58:59], v[58:59], v[122:123]
  v_pk_add_f32 v[60:61], v[60:61], v[124:125]
  v_pk_add_f32 v[62:63], v[62:63], v[126:127]
  ds_read_b128 v[112:115], v247 offset:8192
  ds_read_b128 v[116:119], v247 offset:9216
  ds_read_b128 v[120:123], v247 offset:10240
  ds_read_b128 v[124:127], v247 offset:11264
  v_pk_mul_f32 v[48:49], v[48:49], v[154:155] op_sel:[0,1] op_sel_hi:[1,1]
  v_pk_mul_f32 v[50:51], v[50:51], v[154:155] op_sel:[0,1] op_sel_hi:[1,1]
  v_pk_mul_f32 v[52:53], v[52:53], v[154:155] op_sel:[0,1] op_sel_hi:[1,1]
  v_pk_mul_f32 v[54:55], v[54:55], v[154:155] op_sel:[0,1] op_sel_hi:[1,1]
  v_pk_mul_f32 v[56:57], v[56:57], v[154:155] op_sel:[0,1] op_sel_hi:[1,1]
  v_pk_mul_f32 v[58:59], v[58:59], v[154:155] op_sel:[0,1] op_sel_hi:[1,1]
  v_pk_mul_f32 v[60:61], v[60:61], v[154:155] op_sel:[0,1] op_sel_hi:[1,1]
  v_pk_mul_f32 v[62:63], v[62:63], v[154:155] op_sel:[0,1] op_sel_hi:[1,1]
  v_cvt_pk_bf16_f32 v48, v48, v49
  v_cvt_pk_bf16_f32 v49, v50, v51
  v_cvt_pk_bf16_f32 v50, v52, v53
  v_cvt_pk_bf16_f32 v51, v54, v55
  v_cvt_pk_bf16_f32 v52, v56, v57
  v_cvt_pk_bf16_f32 v53, v58, v59
  v_cvt_pk_bf16_f32 v54, v60, v61
  v_cvt_pk_bf16_f32 v55, v62, v63
  ds_write_b128 v246, v[48:51] offset:6144
  ds_write_b128 v246, v[52:55] offset:7168
  buffer_store_dwordx4 v[48:51], v243, s[16:19], s61 offen offset:0 sc1
  buffer_store_dwordx4 v[52:55], v243, s[16:19], s61 offen offset:1024 sc1
  s_add_u32 s61, s61, 131072
  s_waitcnt lgkmcnt(12)
  v_pk_add_f32 v[64:65], v[64:65], v[128:129]
  v_pk_add_f32 v[66:67], v[66:67], v[130:131]
  v_pk_add_f32 v[68:69], v[68:69], v[132:133]
  v_pk_add_f32 v[70:71], v[70:71], v[134:135]
  v_pk_add_f32 v[72:73], v[72:73], v[136:137]
  v_pk_add_f32 v[74:75], v[74:75], v[138:139]
  v_pk_add_f32 v[76:77], v[76:77], v[140:141]
  v_pk_add_f32 v[78:79], v[78:79], v[142:143]
  v_pk_mul_f32 v[64:65], v[64:65], v[156:157] op_sel:[0,0] op_sel_hi:[1,0]
  v_pk_mul_f32 v[66:67], v[66:67], v[156:157] op_sel:[0,0] op_sel_hi:[1,0]
  v_pk_mul_f32 v[68:69], v[68:69], v[156:157] op_sel:[0,0] op_sel_hi:[1,0]
  v_pk_mul_f32 v[70:71], v[70:71], v[156:157] op_sel:[0,0] op_sel_hi:[1,0]
  v_pk_mul_f32 v[72:73], v[72:73], v[156:157] op_sel:[0,0] op_sel_hi:[1,0]
  v_pk_mul_f32 v[74:75], v[74:75], v[156:157] op_sel:[0,0] op_sel_hi:[1,0]
  v_pk_mul_f32 v[76:77], v[76:77], v[156:157] op_sel:[0,0] op_sel_hi:[1,0]
  v_pk_mul_f32 v[78:79], v[78:79], v[156:157] op_sel:[0,0] op_sel_hi:[1,0]
  v_cvt_pk_bf16_f32 v64, v64, v65
  v_cvt_pk_bf16_f32 v65, v66, v67
  v_cvt_pk_bf16_f32 v66, v68, v69
  v_cvt_pk_bf16_f32 v67, v70, v71
  v_cvt_pk_bf16_f32 v68, v72, v73
  v_cvt_pk_bf16_f32 v69, v74, v75
  v_cvt_pk_bf16_f32 v70, v76, v77
  v_cvt_pk_bf16_f32 v71, v78, v79
  ds_write_b128 v246, v[64:67] offset:8192
  ds_write_b128 v246, v[68:71] offset:9216
  buffer_store_dwordx4 v[64:67], v243, s[16:19], s61 offen offset:0 sc1
  buffer_store_dwordx4 v[68:71], v243, s[16:19], s61 offen offset:1024 sc1
  s_add_u32 s61, s61, 131072
  s_waitcnt lgkmcnt(8)
  v_pk_add_f32 v[80:81], v[80:81], v[168:169]
  v_pk_add_f32 v[82:83], v[82:83], v[170:171]
  v_pk_add_f32 v[84:85], v[84:85], v[172:173]
  v_pk_add_f32 v[86:87], v[86:87], v[174:175]
  v_pk_add_f32 v[88:89], v[88:89], v[176:177]
  v_pk_add_f32 v[90:91], v[90:91], v[178:179]
  v_pk_add_f32 v[92:93], v[92:93], v[180:181]
  v_pk_add_f32 v[94:95], v[94:95], v[182:183]
  v_pk_mul_f32 v[80:81], v[80:81], v[156:157] op_sel:[0,1] op_sel_hi:[1,1]
  v_pk_mul_f32 v[82:83], v[82:83], v[156:157] op_sel:[0,1] op_sel_hi:[1,1]
  v_pk_mul_f32 v[84:85], v[84:85], v[156:157] op_sel:[0,1] op_sel_hi:[1,1]
  v_pk_mul_f32 v[86:87], v[86:87], v[156:157] op_sel:[0,1] op_sel_hi:[1,1]
  v_pk_mul_f32 v[88:89], v[88:89], v[156:157] op_sel:[0,1] op_sel_hi:[1,1]
  v_pk_mul_f32 v[90:91], v[90:91], v[156:157] op_sel:[0,1] op_sel_hi:[1,1]
  v_pk_mul_f32 v[92:93], v[92:93], v[156:157] op_sel:[0,1] op_sel_hi:[1,1]
  v_pk_mul_f32 v[94:95], v[94:95], v[156:157] op_sel:[0,1] op_sel_hi:[1,1]
  v_cvt_pk_bf16_f32 v80, v80, v81
  v_cvt_pk_bf16_f32 v81, v82, v83
  v_cvt_pk_bf16_f32 v82, v84, v85
  v_cvt_pk_bf16_f32 v83, v86, v87
  v_cvt_pk_bf16_f32 v84, v88, v89
  v_cvt_pk_bf16_f32 v85, v90, v91
  v_cvt_pk_bf16_f32 v86, v92, v93
  v_cvt_pk_bf16_f32 v87, v94, v95
  ds_write_b128 v246, v[80:83] offset:10240
  ds_write_b128 v246, v[84:87] offset:11264
  buffer_store_dwordx4 v[80:83], v243, s[16:19], s61 offen offset:0 sc1
  buffer_store_dwordx4 v[84:87], v243, s[16:19], s61 offen offset:1024 sc1
  s_add_u32 s61, s61, 131072
  s_waitcnt lgkmcnt(4)
  v_pk_add_f32 v[96:97], v[96:97], v[112:113]
  v_pk_add_f32 v[98:99], v[98:99], v[114:115]
  v_pk_add_f32 v[100:101], v[100:101], v[116:117]
  v_pk_add_f32 v[102:103], v[102:103], v[118:119]
  v_pk_add_f32 v[104:105], v[104:105], v[120:121]
  v_pk_add_f32 v[106:107], v[106:107], v[122:123]
  v_pk_add_f32 v[108:109], v[108:109], v[124:125]
  v_pk_add_f32 v[110:111], v[110:111], v[126:127]
  v_pk_mul_f32 v[96:97], v[96:97], v[158:159] op_sel:[0,0] op_sel_hi:[1,0]
  v_pk_mul_f32 v[98:99], v[98:99], v[158:159] op_sel:[0,0] op_sel_hi:[1,0]
  v_pk_mul_f32 v[100:101], v[100:101], v[158:159] op_sel:[0,0] op_sel_hi:[1,0]
  v_pk_mul_f32 v[102:103], v[102:103], v[158:159] op_sel:[0,0] op_sel_hi:[1,0]
  v_pk_mul_f32 v[104:105], v[104:105], v[158:159] op_sel:[0,0] op_sel_hi:[1,0]
  v_pk_mul_f32 v[106:107], v[106:107], v[158:159] op_sel:[0,0] op_sel_hi:[1,0]
  v_pk_mul_f32 v[108:109], v[108:109], v[158:159] op_sel:[0,0] op_sel_hi:[1,0]
  v_pk_mul_f32 v[110:111], v[110:111], v[158:159] op_sel:[0,0] op_sel_hi:[1,0]
  v_cvt_pk_bf16_f32 v96, v96, v97
  v_cvt_pk_bf16_f32 v97, v98, v99
  v_cvt_pk_bf16_f32 v98, v100, v101
  v_cvt_pk_bf16_f32 v99, v102, v103
  v_cvt_pk_bf16_f32 v100, v104, v105
  v_cvt_pk_bf16_f32 v101, v106, v107
  v_cvt_pk_bf16_f32 v102, v108, v109
  v_cvt_pk_bf16_f32 v103, v110, v111
  ds_write_b128 v246, v[96:99] offset:12288
  ds_write_b128 v246, v[100:103] offset:13312
  buffer_store_dwordx4 v[96:99], v243, s[16:19], s61 offen offset:0 sc1
  buffer_store_dwordx4 v[100:103], v243, s[16:19], s61 offen offset:1024 sc1
  s_add_u32 s61, s61, 131072
L1_gemm:
  s_mov_b32 s26, 400000
LG_dchk:
  s_cmp_ge_u32 s66, 16
  s_cbranch_scc1 LG_dok
  buffer_load_dword v125, off, s[80:83], 0 sc1
  s_sub_u32 s26, s26, 1
  s_cbranch_scc1 L1_end
  s_waitcnt vmcnt(0)
  v_readfirstlane_b32 s66, v125
  s_nop 0
  s_branch LG_dchk
LG_dok:
  v_lshrrev_b32 v125, 2, v242
  v_mul_u32_u24 v125, 288, v125
  v_and_b32 v124, 3, v242
  v_lshl_add_u32 v125, v124, 3, v125
  v_add_u32 v116, 14336, v125
  v_add_u32 v117, 131072, v116
  s_lshl_b32 s29, s97, 9
  v_lshl_add_u32 v124, v124, 7, s29
  v_lshlrev_b32 v126, 11, v242
  v_mov_b32 v127, 1
  v_lshrrev_b32 v249, 4, v242
  v_lshlrev_b32 v249, 10, v249
  v_and_or_b32 v249, v242, 15, v249
  v_lshlrev_b32 v249, 7, v249
  s_lshl_b32 s62, 1, s89
  s_lshl_b32 s63, 1, s97
  s_add_u32 s48, s67, 14336
  s_mov_b32 s41, 65536
  s_mov_b32 s43, 14
  s_add_u32 s29, s96, 0
  s_and_b32 s29, s29, 3
  s_xor_b32 s29, s29, 1
  s_lshl_b32 s29, s29, 14
  v_add_u32 v118, s29, v243
  s_cmp_eq_u32 s20, 1
  s_cbranch_scc1 LG_w1
  s_cmp_eq_u32 s20, 2
  s_cbranch_scc1 LG_w2
  s_cmp_eq_u32 s20, 3
  s_cbranch_scc1 LG_w3
LG_w0:
  v_add_u32 v112, 0, v243
  v_add_u32 v113, 0, v243
  v_add_u32 v114, 129024, v243
  s_waitcnt vmcnt(16) lgkmcnt(0)
  s_barrier
  ds_read_b64_tr_b16 a[92:93], v117 offset:0
  ds_read_b64_tr_b16 a[94:95], v117 offset:4608
  ds_read_b128 a[64:67], v118 offset:0
  ds_read_b64_tr_b16 a[96:97], v117 offset:32
  ds_read_b64_tr_b16 a[98:99], v117 offset:4640
  ds_read_b64_tr_b16 a[100:101], v117 offset:64
  ds_read_b64_tr_b16 a[102:103], v117 offset:4672
  ds_read_b64_tr_b16 a[104:105], v117 offset:96
  ds_read_b64_tr_b16 a[106:107], v117 offset:4704
  ds_read_b128 a[68:71], v118 offset:2048
  ds_read_b128 a[72:75], v118 offset:4096
  ds_read_b128 a[76:79], v118 offset:6144
  s_add_u32 m0, s67, 79872
  s_add_u32 s30, s96, 1
  s_and_b32 s30, s30, 3
  s_lshl2_add_u32 s29, s89, s30
  s_mul_i32 s64, s29, 73728
  buffer_load_dwordx4 v251, s[68:71], s64 offen offset:0  lds
  buffer_load_dwordx4 v252, s[68:71], s64 offen offset:1024  lds
  buffer_load_dwordx4 v253, s[68:71], s64 offen offset:2048  lds
  buffer_load_dwordx4 v254, s[68:71], s64 offen offset:3072  lds
  s_add_u32 m0, m0, 4096
  s_nop 0
  buffer_load_dwordx4 v255, s[68:71], s64 offen offset:0  lds
  s_waitcnt lgkmcnt(0)
  v_mfma_f32_16x16x32_bf16 v[128:131], a[92:95], a[64:67], 0
  s_add_u32 m0, s67, 112640
  ds_read_b64_tr_b16 a[140:141], v117 offset:9216
  ds_read_b64_tr_b16 a[142:143], v117 offset:13824
  v_mfma_f32_16x16x32_bf16 v[132:135], a[96:99], a[64:67], 0
  ds_read_b128 a[112:115], v118 offset:1024
  ds_read_b64_tr_b16 a[144:145], v117 offset:9248
  ds_read_b64_tr_b16 a[146:147], v117 offset:13856
  v_mfma_f32_16x16x32_bf16 v[136:139], a[100:103], a[64:67], 0
  ds_read_b64_tr_b16 a[148:149], v117 offset:9280
  ds_read_b64_tr_b16 a[150:151], v117 offset:13888
  ds_read_b64_tr_b16 a[152:153], v117 offset:9312
  v_mfma_f32_16x16x32_bf16 v[140:143], a[104:107], a[64:67], 0
  ds_read_b64_tr_b16 a[154:155], v117 offset:13920
  ds_read_b128 a[116:119], v118 offset:3072
  ds_read_b128 a[120:123], v118 offset:5120
  v_mfma_f32_16x16x32_bf16 v[144:147], a[92:95], a[68:71], 0
  ds_read_b128 a[124:127], v118 offset:7168
  s_add_u32 s30, s96, 2
  v_mfma_f32_16x16x32_bf16 v[148:151], a[96:99], a[68:71], 0
  s_and_b32 s30, s30, 3
  s_lshl2_add_u32 s29, s89, s30
  v_mfma_f32_16x16x32_bf16 v[152:155], a[100:103], a[68:71], 0
  s_mul_i32 s64, s29, 73728
  v_mfma_f32_16x16x32_bf16 v[156:159], a[104:107], a[68:71], 0
  buffer_load_dwordx4 v251, s[68:71], s64 offen offset:0  lds
  v_mfma_f32_16x16x32_bf16 v[160:163], a[92:95], a[72:75], 0
  buffer_load_dwordx4 v252, s[68:71], s64 offen offset:1024  lds
  v_mfma_f32_16x16x32_bf16 v[164:167], a[96:99], a[72:75], 0
  buffer_load_dwordx4 v253, s[68:71], s64 offen offset:2048  lds
  v_mfma_f32_16x16x32_bf16 v[168:171], a[100:103], a[72:75], 0
  buffer_load_dwordx4 v254, s[68:71], s64 offen offset:3072  lds
  s_add_u32 m0, m0, 4096
  v_mfma_f32_16x16x32_bf16 v[172:175], a[104:107], a[72:75], 0
  buffer_load_dwordx4 v255, s[68:71], s64 offen offset:0  lds
  v_mfma_f32_16x16x32_bf16 v[176:179], a[92:95], a[76:79], 0
  buffer_load_dword v125, v124, s[76:79], 0 offen sc1
  v_mfma_f32_16x16x32_bf16 v[180:183], a[96:99], a[76:79], 0
  s_add_u32 s29, s96, 1
  s_and_b32 s29, s29, 3
  v_mfma_f32_16x16x32_bf16 v[184:187], a[100:103], a[76:79], 0
  s_xor_b32 s29, s29, 1
  s_lshl_b32 s29, s29, 14
  v_mfma_f32_16x16x32_bf16 v[188:191], a[104:107], a[76:79], 0
  v_add_u32 v118, s29, v243
  v_add_u32 v117, 65536, v116
  s_waitcnt lgkmcnt(0) vmcnt(6)
  s_barrier
  buffer_store_dword v127, v126, s[76:79], s88 offen sc1
  v_mfma_f32_16x16x32_bf16 v[128:131], a[140:143], a[112:115], v[128:131]
  ds_read_b64_tr_b16 a[92:93], v117 offset:0
  ds_read_b64_tr_b16 a[94:95], v117 offset:4608
  ds_read_b128 a[64:67], v118 offset:0
  v_mfma_f32_16x16x32_bf16 v[132:135], a[144:147], a[112:115], v[132:135]
  s_add_u32 m0, s67, 145408
  ds_read_b64_tr_b16 a[96:97], v117 offset:32
  ds_read_b64_tr_b16 a[98:99], v117 offset:4640
  v_mfma_f32_16x16x32_bf16 v[136:139], a[148:151], a[112:115], v[136:139]
  ds_read_b64_tr_b16 a[100:101], v117 offset:64
  ds_read_b64_tr_b16 a[102:103], v117 offset:4672
  ds_read_b64_tr_b16 a[104:105], v117 offset:96
  v_mfma_f32_16x16x32_bf16 v[140:143], a[152:155], a[112:115], v[140:143]
  ds_read_b64_tr_b16 a[106:107], v117 offset:4704
  ds_read_b128 a[68:71], v118 offset:2048
  ds_read_b128 a[72:75], v118 offset:4096
  v_mfma_f32_16x16x32_bf16 v[144:147], a[140:143], a[116:119], v[144:147]
  ds_read_b128 a[76:79], v118 offset:6144
  s_add_u32 s30, s96, 3
  v_mfma_f32_16x16x32_bf16 v[148:151], a[144:147], a[116:119], v[148:151]
  s_and_b32 s30, s30, 3
  s_lshl2_add_u32 s29, s89, s30
  v_mfma_f32_16x16x32_bf16 v[152:155], a[148:151], a[116:119], v[152:155]
  s_mul_i32 s64, s29, 73728
  v_mfma_f32_16x16x32_bf16 v[156:159], a[152:155], a[116:119], v[156:159]
  buffer_load_dwordx4 v251, s[68:71], s64 offen offset:0  lds
  v_mfma_f32_16x16x32_bf16 v[160:163], a[140:143], a[120:123], v[160:163]
  v_mfma_f32_16x16x32_bf16 v[164:167], a[144:147], a[120:123], v[164:167]
  v_mfma_f32_16x16x32_bf16 v[168:171], a[148:151], a[120:123], v[168:171]
  buffer_load_dwordx4 v252, s[68:71], s64 offen offset:1024  lds
  v_mfma_f32_16x16x32_bf16 v[172:175], a[152:155], a[120:123], v[172:175]
  v_mfma_f32_16x16x32_bf16 v[176:179], a[140:143], a[124:127], v[176:179]
  v_mfma_f32_16x16x32_bf16 v[180:183], a[144:147], a[124:127], v[180:183]
  buffer_load_dwordx4 v253, s[68:71], s64 offen offset:2048  lds
  v_mfma_f32_16x16x32_bf16 v[184:187], a[148:151], a[124:127], v[184:187]
  v_mfma_f32_16x16x32_bf16 v[188:191], a[152:155], a[124:127], v[188:191]
  buffer_load_dwordx4 v254, s[68:71], s64 offen offset:3072  lds
  s_add_u32 m0, m0, 4096
  s_nop 0
  buffer_load_dwordx4 v255, s[68:71], s64 offen offset:0  lds
  s_and_b32 s30, s52, 15
  s_lshr_b64 s[52:53], s[52:53], 4
  s_and_b32 s51, s54, 15
  s_lshr_b64 s[54:55], s[54:55], 4
  s_lshl_b32 s51, s51, 14
  s_add_u32 s42, s41, 32768
  s_cmp_eq_u32 s42, 163840
  s_cmov_b32 s42, 65536
  s_waitcnt lgkmcnt(0)
  v_mfma_f32_16x16x32_bf16 v[128:131], a[92:95], a[64:67], v[128:131]
  ds_read_b64_tr_b16 a[140:141], v117 offset:9216
  ds_read_b64_tr_b16 a[142:143], v117 offset:13824
  v_mfma_f32_16x16x32_bf16 v[132:135], a[96:99], a[64:67], v[132:135]
  ds_read_b128 a[112:115], v118 offset:1024
  ds_read_b64_tr_b16 a[144:145], v117 offset:9248
  v_mfma_f32_16x16x32_bf16 v[136:139], a[100:103], a[64:67], v[136:139]
  ds_read_b64_tr_b16 a[146:147], v117 offset:13856
  ds_read_b64_tr_b16 a[148:149], v117 offset:9280
  v_mfma_f32_16x16x32_bf16 v[140:143], a[104:107], a[64:67], v[140:143]
  ds_read_b64_tr_b16 a[150:151], v117 offset:13888
  ds_read_b64_tr_b16 a[152:153], v117 offset:9312
  v_mfma_f32_16x16x32_bf16 v[144:147], a[92:95], a[68:71], v[144:147]
  ds_read_b64_tr_b16 a[154:155], v117 offset:13920
  ds_read_b128 a[116:119], v118 offset:3072
  v_mfma_f32_16x16x32_bf16 v[148:151], a[96:99], a[68:71], v[148:151]
  ds_read_b128 a[120:123], v118 offset:5120
  ds_read_b128 a[124:127], v118 offset:7168
  v_mfma_f32_16x16x32_bf16 v[152:155], a[100:103], a[68:71], v[152:155]
  s_mul_i32 s64, s30, 73728
  s_lshl_b32 s65, s30, 11
  v_mfma_f32_16x16x32_bf16 v[156:159], a[104:107], a[68:71], v[156:159]
  s_mov_b32 s40, s41
  s_mov_b32 s41, s42
  v_mfma_f32_16x16x32_bf16 v[160:163], a[92:95], a[72:75], v[160:163]
  s_cmp_ge_u32 s43, 3
  s_cselect_b32 s70, s70, 0
  v_mfma_f32_16x16x32_bf16 v[164:167], a[96:99], a[72:75], v[164:167]
  s_cselect_b32 s74, s74, 0
  v_add_u32 v117, s42, v116
  v_mfma_f32_16x16x32_bf16 v[168:171], a[100:103], a[72:75], v[168:171]
  v_add_u32 v118, s51, v243
  s_sub_u32 s43, s43, 1
  v_mfma_f32_16x16x32_bf16 v[172:175], a[104:107], a[72:75], v[172:175]
  v_mfma_f32_16x16x32_bf16 v[176:179], a[92:95], a[76:79], v[176:179]
  v_mfma_f32_16x16x32_bf16 v[180:183], a[96:99], a[76:79], v[180:183]
  v_mfma_f32_16x16x32_bf16 v[184:187], a[100:103], a[76:79], v[184:187]
  v_mfma_f32_16x16x32_bf16 v[188:191], a[104:107], a[76:79], v[188:191]
  s_waitcnt lgkmcnt(0) vmcnt(6)
  s_barrier
  s_mov_b32 s26, 400000
LG_o0_chk:
  v_cmp_ne_u32 vcc, 0, v125
  s_sub_u32 s26, s26, 1
  s_cbranch_scc1 L1_end
  s_or_b32 s27, vcc_lo, s62
  s_and_b32 s27, s27, 15
  s_cmp_eq_u32 s27, 15
  s_cbranch_scc1 LG_o0_ok
  buffer_load_dword v125, v124, s[76:79], 0 offen sc1
  s_waitcnt vmcnt(0)
  s_branch LG_o0_chk
LG_o0_ok:
  s_branch LG_in0
LG_loop0:
  s_waitcnt lgkmcnt(0) vmcnt(8)
  s_barrier
LG_in0:
  v_mfma_f32_16x16x32_bf16 v[128:131], a[140:143], a[112:115], v[128:131]
  s_add_u32 m0, s40, s48
  ds_read_b64_tr_b16 a[92:93], v117 offset:0
  v_mfma_f32_16x16x32_bf16 v[132:135], a[144:147], a[112:115], v[132:135]
  buffer_load_dwordx4 v251, s[68:71], s64 offen offset:0  lds
  v_mfma_f32_16x16x32_bf16 v[136:139], a[148:151], a[112:115], v[136:139]
  ds_read_b64_tr_b16 a[94:95], v117 offset:4608
  ds_read_b128 a[64:67], v118 offset:0
  v_mfma_f32_16x16x32_bf16 v[140:143], a[152:155], a[112:115], v[140:143]
  ds_read_b64_tr_b16 a[96:97], v117 offset:32
  ds_read_b64_tr_b16 a[98:99], v117 offset:4640
  v_mfma_f32_16x16x32_bf16 v[144:147], a[140:143], a[116:119], v[144:147]
  buffer_load_dwordx4 v252, s[68:71], s64 offen offset:1024  lds
  v_mfma_f32_16x16x32_bf16 v[148:151], a[144:147], a[116:119], v[148:151]
  ds_read_b64_tr_b16 a[100:101], v117 offset:64
  ds_read_b64_tr_b16 a[102:103], v117 offset:4672
  v_mfma_f32_16x16x32_bf16 v[152:155], a[148:151], a[116:119], v[152:155]
  ds_read_b64_tr_b16 a[104:105], v117 offset:96
  ds_read_b64_tr_b16 a[106:107], v117 offset:4704
  v_mfma_f32_16x16x32_bf16 v[156:159], a[152:155], a[116:119], v[156:159]
  ds_read_b128 a[68:71], v118 offset:2048
  ds_read_b128 a[72:75], v118 offset:4096
  v_mfma_f32_16x16x32_bf16 v[160:163], a[140:143], a[120:123], v[160:163]
  ds_read_b128 a[76:79], v118 offset:6144
  s_and_b32 s30, s52, 15
  v_mfma_f32_16x16x32_bf16 v[164:167], a[144:147], a[120:123], v[164:167]
  s_lshr_b64 s[52:53], s[52:53], 4
  v_mfma_f32_16x16x32_bf16 v[168:171], a[148:151], a[120:123], v[168:171]
  buffer_load_dwordx4 v253, s[68:71], s64 offen offset:2048  lds
  v_mfma_f32_16x16x32_bf16 v[172:175], a[152:155], a[120:123], v[172:175]
  s_and_b32 s51, s54, 15
  s_lshr_b64 s[54:55], s[54:55], 4
  v_mfma_f32_16x16x32_bf16 v[176:179], a[140:143], a[124:127], v[176:179]
  s_lshl_b32 s51, s51, 14
  v_mfma_f32_16x16x32_bf16 v[180:183], a[144:147], a[124:127], v[180:183]
  buffer_load_dwordx4 v254, s[68:71], s64 offen offset:3072  lds
  v_mfma_f32_16x16x32_bf16 v[184:187], a[148:151], a[124:127], v[184:187]
  s_add_u32 s42, s41, 32768
  s_cmp_eq_u32 s42, 163840
  v_mfma_f32_16x16x32_bf16 v[188:191], a[152:155], a[124:127], v[188:191]
  s_cmov_b32 s42, 65536
  s_waitcnt lgkmcnt(0)
  v_mfma_f32_16x16x32_bf16 v[128:131], a[92:95], a[64:67], v[128:131]
  s_add_u32 m0, m0, 4096
  ds_read_b64_tr_b16 a[140:141], v117 offset:9216
  v_mfma_f32_16x16x32_bf16 v[132:135], a[96:99], a[64:67], v[132:135]
  buffer_load_dwordx4 v255, s[68:71], s64 offen offset:0  lds
  v_mfma_f32_16x16x32_bf16 v[136:139], a[100:103], a[64:67], v[136:139]
  ds_read_b64_tr_b16 a[142:143], v117 offset:13824
  ds_read_b128 a[112:115], v118 offset:1024
  v_mfma_f32_16x16x32_bf16 v[140:143], a[104:107], a[64:67], v[140:143]
  s_add_u32 m0, s40, 0
  ds_read_b64_tr_b16 a[144:145], v117 offset:9248
  v_mfma_f32_16x16x32_bf16 v[144:147], a[92:95], a[68:71], v[144:147]
  buffer_load_dwordx4 v112, s[72:75], s65 offen offset:0 sc1 lds
  v_mfma_f32_16x16x32_bf16 v[148:151], a[96:99], a[68:71], v[148:151]
  ds_read_b64_tr_b16 a[146:147], v117 offset:13856
  ds_read_b64_tr_b16 a[148:149], v117 offset:9280
  v_mfma_f32_16x16x32_bf16 v[152:155], a[100:103], a[68:71], v[152:155]
  ds_read_b64_tr_b16 a[150:151], v117 offset:13888
  ds_read_b64_tr_b16 a[152:153], v117 offset:9312
  v_mfma_f32_16x16x32_bf16 v[156:159], a[104:107], a[68:71], v[156:159]
  buffer_load_dwordx4 v113, s[72:75], s65 offen offset:1024 sc1 lds
  v_mfma_f32_16x16x32_bf16 v[160:163], a[92:95], a[72:75], v[160:163]
  ds_read_b64_tr_b16 a[154:155], v117 offset:13920
  ds_read_b128 a[116:119], v118 offset:3072
  v_mfma_f32_16x16x32_bf16 v[164:167], a[96:99], a[72:75], v[164:167]
  ds_read_b128 a[120:123], v118 offset:5120
  ds_read_b128 a[124:127], v118 offset:7168
  v_mfma_f32_16x16x32_bf16 v[168:171], a[100:103], a[72:75], v[168:171]
  buffer_load_dwordx4 v114, s[72:75], s65 offen offset:2048 sc1 lds
  v_mfma_f32_16x16x32_bf16 v[172:175], a[104:107], a[72:75], v[172:175]
  s_mul_i32 s64, s30, 73728
  s_lshl_b32 s65, s30, 11
  v_mfma_f32_16x16x32_bf16 v[176:179], a[92:95], a[76:79], v[176:179]
  s_mov_b32 s40, s41
  s_mov_b32 s41, s42
  v_mfma_f32_16x16x32_bf16 v[180:183], a[96:99], a[76:79], v[180:183]
  s_cmp_ge_u32 s43, 3
  s_cselect_b32 s70, s70, 0
  v_mfma_f32_16x16x32_bf16 v[184:187], a[100:103], a[76:79], v[184:187]
  s_cselect_b32 s74, s74, 0
  v_add_u32 v117, s42, v116
  v_mfma_f32_16x16x32_bf16 v[188:191], a[104:107], a[76:79], v[188:191]
  v_add_u32 v118, s51, v243
  s_sub_u32 s43, s43, 1
  s_cbranch_scc0 LG_loop0
  s_waitcnt lgkmcnt(0)
  v_mfma_f32_16x16x32_bf16 v[128:131], a[140:143], a[112:115], v[128:131]
  v_mfma_f32_16x16x32_bf16 v[132:135], a[144:147], a[112:115], v[132:135]
  v_mfma_f32_16x16x32_bf16 v[136:139], a[148:151], a[112:115], v[136:139]
  v_mfma_f32_16x16x32_bf16 v[140:143], a[152:155], a[112:115], v[140:143]
  v_mfma_f32_16x16x32_bf16 v[144:147], a[140:143], a[116:119], v[144:147]
  v_mfma_f32_16x16x32_bf16 v[148:151], a[144:147], a[116:119], v[148:151]
  v_mfma_f32_16x16x32_bf16 v[152:155], a[148:151], a[116:119], v[152:155]
  v_mfma_f32_16x16x32_bf16 v[156:159], a[152:155], a[116:119], v[156:159]
  v_mfma_f32_16x16x32_bf16 v[160:163], a[140:143], a[120:123], v[160:163]
  v_mfma_f32_16x16x32_bf16 v[164:167], a[144:147], a[120:123], v[164:167]
  v_mfma_f32_16x16x32_bf16 v[168:171], a[148:151], a[120:123], v[168:171]
  v_mfma_f32_16x16x32_bf16 v[172:175], a[152:155], a[120:123], v[172:175]
  v_mfma_f32_16x16x32_bf16 v[176:179], a[140:143], a[124:127], v[176:179]
  v_mfma_f32_16x16x32_bf16 v[180:183], a[144:147], a[124:127], v[180:183]
  v_mfma_f32_16x16x32_bf16 v[184:187], a[148:151], a[124:127], v[184:187]
  v_mfma_f32_16x16x32_bf16 v[188:191], a[152:155], a[124:127], v[188:191]
  s_mov_b32 s36, 0
  s_mov_b32 s37, 32
  s_mov_b32 s38, 64
  s_mov_b32 s39, 96
  s_cmp_eq_u32 s97, 1
  s_cmov_b32 s36, 36864
  s_cmov_b32 s37, 36896
  s_cmov_b32 s38, 36928
  s_cmov_b32 s39, 36960
  s_cmp_eq_u32 s97, 2
  s_cmov_b32 s36, 73728
  s_cmov_b32 s37, 73760
  s_cmov_b32 s38, 73792
  s_cmov_b32 s39, 73824
  s_cmp_eq_u32 s97, 3
  s_cmov_b32 s36, 110592
  s_cmov_b32 s37, 110624
  s_cmov_b32 s38, 110656
  s_cmov_b32 s39, 110688
  s_branch LG_fin
LG_w1:
  v_add_u32 v112, 132096, v243
  v_add_u32 v113, 261120, v243
  v_add_u32 v114, 261120, v243
  s_waitcnt vmcnt(16) lgkmcnt(0)
  s_barrier
  ds_read_b64_tr_b16 a[92:93], v117 offset:128
  ds_read_b64_tr_b16 a[94:95], v117 offset:4736
  ds_read_b128 a[64:67], v118 offset:0
  ds_read_b64_tr_b16 a[96:97], v117 offset:160
  ds_read_b64_tr_b16 a[98:99], v117 offset:4768
  ds_read_b64_tr_b16 a[100:101], v117 offset:192
  ds_read_b64_tr_b16 a[102:103], v117 offset:4800
  ds_read_b64_tr_b16 a[104:105], v117 offset:224
  ds_read_b64_tr_b16 a[106:107], v117 offset:4832
  ds_read_b128 a[68:71], v118 offset:2048
  ds_read_b128 a[72:75], v118 offset:4096
  ds_read_b128 a[76:79], v118 offset:6144
  s_add_u32 m0, s67, 79872
  s_add_u32 s30, s96, 1
  s_and_b32 s30, s30, 3
  s_lshl2_add_u32 s29, s89, s30
  s_mul_i32 s64, s29, 73728
  buffer_load_dwordx4 v251, s[68:71], s64 offen offset:0  lds
  buffer_load_dwordx4 v252, s[68:71], s64 offen offset:1024  lds
  buffer_load_dwordx4 v253, s[68:71], s64 offen offset:2048  lds
  buffer_load_dwordx4 v254, s[68:71], s64 offen offset:3072  lds
  s_add_u32 m0, m0, 4096
  s_nop 0
  buffer_load_dwordx4 v255, s[68:71], s64 offen offset:0  lds
  s_waitcnt lgkmcnt(0)
  v_mfma_f32_16x16x32_bf16 v[128:131], a[92:95], a[64:67], 0
  s_add_u32 m0, s67, 112640
  ds_read_b64_tr_b16 a[140:141], v117 offset:9344
  ds_read_b64_tr_b16 a[142:143], v117 offset:13952
  v_mfma_f32_16x16x32_bf16 v[132:135], a[96:99], a[64:67], 0
  ds_read_b128 a[112:115], v118 offset:1024
  ds_read_b64_tr_b16 a[144:145], v117 offset:9376
  ds_read_b64_tr_b16 a[146:147], v117 offset:13984
  v_mfma_f32_16x16x32_bf16 v[136:139], a[100:103], a[64:67], 0
  ds_read_b64_tr_b16 a[148:149], v117 offset:9408
  ds_read_b64_tr_b16 a[150:151], v117 offset:14016
  ds_read_b64_tr_b16 a[152:153], v117 offset:9440
  v_mfma_f32_16x16x32_bf16 v[140:143], a[104:107], a[64:67], 0
  ds_read_b64_tr_b16 a[154:155], v117 offset:14048
  ds_read_b128 a[116:119], v118 offset:3072
  ds_read_b128 a[120:123], v118 offset:5120
  v_mfma_f32_16x16x32_bf16 v[144:147], a[92:95], a[68:71], 0
  ds_read_b128 a[124:127], v118 offset:7168
  s_add_u32 s30, s96, 2
  v_mfma_f32_16x16x32_bf16 v[148:151], a[96:99], a[68:71], 0
  s_and_b32 s30, s30, 3
  s_lshl2_add_u32 s29, s89, s30
  v_mfma_f32_16x16x32_bf16 v[152:155], a[100:103], a[68:71], 0
  s_mul_i32 s64, s29, 73728
  v_mfma_f32_16x16x32_bf16 v[156:159], a[104:107], a[68:71], 0
  buffer_load_dwordx4 v251, s[68:71], s64 offen offset:0  lds
  v_mfma_f32_16x16x32_bf16 v[160:163], a[92:95], a[72:75], 0
  buffer_load_dwordx4 v252, s[68:71], s64 offen offset:1024  lds
  v_mfma_f32_16x16x32_bf16 v[164:167], a[96:99], a[72:75], 0
  buffer_load_dwordx4 v253, s[68:71], s64 offen offset:2048  lds
  v_mfma_f32_16x16x32_bf16 v[168:171], a[100:103], a[72:75], 0
  buffer_load_dwordx4 v254, s[68:71], s64 offen offset:3072  lds
  s_add_u32 m0, m0, 4096
  v_mfma_f32_16x16x32_bf16 v[172:175], a[104:107], a[72:75], 0
  buffer_load_dwordx4 v255, s[68:71], s64 offen offset:0  lds
  v_mfma_f32_16x16x32_bf16 v[176:179], a[92:95], a[76:79], 0
  buffer_load_dword v125, v124, s[76:79], 0 offen sc1
  v_mfma_f32_16x16x32_bf16 v[180:183], a[96:99], a[76:79], 0
  s_add_u32 s29, s96, 1
  s_and_b32 s29, s29, 3
  v_mfma_f32_16x16x32_bf16 v[184:187], a[100:103], a[76:79], 0
  s_xor_b32 s29, s29, 1
  s_lshl_b32 s29, s29, 14
  v_mfma_f32_16x16x32_bf16 v[188:191], a[104:107], a[76:79], 0
  v_add_u32 v118, s29, v243
  v_add_u32 v117, 65536, v116
  s_waitcnt lgkmcnt(0) vmcnt(6)
  s_barrier
  v_mfma_f32_16x16x32_bf16 v[128:131], a[140:143], a[112:115], v[128:131]
  ds_read_b64_tr_b16 a[92:93], v117 offset:128
  ds_read_b64_tr_b16 a[94:95], v117 offset:4736
  ds_read_b128 a[64:67], v118 offset:0
  v_mfma_f32_16x16x32_bf16 v[132:135], a[144:147], a[112:115], v[132:135]
  s_add_u32 m0, s67, 145408
  ds_read_b64_tr_b16 a[96:97], v117 offset:160
  ds_read_b64_tr_b16 a[98:99], v117 offset:4768
  v_mfma_f32_16x16x32_bf16 v[136:139], a[148:151], a[112:115], v[136:139]
  ds_read_b64_tr_b16 a[100:101], v117 offset:192
  ds_read_b64_tr_b16 a[102:103], v117 offset:4800
  ds_read_b64_tr_b16 a[104:105], v117 offset:224
  v_mfma_f32_16x16x32_bf16 v[140:143], a[152:155], a[112:115], v[140:143]
  ds_read_b64_tr_b16 a[106:107], v117 offset:4832
  ds_read_b128 a[68:71], v118 offset:2048
  ds_read_b128 a[72:75], v118 offset:4096
  v_mfma_f32_16x16x32_bf16 v[144:147], a[140:143], a[116:119], v[144:147]
  ds_read_b128 a[76:79], v118 offset:6144
  s_add_u32 s30, s96, 3
  v_mfma_f32_16x16x32_bf16 v[148:151], a[144:147], a[116:119], v[148:151]
  s_and_b32 s30, s30, 3
  s_lshl2_add_u32 s29, s89, s30
  v_mfma_f32_16x16x32_bf16 v[152:155], a[148:151], a[116:119], v[152:155]
  s_mul_i32 s64, s29, 73728
  v_mfma_f32_16x16x32_bf16 v[156:159], a[152:155], a[116:119], v[156:159]
  buffer_load_dwordx4 v251, s[68:71], s64 offen offset:0  lds
  v_mfma_f32_16x16x32_bf16 v[160:163], a[140:143], a[120:123], v[160:163]
  v_mfma_f32_16x16x32_bf16 v[164:167], a[144:147], a[120:123], v[164:167]
  v_mfma_f32_16x16x32_bf16 v[168:171], a[148:151], a[120:123], v[168:171]
  buffer_load_dwordx4 v252, s[68:71], s64 offen offset:1024  lds
  v_mfma_f32_16x16x32_bf16 v[172:175], a[152:155], a[120:123], v[172:175]
  v_mfma_f32_16x16x32_bf16 v[176:179], a[140:143], a[124:127], v[176:179]
  v_mfma_f32_16x16x32_bf16 v[180:183], a[144:147], a[124:127], v[180:183]
  buffer_load_dwordx4 v253, s[68:71], s64 offen offset:2048  lds
  v_mfma_f32_16x16x32_bf16 v[184:187], a[148:151], a[124:127], v[184:187]
  v_mfma_f32_16x16x32_bf16 v[188:191], a[152:155], a[124:127], v[188:191]
  buffer_load_dwordx4 v254, s[68:71], s64 offen offset:3072  lds
  s_add_u32 m0, m0, 4096
  s_nop 0
  buffer_load_dwordx4 v255, s[68:71], s64 offen offset:0  lds
  s_and_b32 s30, s52, 15
  s_lshr_b64 s[52:53], s[52:53], 4
  s_and_b32 s51, s54, 15
  s_lshr_b64 s[54:55], s[54:55], 4
  s_lshl_b32 s51, s51, 14
  s_add_u32 s42, s41, 32768
  s_cmp_eq_u32 s42, 163840
  s_cmov_b32 s42, 65536
  s_waitcnt lgkmcnt(0)
  v_mfma_f32_16x16x32_bf16 v[128:131], a[92:95], a[64:67], v[128:131]
  ds_read_b64_tr_b16 a[140:141], v117 offset:9344
  ds_read_b64_tr_b16 a[142:143], v117 offset:13952
  v_mfma_f32_16x16x32_bf16 v[132:135], a[96:99], a[64:67], v[132:135]
  ds_read_b128 a[112:115], v118 offset:1024
  ds_read_b64_tr_b16 a[144:145], v117 offset:9376
  v_mfma_f32_16x16x32_bf16 v[136:139], a[100:103], a[64:67], v[136:139]
  ds_read_b64_tr_b16 a[146:147], v117 offset:13984
  ds_read_b64_tr_b16 a[148:149], v117 offset:9408
  v_mfma_f32_16x16x32_bf16 v[140:143], a[104:107], a[64:67], v[140:143]
  ds_read_b64_tr_b16 a[150:151], v117 offset:14016
  ds_read_b64_tr_b16 a[152:153], v117 offset:9440
  v_mfma_f32_16x16x32_bf16 v[144:147], a[92:95], a[68:71], v[144:147]
  ds_read_b64_tr_b16 a[154:155], v117 offset:14048
  ds_read_b128 a[116:119], v118 offset:3072
  v_mfma_f32_16x16x32_bf16 v[148:151], a[96:99], a[68:71], v[148:151]
  ds_read_b128 a[120:123], v118 offset:5120
  ds_read_b128 a[124:127], v118 offset:7168
  v_mfma_f32_16x16x32_bf16 v[152:155], a[100:103], a[68:71], v[152:155]
  s_mul_i32 s64, s30, 73728
  s_lshl_b32 s65, s30, 11
  v_mfma_f32_16x16x32_bf16 v[156:159], a[104:107], a[68:71], v[156:159]
  s_mov_b32 s40, s41
  s_mov_b32 s41, s42
  v_mfma_f32_16x16x32_bf16 v[160:163], a[92:95], a[72:75], v[160:163]
  s_cmp_ge_u32 s43, 3
  s_cselect_b32 s70, s70, 0
  v_mfma_f32_16x16x32_bf16 v[164:167], a[96:99], a[72:75], v[164:167]
  s_cselect_b32 s74, s74, 0
  v_add_u32 v117, s42, v116
  v_mfma_f32_16x16x32_bf16 v[168:171], a[100:103], a[72:75], v[168:171]
  v_add_u32 v118, s51, v243
  s_sub_u32 s43, s43, 1
  v_mfma_f32_16x16x32_bf16 v[172:175], a[104:107], a[72:75], v[172:175]
  v_mfma_f32_16x16x32_bf16 v[176:179], a[92:95], a[76:79], v[176:179]
  v_mfma_f32_16x16x32_bf16 v[180:183], a[96:99], a[76:79], v[180:183]
  v_mfma_f32_16x16x32_bf16 v[184:187], a[100:103], a[76:79], v[184:187]
  v_mfma_f32_16x16x32_bf16 v[188:191], a[104:107], a[76:79], v[188:191]
  s_waitcnt lgkmcnt(0) vmcnt(5)
  s_barrier
  s_mov_b32 s26, 400000
LG_o1_chk:
  v_cmp_ne_u32 vcc, 0, v125
  s_sub_u32 s26, s26, 1
  s_cbranch_scc1 L1_end
  s_or_b32 s27, vcc_lo, s62
  s_and_b32 s27, s27, 15
  s_cmp_eq_u32 s27, 15
  s_cbranch_scc1 LG_o1_ok
  buffer_load_dword v125, v124, s[76:79], 0 offen sc1
  s_waitcnt vmcnt(0)
  s_branch LG_o1_chk
LG_o1_ok:
  s_branch LG_in1
LG_loop1:
  s_waitcnt lgkmcnt(0) vmcnt(8)
  s_barrier
LG_in1:
  v_mfma_f32_16x16x32_bf16 v[128:131], a[140:143], a[112:115], v[128:131]
  s_add_u32 m0, s40, s48
  ds_read_b64_tr_b16 a[92:93], v117 offset:128
  v_mfma_f32_16x16x32_bf16 v[132:135], a[144:147], a[112:115], v[132:135]
  buffer_load_dwordx4 v251, s[68:71], s64 offen offset:0  lds
  v_mfma_f32_16x16x32_bf16 v[136:139], a[148:151], a[112:115], v[136:139]
  ds_read_b64_tr_b16 a[94:95], v117 offset:4736
  ds_read_b128 a[64:67], v118 offset:0
  v_mfma_f32_16x16x32_bf16 v[140:143], a[152:155], a[112:115], v[140:143]
  ds_read_b64_tr_b16 a[96:97], v117 offset:160
  ds_read_b64_tr_b16 a[98:99], v117 offset:4768
  v_mfma_f32_16x16x32_bf16 v[144:147], a[140:143], a[116:119], v[144:147]
  buffer_load_dwordx4 v252, s[68:71], s64 offen offset:1024  lds
  v_mfma_f32_16x16x32_bf16 v[148:151], a[144:147], a[116:119], v[148:151]
  ds_read_b64_tr_b16 a[100:101], v117 offset:192
  ds_read_b64_tr_b16 a[102:103], v117 offset:4800
  v_mfma_f32_16x16x32_bf16 v[152:155], a[148:151], a[116:119], v[152:155]
  ds_read_b64_tr_b16 a[104:105], v117 offset:224
  ds_read_b64_tr_b16 a[106:107], v117 offset:4832
  v_mfma_f32_16x16x32_bf16 v[156:159], a[152:155], a[116:119], v[156:159]
  ds_read_b128 a[68:71], v118 offset:2048
  ds_read_b128 a[72:75], v118 offset:4096
  v_mfma_f32_16x16x32_bf16 v[160:163], a[140:143], a[120:123], v[160:163]
  ds_read_b128 a[76:79], v118 offset:6144
  s_and_b32 s30, s52, 15
  v_mfma_f32_16x16x32_bf16 v[164:167], a[144:147], a[120:123], v[164:167]
  s_lshr_b64 s[52:53], s[52:53], 4
  v_mfma_f32_16x16x32_bf16 v[168:171], a[148:151], a[120:123], v[168:171]
  buffer_load_dwordx4 v253, s[68:71], s64 offen offset:2048  lds
  v_mfma_f32_16x16x32_bf16 v[172:175], a[152:155], a[120:123], v[172:175]
  s_and_b32 s51, s54, 15
  s_lshr_b64 s[54:55], s[54:55], 4
  v_mfma_f32_16x16x32_bf16 v[176:179], a[140:143], a[124:127], v[176:179]
  s_lshl_b32 s51, s51, 14
  v_mfma_f32_16x16x32_bf16 v[180:183], a[144:147], a[124:127], v[180:183]
  buffer_load_dwordx4 v254, s[68:71], s64 offen offset:3072  lds
  v_mfma_f32_16x16x32_bf16 v[184:187], a[148:151], a[124:127], v[184:187]
  s_add_u32 s42, s41, 32768
  s_cmp_eq_u32 s42, 163840
  v_mfma_f32_16x16x32_bf16 v[188:191], a[152:155], a[124:127], v[188:191]
  s_cmov_b32 s42, 65536
  s_waitcnt lgkmcnt(0)
  v_mfma_f32_16x16x32_bf16 v[128:131], a[92:95], a[64:67], v[128:131]
  s_add_u32 m0, m0, 4096
  ds_read_b64_tr_b16 a[140:141], v117 offset:9344
  v_mfma_f32_16x16x32_bf16 v[132:135], a[96:99], a[64:67], v[132:135]
  buffer_load_dwordx4 v255, s[68:71], s64 offen offset:0  lds
  v_mfma_f32_16x16x32_bf16 v[136:139], a[100:103], a[64:67], v[136:139]
  ds_read_b64_tr_b16 a[142:143], v117 offset:13952
  ds_read_b128 a[112:115], v118 offset:1024
  v_mfma_f32_16x16x32_bf16 v[140:143], a[104:107], a[64:67], v[140:143]
  s_add_u32 m0, s40, 3072
  ds_read_b64_tr_b16 a[144:145], v117 offset:9376
  v_mfma_f32_16x16x32_bf16 v[144:147], a[92:95], a[68:71], v[144:147]
  buffer_load_dwordx4 v112, s[72:75], s65 offen offset:0 sc1 lds
  v_mfma_f32_16x16x32_bf16 v[148:151], a[96:99], a[68:71], v[148:151]
  ds_read_b64_tr_b16 a[146:147], v117 offset:13984
  ds_read_b64_tr_b16 a[148:149], v117 offset:9408
  v_mfma_f32_16x16x32_bf16 v[152:155], a[100:103], a[68:71], v[152:155]
  ds_read_b64_tr_b16 a[150:151], v117 offset:14016
  ds_read_b64_tr_b16 a[152:153], v117 offset:9440
  v_mfma_f32_16x16x32_bf16 v[156:159], a[104:107], a[68:71], v[156:159]
  buffer_load_dwordx4 v113, s[72:75], s65 offen offset:1024 sc1 lds
  v_mfma_f32_16x16x32_bf16 v[160:163], a[92:95], a[72:75], v[160:163]
  ds_read_b64_tr_b16 a[154:155], v117 offset:14048
  ds_read_b128 a[116:119], v118 offset:3072
  v_mfma_f32_16x16x32_bf16 v[164:167], a[96:99], a[72:75], v[164:167]
  ds_read_b128 a[120:123], v118 offset:5120
  ds_read_b128 a[124:127], v118 offset:7168
  v_mfma_f32_16x16x32_bf16 v[168:171], a[100:103], a[72:75], v[168:171]
  buffer_load_dwordx4 v114, s[72:75], s65 offen offset:2048 sc1 lds
  v_mfma_f32_16x16x32_bf16 v[172:175], a[104:107], a[72:75], v[172:175]
  s_mul_i32 s64, s30, 73728
  s_lshl_b32 s65, s30, 11
  v_mfma_f32_16x16x32_bf16 v[176:179], a[92:95], a[76:79], v[176:179]
  s_mov_b32 s40, s41
  s_mov_b32 s41, s42
  v_mfma_f32_16x16x32_bf16 v[180:183], a[96:99], a[76:79], v[180:183]
  s_cmp_ge_u32 s43, 3
  s_cselect_b32 s70, s70, 0
  v_mfma_f32_16x16x32_bf16 v[184:187], a[100:103], a[76:79], v[184:187]
  s_cselect_b32 s74, s74, 0
  v_add_u32 v117, s42, v116
  v_mfma_f32_16x16x32_bf16 v[188:191], a[104:107], a[76:79], v[188:191]
  v_add_u32 v118, s51, v243
  s_sub_u32 s43, s43, 1
  s_cbranch_scc0 LG_loop1
  s_waitcnt lgkmcnt(0)
  v_mfma_f32_16x16x32_bf16 v[128:131], a[140:143], a[112:115], v[128:131]
  v_mfma_f32_16x16x32_bf16 v[132:135], a[144:147], a[112:115], v[132:135]
  v_mfma_f32_16x16x32_bf16 v[136:139], a[148:151], a[112:115], v[136:139]
  v_mfma_f32_16x16x32_bf16 v[140:143], a[152:155], a[112:115], v[140:143]
  v_mfma_f32_16x16x32_bf16 v[144:147], a[140:143], a[116:119], v[144:147]
  v_mfma_f32_16x16x32_bf16 v[148:151], a[144:147], a[116:119], v[148:151]
  v_mfma_f32_16x16x32_bf16 v[152:155], a[148:151], a[116:119], v[152:155]
  v_mfma_f32_16x16x32_bf16 v[156:159], a[152:155], a[116:119], v[156:159]
  v_mfma_f32_16x16x32_bf16 v[160:163], a[140:143], a[120:123], v[160:163]
  v_mfma_f32_16x16x32_bf16 v[164:167], a[144:147], a[120:123], v[164:167]
  v_mfma_f32_16x16x32_bf16 v[168:171], a[148:151], a[120:123], v[168:171]
  v_mfma_f32_16x16x32_bf16 v[172:175], a[152:155], a[120:123], v[172:175]
  v_mfma_f32_16x16x32_bf16 v[176:179], a[140:143], a[124:127], v[176:179]
  v_mfma_f32_16x16x32_bf16 v[180:183], a[144:147], a[124:127], v[180:183]
  v_mfma_f32_16x16x32_bf16 v[184:187], a[148:151], a[124:127], v[184:187]
  v_mfma_f32_16x16x32_bf16 v[188:191], a[152:155], a[124:127], v[188:191]
  s_mov_b32 s36, 128
  s_mov_b32 s37, 160
  s_mov_b32 s38, 192
  s_mov_b32 s39, 224
  s_cmp_eq_u32 s97, 1
  s_cmov_b32 s36, 36992
  s_cmov_b32 s37, 37024
  s_cmov_b32 s38, 37056
  s_cmov_b32 s39, 37088
  s_cmp_eq_u32 s97, 2
  s_cmov_b32 s36, 73856
  s_cmov_b32 s37, 73888
  s_cmov_b32 s38, 73920
  s_cmov_b32 s39, 73952
  s_cmp_eq_u32 s97, 3
  s_cmov_b32 s36, 110720
  s_cmov_b32 s37, 110752
  s_cmov_b32 s38, 110784
  s_cmov_b32 s39, 110816
  s_branch LG_fin
LG_w2:
  v_add_u32 v112, 393216, v243
  v_add_u32 v113, 393216, v243
  v_add_u32 v114, 522240, v243
  v_add_u32 v115, 522240, v243
  s_waitcnt vmcnt(16) lgkmcnt(0)
  s_barrier
  ds_read_b64_tr_b16 a[92:93], v117 offset:0
  ds_read_b64_tr_b16 a[94:95], v117 offset:4608
  ds_read_b128 a[64:67], v118 offset:8192
  ds_read_b64_tr_b16 a[96:97], v117 offset:32
  ds_read_b64_tr_b16 a[98:99], v117 offset:4640
  ds_read_b64_tr_b16 a[100:101], v117 offset:64
  ds_read_b64_tr_b16 a[102:103], v117 offset:4672
  ds_read_b64_tr_b16 a[104:105], v117 offset:96
  ds_read_b64_tr_b16 a[106:107], v117 offset:4704
  ds_read_b128 a[68:71], v118 offset:10240
  ds_read_b128 a[72:75], v118 offset:12288
  ds_read_b64_tr_b16 a[108:109], v117 offset:128
  ds_read_b64_tr_b16 a[110:111], v117 offset:4736
  s_add_u32 m0, s67, 79872
  s_add_u32 s30, s96, 1
  s_and_b32 s30, s30, 3
  s_lshl2_add_u32 s29, s89, s30
  s_mul_i32 s64, s29, 73728
  buffer_load_dwordx4 v251, s[68:71], s64 offen offset:0  lds
  buffer_load_dwordx4 v252, s[68:71], s64 offen offset:1024  lds
  buffer_load_dwordx4 v253, s[68:71], s64 offen offset:2048  lds
  buffer_load_dwordx4 v254, s[68:71], s64 offen offset:3072  lds
  s_waitcnt lgkmcnt(0)
  v_mfma_f32_16x16x32_bf16 v[128:131], a[92:95], a[64:67], 0
  s_add_u32 m0, s67, 112640
  ds_read_b64_tr_b16 a[140:141], v117 offset:9216
  ds_read_b64_tr_b16 a[142:143], v117 offset:13824
  v_mfma_f32_16x16x32_bf16 v[132:135], a[96:99], a[64:67], 0
  ds_read_b128 a[112:115], v118 offset:9216
  ds_read_b64_tr_b16 a[144:145], v117 offset:9248
  ds_read_b64_tr_b16 a[146:147], v117 offset:13856
  v_mfma_f32_16x16x32_bf16 v[136:139], a[100:103], a[64:67], 0
  ds_read_b64_tr_b16 a[148:149], v117 offset:9280
  ds_read_b64_tr_b16 a[150:151], v117 offset:13888
  ds_read_b64_tr_b16 a[152:153], v117 offset:9312
  v_mfma_f32_16x16x32_bf16 v[140:143], a[104:107], a[64:67], 0
  ds_read_b64_tr_b16 a[154:155], v117 offset:13920
  ds_read_b128 a[116:119], v118 offset:11264
  ds_read_b128 a[120:123], v118 offset:13312
  v_mfma_f32_16x16x32_bf16 v[144:147], a[92:95], a[68:71], 0
  ds_read_b64_tr_b16 a[156:157], v117 offset:9344
  ds_read_b64_tr_b16 a[158:159], v117 offset:13952
  v_mfma_f32_16x16x32_bf16 v[148:151], a[96:99], a[68:71], 0
  s_add_u32 s30, s96, 2
  s_and_b32 s30, s30, 3
  v_mfma_f32_16x16x32_bf16 v[152:155], a[100:103], a[68:71], 0
  s_lshl2_add_u32 s29, s89, s30
  s_mul_i32 s64, s29, 73728
  v_mfma_f32_16x16x32_bf16 v[156:159], a[104:107], a[68:71], 0
  buffer_load_dwordx4 v251, s[68:71], s64 offen offset:0  lds
  v_mfma_f32_16x16x32_bf16 v[160:163], a[92:95], a[72:75], 0
  v_mfma_f32_16x16x32_bf16 v[164:167], a[96:99], a[72:75], 0
  v_mfma_f32_16x16x32_bf16 v[168:171], a[100:103], a[72:75], 0
  buffer_load_dwordx4 v252, s[68:71], s64 offen offset:1024  lds
  v_mfma_f32_16x16x32_bf16 v[172:175], a[104:107], a[72:75], 0
  v_mfma_f32_16x16x32_bf16 v[176:179], a[108:111], a[64:67], 0
  v_mfma_f32_16x16x32_bf16 v[180:183], a[108:111], a[68:71], 0
  buffer_load_dwordx4 v253, s[68:71], s64 offen offset:2048  lds
  v_mfma_f32_16x16x32_bf16 v[184:187], a[108:111], a[72:75], 0
  buffer_load_dwordx4 v254, s[68:71], s64 offen offset:3072  lds
  buffer_load_dword v125, v124, s[76:79], 0 offen sc1
  s_add_u32 s29, s96, 1
  s_and_b32 s29, s29, 3
  s_xor_b32 s29, s29, 1
  s_lshl_b32 s29, s29, 14
  v_add_u32 v118, s29, v243
  v_add_u32 v117, 65536, v116
  s_waitcnt lgkmcnt(0) vmcnt(5)
  s_barrier
  v_mfma_f32_16x16x32_bf16 v[128:131], a[140:143], a[112:115], v[128:131]
  ds_read_b64_tr_b16 a[92:93], v117 offset:0
  ds_read_b64_tr_b16 a[94:95], v117 offset:4608
  ds_read_b128 a[64:67], v118 offset:8192
  v_mfma_f32_16x16x32_bf16 v[132:135], a[144:147], a[112:115], v[132:135]
  s_add_u32 m0, s67, 145408
  ds_read_b64_tr_b16 a[96:97], v117 offset:32
  ds_read_b64_tr_b16 a[98:99], v117 offset:4640
  v_mfma_f32_16x16x32_bf16 v[136:139], a[148:151], a[112:115], v[136:139]
  ds_read_b64_tr_b16 a[100:101], v117 offset:64
  ds_read_b64_tr_b16 a[102:103], v117 offset:4672
  ds_read_b64_tr_b16 a[104:105], v117 offset:96
  v_mfma_f32_16x16x32_bf16 v[140:143], a[152:155], a[112:115], v[140:143]
  ds_read_b64_tr_b16 a[106:107], v117 offset:4704
  ds_read_b128 a[68:71], v118 offset:10240
  ds_read_b128 a[72:75], v118 offset:12288
  v_mfma_f32_16x16x32_bf16 v[144:147], a[140:143], a[116:119], v[144:147]
  ds_read_b64_tr_b16 a[108:109], v117 offset:128
  ds_read_b64_tr_b16 a[110:111], v117 offset:4736
  v_mfma_f32_16x16x32_bf16 v[148:151], a[144:147], a[116:119], v[148:151]
  s_add_u32 s30, s96, 3
  s_and_b32 s30, s30, 3
  v_mfma_f32_16x16x32_bf16 v[152:155], a[148:151], a[116:119], v[152:155]
  s_lshl2_add_u32 s29, s89, s30
  s_mul_i32 s64, s29, 73728
  v_mfma_f32_16x16x32_bf16 v[156:159], a[152:155], a[116:119], v[156:159]
  buffer_load_dwordx4 v251, s[68:71], s64 offen offset:0  lds
  v_mfma_f32_16x16x32_bf16 v[160:163], a[140:143], a[120:123], v[160:163]
  v_mfma_f32_16x16x32_bf16 v[164:167], a[144:147], a[120:123], v[164:167]
  v_mfma_f32_16x16x32_bf16 v[168:171], a[148:151], a[120:123], v[168:171]
  buffer_load_dwordx4 v252, s[68:71], s64 offen offset:1024  lds
  v_mfma_f32_16x16x32_bf16 v[172:175], a[152:155], a[120:123], v[172:175]
  v_mfma_f32_16x16x32_bf16 v[176:179], a[156:159], a[112:115], v[176:179]
  v_mfma_f32_16x16x32_bf16 v[180:183], a[156:159], a[116:119], v[180:183]
  buffer_load_dwordx4 v253, s[68:71], s64 offen offset:2048  lds
  v_mfma_f32_16x16x32_bf16 v[184:187], a[156:159], a[120:123], v[184:187]
  buffer_load_dwordx4 v254, s[68:71], s64 offen offset:3072  lds
  s_and_b32 s30, s52, 15
  s_lshr_b64 s[52:53], s[52:53], 4
  s_and_b32 s51, s54, 15
  s_lshr_b64 s[54:55], s[54:55], 4
  s_lshl_b32 s51, s51, 14
  s_add_u32 s42, s41, 32768
  s_cmp_eq_u32 s42, 163840
  s_cmov_b32 s42, 65536
  s_waitcnt lgkmcnt(0)
  v_mfma_f32_16x16x32_bf16 v[128:131], a[92:95], a[64:67], v[128:131]
  ds_read_b64_tr_b16 a[140:141], v117 offset:9216
  ds_read_b64_tr_b16 a[142:143], v117 offset:13824
  v_mfma_f32_16x16x32_bf16 v[132:135], a[96:99], a[64:67], v[132:135]
  ds_read_b128 a[112:115], v118 offset:9216
  ds_read_b64_tr_b16 a[144:145], v117 offset:9248
  v_mfma_f32_16x16x32_bf16 v[136:139], a[100:103], a[64:67], v[136:139]
  ds_read_b64_tr_b16 a[146:147], v117 offset:13856
  ds_read_b64_tr_b16 a[148:149], v117 offset:9280
  v_mfma_f32_16x16x32_bf16 v[140:143], a[104:107], a[64:67], v[140:143]
  ds_read_b64_tr_b16 a[150:151], v117 offset:13888
  ds_read_b64_tr_b16 a[152:153], v117 offset:9312
  v_mfma_f32_16x16x32_bf16 v[144:147], a[92:95], a[68:71], v[144:147]
  ds_read_b64_tr_b16 a[154:155], v117 offset:13920
  ds_read_b128 a[116:119], v118 offset:11264
  v_mfma_f32_16x16x32_bf16 v[148:151], a[96:99], a[68:71], v[148:151]
  ds_read_b128 a[120:123], v118 offset:13312
  ds_read_b64_tr_b16 a[156:157], v117 offset:9344
  v_mfma_f32_16x16x32_bf16 v[152:155], a[100:103], a[68:71], v[152:155]
  ds_read_b64_tr_b16 a[158:159], v117 offset:13952
  s_mul_i32 s64, s30, 73728
  v_mfma_f32_16x16x32_bf16 v[156:159], a[104:107], a[68:71], v[156:159]
  s_lshl_b32 s65, s30, 11
  s_mov_b32 s40, s41
  v_mfma_f32_16x16x32_bf16 v[160:163], a[92:95], a[72:75], v[160:163]
  s_mov_b32 s41, s42
  s_cmp_ge_u32 s43, 3
  v_mfma_f32_16x16x32_bf16 v[164:167], a[96:99], a[72:75], v[164:167]
  s_cselect_b32 s70, s70, 0
  s_cselect_b32 s74, s74, 0
  v_mfma_f32_16x16x32_bf16 v[168:171], a[100:103], a[72:75], v[168:171]
  v_add_u32 v117, s42, v116
  v_add_u32 v118, s51, v243
  v_mfma_f32_16x16x32_bf16 v[172:175], a[104:107], a[72:75], v[172:175]
  s_sub_u32 s43, s43, 1
  v_mfma_f32_16x16x32_bf16 v[176:179], a[108:111], a[64:67], v[176:179]
  v_mfma_f32_16x16x32_bf16 v[180:183], a[108:111], a[68:71], v[180:183]
  v_mfma_f32_16x16x32_bf16 v[184:187], a[108:111], a[72:75], v[184:187]
  s_waitcnt lgkmcnt(0) vmcnt(4)
  s_barrier
  s_mov_b32 s26, 400000
LG_o2_chk:
  v_cmp_ne_u32 vcc, 0, v125
  s_sub_u32 s26, s26, 1
  s_cbranch_scc1 L1_end
  s_or_b32 s27, vcc_lo, s62
  s_and_b32 s27, s27, 15
  s_cmp_eq_u32 s27, 15
  s_cbranch_scc1 LG_o2_ok
  buffer_load_dword v125, v124, s[76:79], 0 offen sc1
  s_waitcnt vmcnt(0)
  s_branch LG_o2_chk
LG_o2_ok:
  s_branch LG_in2
LG_loop2:
  s_waitcnt lgkmcnt(0) vmcnt(8)
  s_barrier
LG_in2:
  v_mfma_f32_16x16x32_bf16 v[128:131], a[140:143], a[112:115], v[128:131]
  s_add_u32 m0, s40, s48
  ds_read_b64_tr_b16 a[92:93], v117 offset:0
  v_mfma_f32_16x16x32_bf16 v[132:135], a[144:147], a[112:115], v[132:135]
  buffer_load_dwordx4 v251, s[68:71], s64 offen offset:0  lds
  v_mfma_f32_16x16x32_bf16 v[136:139], a[148:151], a[112:115], v[136:139]
  ds_read_b64_tr_b16 a[94:95], v117 offset:4608
  ds_read_b128 a[64:67], v118 offset:8192
  v_mfma_f32_16x16x32_bf16 v[140:143], a[152:155], a[112:115], v[140:143]
  ds_read_b64_tr_b16 a[96:97], v117 offset:32
  ds_read_b64_tr_b16 a[98:99], v117 offset:4640
  v_mfma_f32_16x16x32_bf16 v[144:147], a[140:143], a[116:119], v[144:147]
  buffer_load_dwordx4 v252, s[68:71], s64 offen offset:1024  lds
  v_mfma_f32_16x16x32_bf16 v[148:151], a[144:147], a[116:119], v[148:151]
  ds_read_b64_tr_b16 a[100:101], v117 offset:64
  ds_read_b64_tr_b16 a[102:103], v117 offset:4672
  v_mfma_f32_16x16x32_bf16 v[152:155], a[148:151], a[116:119], v[152:155]
  ds_read_b64_tr_b16 a[104:105], v117 offset:96
  ds_read_b64_tr_b16 a[106:107], v117 offset:4704
  v_mfma_f32_16x16x32_bf16 v[156:159], a[152:155], a[116:119], v[156:159]
  ds_read_b128 a[68:71], v118 offset:10240
  ds_read_b128 a[72:75], v118 offset:12288
  v_mfma_f32_16x16x32_bf16 v[160:163], a[140:143], a[120:123], v[160:163]
  ds_read_b64_tr_b16 a[108:109], v117 offset:128
  ds_read_b64_tr_b16 a[110:111], v117 offset:4736
  v_mfma_f32_16x16x32_bf16 v[164:167], a[144:147], a[120:123], v[164:167]
  s_and_b32 s30, s52, 15
  s_lshr_b64 s[52:53], s[52:53], 4
  v_mfma_f32_16x16x32_bf16 v[168:171], a[148:151], a[120:123], v[168:171]
  buffer_load_dwordx4 v253, s[68:71], s64 offen offset:2048  lds
  v_mfma_f32_16x16x32_bf16 v[172:175], a[152:155], a[120:123], v[172:175]
  s_and_b32 s51, s54, 15
  s_lshr_b64 s[54:55], s[54:55], 4
  v_mfma_f32_16x16x32_bf16 v[176:179], a[156:159], a[112:115], v[176:179]
  s_lshl_b32 s51, s51, 14
  v_mfma_f32_16x16x32_bf16 v[180:183], a[156:159], a[116:119], v[180:183]
  buffer_load_dwordx4 v254, s[68:71], s64 offen offset:3072  lds
  s_add_u32 s42, s41, 32768
  v_mfma_f32_16x16x32_bf16 v[184:187], a[156:159], a[120:123], v[184:187]
  s_cmp_eq_u32 s42, 163840
  s_cmov_b32 s42, 65536
  s_waitcnt lgkmcnt(0)
  v_mfma_f32_16x16x32_bf16 v[128:131], a[92:95], a[64:67], v[128:131]
  s_add_u32 m0, s40, 6144
  ds_read_b64_tr_b16 a[140:141], v117 offset:9216
  ds_read_b64_tr_b16 a[142:143], v117 offset:13824
  v_mfma_f32_16x16x32_bf16 v[132:135], a[96:99], a[64:67], v[132:135]
  buffer_load_dwordx4 v112, s[72:75], s65 offen offset:0 sc1 lds
  ds_read_b128 a[112:115], v118 offset:9216
  v_mfma_f32_16x16x32_bf16 v[136:139], a[100:103], a[64:67], v[136:139]
  ds_read_b64_tr_b16 a[144:145], v117 offset:9248
  ds_read_b64_tr_b16 a[146:147], v117 offset:13856
  v_mfma_f32_16x16x32_bf16 v[140:143], a[104:107], a[64:67], v[140:143]
  ds_read_b64_tr_b16 a[148:149], v117 offset:9280
  ds_read_b64_tr_b16 a[150:151], v117 offset:13888
  v_mfma_f32_16x16x32_bf16 v[144:147], a[92:95], a[68:71], v[144:147]
  buffer_load_dwordx4 v113, s[72:75], s65 offen offset:1024 sc1 lds
  v_mfma_f32_16x16x32_bf16 v[148:151], a[96:99], a[68:71], v[148:151]
  ds_read_b64_tr_b16 a[152:153], v117 offset:9312
  ds_read_b64_tr_b16 a[154:155], v117 offset:13920
  v_mfma_f32_16x16x32_bf16 v[152:155], a[100:103], a[68:71], v[152:155]
  ds_read_b128 a[116:119], v118 offset:11264
  ds_read_b128 a[120:123], v118 offset:13312
  v_mfma_f32_16x16x32_bf16 v[156:159], a[104:107], a[68:71], v[156:159]
  buffer_load_dwordx4 v114, s[72:75], s65 offen offset:2048 sc1 lds
  v_mfma_f32_16x16x32_bf16 v[160:163], a[92:95], a[72:75], v[160:163]
  ds_read_b64_tr_b16 a[156:157], v117 offset:9344
  ds_read_b64_tr_b16 a[158:159], v117 offset:13952
  v_mfma_f32_16x16x32_bf16 v[164:167], a[96:99], a[72:75], v[164:167]
  v_mfma_f32_16x16x32_bf16 v[168:171], a[100:103], a[72:75], v[168:171]
  buffer_load_dwordx4 v115, s[72:75], s65 offen offset:3072 sc1 lds
  s_mul_i32 s64, s30, 73728
  v_mfma_f32_16x16x32_bf16 v[172:175], a[104:107], a[72:75], v[172:175]
  s_lshl_b32 s65, s30, 11
  s_mov_b32 s40, s41
  s_mov_b32 s41, s42
  v_mfma_f32_16x16x32_bf16 v[176:179], a[108:111], a[64:67], v[176:179]
  s_cmp_ge_u32 s43, 3
  s_cselect_b32 s70, s70, 0
  v_mfma_f32_16x16x32_bf16 v[180:183], a[108:111], a[68:71], v[180:183]
  s_cselect_b32 s74, s74, 0
  v_add_u32 v117, s42, v116
  v_mfma_f32_16x16x32_bf16 v[184:187], a[108:111], a[72:75], v[184:187]
  v_add_u32 v118, s51, v243
  s_sub_u32 s43, s43, 1
  s_cbranch_scc0 LG_loop2
  s_waitcnt lgkmcnt(0)
  v_mfma_f32_16x16x32_bf16 v[128:131], a[140:143], a[112:115], v[128:131]
  v_mfma_f32_16x16x32_bf16 v[132:135], a[144:147], a[112:115], v[132:135]
  v_mfma_f32_16x16x32_bf16 v[136:139], a[148:151], a[112:115], v[136:139]
  v_mfma_f32_16x16x32_bf16 v[140:143], a[152:155], a[112:115], v[140:143]
  v_mfma_f32_16x16x32_bf16 v[144:147], a[140:143], a[116:119], v[144:147]
  v_mfma_f32_16x16x32_bf16 v[148:151], a[144:147], a[116:119], v[148:151]
  v_mfma_f32_16x16x32_bf16 v[152:155], a[148:151], a[116:119], v[152:155]
  v_mfma_f32_16x16x32_bf16 v[156:159], a[152:155], a[116:119], v[156:159]
  v_mfma_f32_16x16x32_bf16 v[160:163], a[140:143], a[120:123], v[160:163]
  v_mfma_f32_16x16x32_bf16 v[164:167], a[144:147], a[120:123], v[164:167]
  v_mfma_f32_16x16x32_bf16 v[168:171], a[148:151], a[120:123], v[168:171]
  v_mfma_f32_16x16x32_bf16 v[172:175], a[152:155], a[120:123], v[172:175]
  v_mfma_f32_16x16x32_bf16 v[176:179], a[156:159], a[112:115], v[176:179]
  v_mfma_f32_16x16x32_bf16 v[180:183], a[156:159], a[116:119], v[180:183]
  v_mfma_f32_16x16x32_bf16 v[184:187], a[156:159], a[120:123], v[184:187]
  s_mov_b32 s36, 147456
  s_mov_b32 s37, 147488
  s_mov_b32 s38, 147520
  s_mov_b32 s39, 147552
  s_cmp_eq_u32 s97, 1
  s_cmov_b32 s36, 184320
  s_cmov_b32 s37, 184352
  s_cmov_b32 s38, 184384
  s_cmov_b32 s39, 184416
  s_cmp_eq_u32 s97, 2
  s_cmov_b32 s36, 221184
  s_cmov_b32 s37, 221216
  s_cmov_b32 s38, 221248
  s_cmov_b32 s39, 221280
  s_cmp_eq_u32 s97, 3
  s_cmov_b32 s36, 147584
  s_cmov_b32 s37, 184448
  s_cmov_b32 s38, 221312
  s_cmov_b32 s39, 1073741824
  s_branch LG_fin
LG_w3:
  v_add_u32 v112, 655360, v243
  v_add_u32 v113, 655360, v243
  v_add_u32 v114, 784384, v243
  v_add_u32 v115, 784384, v243
  s_waitcnt vmcnt(16) lgkmcnt(0)
  s_barrier
  ds_read_b64_tr_b16 a[92:93], v117 offset:160
  ds_read_b64_tr_b16 a[94:95], v117 offset:4768
  ds_read_b128 a[80:83], v118 offset:8192
  ds_read_b64_tr_b16 a[96:97], v117 offset:192
  ds_read_b64_tr_b16 a[98:99], v117 offset:4800
  ds_read_b64_tr_b16 a[100:101], v117 offset:224
  ds_read_b64_tr_b16 a[102:103], v117 offset:4832
  ds_read_b64_tr_b16 a[104:105], v117 offset:256
  ds_read_b64_tr_b16 a[106:107], v117 offset:4864
  ds_read_b128 a[84:87], v118 offset:10240
  ds_read_b128 a[88:91], v118 offset:12288
  ds_read_b128 a[64:67], v118 offset:0
  ds_read_b128 a[68:71], v118 offset:2048
  ds_read_b128 a[72:75], v118 offset:4096
  ds_read_b128 a[76:79], v118 offset:6144
  s_add_u32 m0, s67, 79872
  s_add_u32 s30, s96, 1
  s_and_b32 s30, s30, 3
  s_lshl2_add_u32 s29, s89, s30
  s_mul_i32 s64, s29, 73728
  buffer_load_dwordx4 v252, s[68:71], s64 offen offset:1024  lds
  buffer_load_dwordx4 v253, s[68:71], s64 offen offset:2048  lds
  buffer_load_dwordx4 v254, s[68:71], s64 offen offset:3072  lds
  s_add_u32 m0, m0, 4096
  s_nop 0
  buffer_load_dwordx4 v255, s[68:71], s64 offen offset:0  lds
  s_waitcnt lgkmcnt(0)
  v_mfma_f32_16x16x32_bf16 v[128:131], a[92:95], a[80:83], 0
  s_add_u32 m0, s67, 112640
  ds_read_b64_tr_b16 a[140:141], v117 offset:9376
  ds_read_b64_tr_b16 a[142:143], v117 offset:13984
  v_mfma_f32_16x16x32_bf16 v[132:135], a[96:99], a[80:83], 0
  ds_read_b128 a[128:131], v118 offset:9216
  ds_read_b64_tr_b16 a[144:145], v117 offset:9408
  ds_read_b64_tr_b16 a[146:147], v117 offset:14016
  v_mfma_f32_16x16x32_bf16 v[136:139], a[100:103], a[80:83], 0
  ds_read_b64_tr_b16 a[148:149], v117 offset:9440
  ds_read_b64_tr_b16 a[150:151], v117 offset:14048
  ds_read_b64_tr_b16 a[152:153], v117 offset:9472
  v_mfma_f32_16x16x32_bf16 v[140:143], a[104:107], a[80:83], 0
  ds_read_b64_tr_b16 a[154:155], v117 offset:14080
  ds_read_b128 a[132:135], v118 offset:11264
  ds_read_b128 a[136:139], v118 offset:13312
  v_mfma_f32_16x16x32_bf16 v[144:147], a[92:95], a[84:87], 0
  ds_read_b128 a[112:115], v118 offset:1024
  ds_read_b128 a[116:119], v118 offset:3072
  ds_read_b128 a[120:123], v118 offset:5120
  v_mfma_f32_16x16x32_bf16 v[148:151], a[96:99], a[84:87], 0
  ds_read_b128 a[124:127], v118 offset:7168
  s_add_u32 s30, s96, 2
  v_mfma_f32_16x16x32_bf16 v[152:155], a[100:103], a[84:87], 0
  s_and_b32 s30, s30, 3
  s_lshl2_add_u32 s29, s89, s30
  v_mfma_f32_16x16x32_bf16 v[156:159], a[104:107], a[84:87], 0
  s_mul_i32 s64, s29, 73728
  v_mfma_f32_16x16x32_bf16 v[160:163], a[92:95], a[88:91], 0
  buffer_load_dwordx4 v252, s[68:71], s64 offen offset:1024  lds
  v_mfma_f32_16x16x32_bf16 v[164:167], a[96:99], a[88:91], 0
  v_mfma_f32_16x16x32_bf16 v[168:171], a[100:103], a[88:91], 0
  v_mfma_f32_16x16x32_bf16 v[172:175], a[104:107], a[88:91], 0
  buffer_load_dwordx4 v253, s[68:71], s64 offen offset:2048  lds
  v_mfma_f32_16x16x32_bf16 v[176:179], a[104:107], a[64:67], 0
  v_mfma_f32_16x16x32_bf16 v[180:183], a[104:107], a[68:71], 0
  v_mfma_f32_16x16x32_bf16 v[184:187], a[104:107], a[72:75], 0
  buffer_load_dwordx4 v254, s[68:71], s64 offen offset:3072  lds
  s_add_u32 m0, m0, 4096
  v_mfma_f32_16x16x32_bf16 v[188:191], a[104:107], a[76:79], 0
  buffer_load_dwordx4 v255, s[68:71], s64 offen offset:0  lds
  buffer_load_dword v125, v124, s[76:79], 0 offen sc1
  s_add_u32 s29, s96, 1
  s_and_b32 s29, s29, 3
  s_xor_b32 s29, s29, 1
  s_lshl_b32 s29, s29, 14
  v_add_u32 v118, s29, v243
  v_add_u32 v117, 65536, v116
  s_waitcnt lgkmcnt(0) vmcnt(5)
  s_barrier
  v_mfma_f32_16x16x32_bf16 v[128:131], a[140:143], a[128:131], v[128:131]
  ds_read_b64_tr_b16 a[92:93], v117 offset:160
  ds_read_b64_tr_b16 a[94:95], v117 offset:4768
  ds_read_b128 a[80:83], v118 offset:8192
  v_mfma_f32_16x16x32_bf16 v[132:135], a[144:147], a[128:131], v[132:135]
  s_add_u32 m0, s67, 145408
  ds_read_b64_tr_b16 a[96:97], v117 offset:192
  ds_read_b64_tr_b16 a[98:99], v117 offset:4800
  v_mfma_f32_16x16x32_bf16 v[136:139], a[148:151], a[128:131], v[136:139]
  ds_read_b64_tr_b16 a[100:101], v117 offset:224
  ds_read_b64_tr_b16 a[102:103], v117 offset:4832
  ds_read_b64_tr_b16 a[104:105], v117 offset:256
  v_mfma_f32_16x16x32_bf16 v[140:143], a[152:155], a[128:131], v[140:143]
  ds_read_b64_tr_b16 a[106:107], v117 offset:4864
  ds_read_b128 a[84:87], v118 offset:10240
  ds_read_b128 a[88:91], v118 offset:12288
  v_mfma_f32_16x16x32_bf16 v[144:147], a[140:143], a[132:135], v[144:147]
  ds_read_b128 a[64:67], v118 offset:0
  ds_read_b128 a[68:71], v118 offset:2048
  ds_read_b128 a[72:75], v118 offset:4096
  v_mfma_f32_16x16x32_bf16 v[148:151], a[144:147], a[132:135], v[148:151]
  ds_read_b128 a[76:79], v118 offset:6144
  s_add_u32 s30, s96, 3
  v_mfma_f32_16x16x32_bf16 v[152:155], a[148:151], a[132:135], v[152:155]
  s_and_b32 s30, s30, 3
  s_lshl2_add_u32 s29, s89, s30
  v_mfma_f32_16x16x32_bf16 v[156:159], a[152:155], a[132:135], v[156:159]
  s_mul_i32 s64, s29, 73728
  v_mfma_f32_16x16x32_bf16 v[160:163], a[140:143], a[136:139], v[160:163]
  buffer_load_dwordx4 v252, s[68:71], s64 offen offset:1024  lds
  v_mfma_f32_16x16x32_bf16 v[164:167], a[144:147], a[136:139], v[164:167]
  v_mfma_f32_16x16x32_bf16 v[168:171], a[148:151], a[136:139], v[168:171]
  v_mfma_f32_16x16x32_bf16 v[172:175], a[152:155], a[136:139], v[172:175]
  buffer_load_dwordx4 v253, s[68:71], s64 offen offset:2048  lds
  v_mfma_f32_16x16x32_bf16 v[176:179], a[152:155], a[112:115], v[176:179]
  v_mfma_f32_16x16x32_bf16 v[180:183], a[152:155], a[116:119], v[180:183]
  v_mfma_f32_16x16x32_bf16 v[184:187], a[152:155], a[120:123], v[184:187]
  buffer_load_dwordx4 v254, s[68:71], s64 offen offset:3072  lds
  s_add_u32 m0, m0, 4096
  v_mfma_f32_16x16x32_bf16 v[188:191], a[152:155], a[124:127], v[188:191]
  buffer_load_dwordx4 v255, s[68:71], s64 offen offset:0  lds
  s_and_b32 s30, s52, 15
  s_lshr_b64 s[52:53], s[52:53], 4
  s_and_b32 s51, s54, 15
  s_lshr_b64 s[54:55], s[54:55], 4
  s_lshl_b32 s51, s51, 14
  s_add_u32 s42, s41, 32768
  s_cmp_eq_u32 s42, 163840
  s_cmov_b32 s42, 65536
  s_waitcnt lgkmcnt(0)
  v_mfma_f32_16x16x32_bf16 v[128:131], a[92:95], a[80:83], v[128:131]
  ds_read_b64_tr_b16 a[140:141], v117 offset:9376
  ds_read_b64_tr_b16 a[142:143], v117 offset:13984
  v_mfma_f32_16x16x32_bf16 v[132:135], a[96:99], a[80:83], v[132:135]
  ds_read_b128 a[128:131], v118 offset:9216
  ds_read_b64_tr_b16 a[144:145], v117 offset:9408
  v_mfma_f32_16x16x32_bf16 v[136:139], a[100:103], a[80:83], v[136:139]
  ds_read_b64_tr_b16 a[146:147], v117 offset:14016
  ds_read_b64_tr_b16 a[148:149], v117 offset:9440
  v_mfma_f32_16x16x32_bf16 v[140:143], a[104:107], a[80:83], v[140:143]
  ds_read_b64_tr_b16 a[150:151], v117 offset:14048
  ds_read_b64_tr_b16 a[152:153], v117 offset:9472
  v_mfma_f32_16x16x32_bf16 v[144:147], a[92:95], a[84:87], v[144:147]
  ds_read_b64_tr_b16 a[154:155], v117 offset:14080
  ds_read_b128 a[132:135], v118 offset:11264
  v_mfma_f32_16x16x32_bf16 v[148:151], a[96:99], a[84:87], v[148:151]
  ds_read_b128 a[136:139], v118 offset:13312
  ds_read_b128 a[112:115], v118 offset:1024
  v_mfma_f32_16x16x32_bf16 v[152:155], a[100:103], a[84:87], v[152:155]
  ds_read_b128 a[116:119], v118 offset:3072
  ds_read_b128 a[120:123], v118 offset:5120
  v_mfma_f32_16x16x32_bf16 v[156:159], a[104:107], a[84:87], v[156:159]
  ds_read_b128 a[124:127], v118 offset:7168
  s_mul_i32 s64, s30, 73728
  v_mfma_f32_16x16x32_bf16 v[160:163], a[92:95], a[88:91], v[160:163]
  s_lshl_b32 s65, s30, 11
  s_mov_b32 s40, s41
  v_mfma_f32_16x16x32_bf16 v[164:167], a[96:99], a[88:91], v[164:167]
  s_mov_b32 s41, s42
  s_cmp_ge_u32 s43, 3
  v_mfma_f32_16x16x32_bf16 v[168:171], a[100:103], a[88:91], v[168:171]
  s_cselect_b32 s70, s70, 0
  s_cselect_b32 s74, s74, 0
  v_mfma_f32_16x16x32_bf16 v[172:175], a[104:107], a[88:91], v[172:175]
  v_add_u32 v117, s42, v116
  v_add_u32 v118, s51, v243
  v_mfma_f32_16x16x32_bf16 v[176:179], a[104:107], a[64:67], v[176:179]
  s_sub_u32 s43, s43, 1
  v_mfma_f32_16x16x32_bf16 v[180:183], a[104:107], a[68:71], v[180:183]
  v_mfma_f32_16x16x32_bf16 v[184:187], a[104:107], a[72:75], v[184:187]
  v_mfma_f32_16x16x32_bf16 v[188:191], a[104:107], a[76:79], v[188:191]
  s_waitcnt lgkmcnt(0) vmcnt(4)
  s_barrier
  s_mov_b32 s26, 400000
LG_o3_chk:
  v_cmp_ne_u32 vcc, 0, v125
  s_sub_u32 s26, s26, 1
  s_cbranch_scc1 L1_end
  s_or_b32 s27, vcc_lo, s62
  s_and_b32 s27, s27, 15
  s_cmp_eq_u32 s27, 15
  s_cbranch_scc1 LG_o3_ok
  buffer_load_dword v125, v124, s[76:79], 0 offen sc1
  s_waitcnt vmcnt(0)
  s_branch LG_o3_chk
LG_o3_ok:
  s_branch LG_in3
LG_loop3:
  s_waitcnt lgkmcnt(0) vmcnt(8)
  s_barrier
LG_in3:
  v_mfma_f32_16x16x32_bf16 v[128:131], a[140:143], a[128:131], v[128:131]
  s_add_u32 m0, s40, s48
  ds_read_b64_tr_b16 a[92:93], v117 offset:160
  ds_read_b64_tr_b16 a[94:95], v117 offset:4768
  v_mfma_f32_16x16x32_bf16 v[132:135], a[144:147], a[128:131], v[132:135]
  buffer_load_dwordx4 v252, s[68:71], s64 offen offset:1024  lds
  v_mfma_f32_16x16x32_bf16 v[136:139], a[148:151], a[128:131], v[136:139]
  ds_read_b128 a[80:83], v118 offset:8192
  ds_read_b64_tr_b16 a[96:97], v117 offset:192
  v_mfma_f32_16x16x32_bf16 v[140:143], a[152:155], a[128:131], v[140:143]
  ds_read_b64_tr_b16 a[98:99], v117 offset:4800
  ds_read_b64_tr_b16 a[100:101], v117 offset:224
  v_mfma_f32_16x16x32_bf16 v[144:147], a[140:143], a[132:135], v[144:147]
  buffer_load_dwordx4 v253, s[68:71], s64 offen offset:2048  lds
  v_mfma_f32_16x16x32_bf16 v[148:151], a[144:147], a[132:135], v[148:151]
  ds_read_b64_tr_b16 a[102:103], v117 offset:4832
  ds_read_b64_tr_b16 a[104:105], v117 offset:256
  v_mfma_f32_16x16x32_bf16 v[152:155], a[148:151], a[132:135], v[152:155]
  ds_read_b64_tr_b16 a[106:107], v117 offset:4864
  ds_read_b128 a[84:87], v118 offset:10240
  v_mfma_f32_16x16x32_bf16 v[156:159], a[152:155], a[132:135], v[156:159]
  ds_read_b128 a[88:91], v118 offset:12288
  ds_read_b128 a[64:67], v118 offset:0
  v_mfma_f32_16x16x32_bf16 v[160:163], a[140:143], a[136:139], v[160:163]
  ds_read_b128 a[68:71], v118 offset:2048
  ds_read_b128 a[72:75], v118 offset:4096
  v_mfma_f32_16x16x32_bf16 v[164:167], a[144:147], a[136:139], v[164:167]
  ds_read_b128 a[76:79], v118 offset:6144
  s_and_b32 s30, s52, 15
  v_mfma_f32_16x16x32_bf16 v[168:171], a[148:151], a[136:139], v[168:171]
  s_lshr_b64 s[52:53], s[52:53], 4
  v_mfma_f32_16x16x32_bf16 v[172:175], a[152:155], a[136:139], v[172:175]
  buffer_load_dwordx4 v254, s[68:71], s64 offen offset:3072  lds
  s_and_b32 s51, s54, 15
  v_mfma_f32_16x16x32_bf16 v[176:179], a[152:155], a[112:115], v[176:179]
  s_lshr_b64 s[54:55], s[54:55], 4
  s_lshl_b32 s51, s51, 14
  v_mfma_f32_16x16x32_bf16 v[180:183], a[152:155], a[116:119], v[180:183]
  s_add_u32 m0, m0, 4096
  v_mfma_f32_16x16x32_bf16 v[184:187], a[152:155], a[120:123], v[184:187]
  buffer_load_dwordx4 v255, s[68:71], s64 offen offset:0  lds
  s_add_u32 s42, s41, 32768
  v_mfma_f32_16x16x32_bf16 v[188:191], a[152:155], a[124:127], v[188:191]
  s_cmp_eq_u32 s42, 163840
  s_cmov_b32 s42, 65536
  s_waitcnt lgkmcnt(0)
  v_mfma_f32_16x16x32_bf16 v[128:131], a[92:95], a[80:83], v[128:131]
  s_add_u32 m0, s40, 10240
  ds_read_b64_tr_b16 a[140:141], v117 offset:9376
  ds_read_b64_tr_b16 a[142:143], v117 offset:13984
  v_mfma_f32_16x16x32_bf16 v[132:135], a[96:99], a[80:83], v[132:135]
  buffer_load_dwordx4 v112, s[72:75], s65 offen offset:0 sc1 lds
  ds_read_b128 a[128:131], v118 offset:9216
  v_mfma_f32_16x16x32_bf16 v[136:139], a[100:103], a[80:83], v[136:139]
  ds_read_b64_tr_b16 a[144:145], v117 offset:9408
  ds_read_b64_tr_b16 a[146:147], v117 offset:14016
  v_mfma_f32_16x16x32_bf16 v[140:143], a[104:107], a[80:83], v[140:143]
  ds_read_b64_tr_b16 a[148:149], v117 offset:9440
  ds_read_b64_tr_b16 a[150:151], v117 offset:14048
  v_mfma_f32_16x16x32_bf16 v[144:147], a[92:95], a[84:87], v[144:147]
  buffer_load_dwordx4 v113, s[72:75], s65 offen offset:1024 sc1 lds
  v_mfma_f32_16x16x32_bf16 v[148:151], a[96:99], a[84:87], v[148:151]
  ds_read_b64_tr_b16 a[152:153], v117 offset:9472
  ds_read_b64_tr_b16 a[154:155], v117 offset:14080
  v_mfma_f32_16x16x32_bf16 v[152:155], a[100:103], a[84:87], v[152:155]
  ds_read_b128 a[132:135], v118 offset:11264
  ds_read_b128 a[136:139], v118 offset:13312
  v_mfma_f32_16x16x32_bf16 v[156:159], a[104:107], a[84:87], v[156:159]
  buffer_load_dwordx4 v114, s[72:75], s65 offen offset:2048 sc1 lds
  v_mfma_f32_16x16x32_bf16 v[160:163], a[92:95], a[88:91], v[160:163]
  ds_read_b128 a[112:115], v118 offset:1024
  ds_read_b128 a[116:119], v118 offset:3072
  v_mfma_f32_16x16x32_bf16 v[164:167], a[96:99], a[88:91], v[164:167]
  ds_read_b128 a[120:123], v118 offset:5120
  ds_read_b128 a[124:127], v118 offset:7168
  v_mfma_f32_16x16x32_bf16 v[168:171], a[100:103], a[88:91], v[168:171]
  buffer_load_dwordx4 v115, s[72:75], s65 offen offset:3072 sc1 lds
  v_mfma_f32_16x16x32_bf16 v[172:175], a[104:107], a[88:91], v[172:175]
  s_mul_i32 s64, s30, 73728
  s_lshl_b32 s65, s30, 11
  v_mfma_f32_16x16x32_bf16 v[176:179], a[104:107], a[64:67], v[176:179]
  s_mov_b32 s40, s41
  s_mov_b32 s41, s42
  v_mfma_f32_16x16x32_bf16 v[180:183], a[104:107], a[68:71], v[180:183]
  s_cmp_ge_u32 s43, 3
  s_cselect_b32 s70, s70, 0
  v_mfma_f32_16x16x32_bf16 v[184:187], a[104:107], a[72:75], v[184:187]
  s_cselect_b32 s74, s74, 0
  v_add_u32 v117, s42, v116
  v_mfma_f32_16x16x32_bf16 v[188:191], a[104:107], a[76:79], v[188:191]
  v_add_u32 v118, s51, v243
  s_sub_u32 s43, s43, 1
  s_cbranch_scc0 LG_loop3
  s_waitcnt lgkmcnt(0)
  v_mfma_f32_16x16x32_bf16 v[128:131], a[140:143], a[128:131], v[128:131]
  v_mfma_f32_16x16x32_bf16 v[132:135], a[144:147], a[128:131], v[132:135]
  v_mfma_f32_16x16x32_bf16 v[136:139], a[148:151], a[128:131], v[136:139]
  v_mfma_f32_16x16x32_bf16 v[140:143], a[152:155], a[128:131], v[140:143]
  v_mfma_f32_16x16x32_bf16 v[144:147], a[140:143], a[132:135], v[144:147]
  v_mfma_f32_16x16x32_bf16 v[148:151], a[144:147], a[132:135], v[148:151]
  v_mfma_f32_16x16x32_bf16 v[152:155], a[148:151], a[132:135], v[152:155]
  v_mfma_f32_16x16x32_bf16 v[156:159], a[152:155], a[132:135], v[156:159]
  v_mfma_f32_16x16x32_bf16 v[160:163], a[140:143], a[136:139], v[160:163]
  v_mfma_f32_16x16x32_bf16 v[164:167], a[144:147], a[136:139], v[164:167]
  v_mfma_f32_16x16x32_bf16 v[168:171], a[148:151], a[136:139], v[168:171]
  v_mfma_f32_16x16x32_bf16 v[172:175], a[152:155], a[136:139], v[172:175]
  v_mfma_f32_16x16x32_bf16 v[176:179], a[152:155], a[112:115], v[176:179]
  v_mfma_f32_16x16x32_bf16 v[180:183], a[152:155], a[116:119], v[180:183]
  v_mfma_f32_16x16x32_bf16 v[184:187], a[152:155], a[120:123], v[184:187]
  v_mfma_f32_16x16x32_bf16 v[188:191], a[152:155], a[124:127], v[188:191]
  s_mov_b32 s36, 147616
  s_mov_b32 s37, 147648
  s_mov_b32 s38, 147680
  s_mov_b32 s39, 147712
  s_cmp_eq_u32 s97, 1
  s_cmov_b32 s36, 184480
  s_cmov_b32 s37, 184512
  s_cmov_b32 s38, 184544
  s_cmov_b32 s39, 184576
  s_cmp_eq_u32 s97, 2
  s_cmov_b32 s36, 221344
  s_cmov_b32 s37, 221376
  s_cmov_b32 s38, 221408
  s_cmov_b32 s39, 221440
  s_cmp_eq_u32 s97, 3
  s_cmov_b32 s36, 256
  s_cmov_b32 s37, 37120
  s_cmov_b32 s38, 73984
  s_cmov_b32 s39, 110848
LG_fin:
  s_lshl_b32 s29, s97, 13
  s_add_u32 s30, s29, 4096
  v_cvt_pk_bf16_f32 v128, v128, v129
  v_cvt_pk_bf16_f32 v129, v130, v131
  v_cvt_pk_bf16_f32 v130, v132, v133
  v_cvt_pk_bf16_f32 v131, v134, v135
  v_cvt_pk_bf16_f32 v136, v136, v137
  v_cvt_pk_bf16_f32 v137, v138, v139
  v_cvt_pk_bf16_f32 v138, v140, v141
  v_cvt_pk_bf16_f32 v139, v142, v143
  s_cmp_lg_u32 s97, 0
  s_cbranch_scc1 LG_st0
  v_mov_b32 v0, v128
  v_mov_b32 v1, v129
  v_mov_b32 v2, v130
  v_mov_b32 v3, v131
  v_mov_b32 v16, v136
  v_mov_b32 v17, v137
  v_mov_b32 v18, v138
  v_mov_b32 v19, v139
  s_branch LG_nx0
LG_st0:
  v_min_u32 v128, -2, v128
  v_min_u32 v129, -2, v129
  v_min_u32 v130, -2, v130
  v_min_u32 v131, -2, v131
  buffer_store_dwordx4 v[128:131], v243, s[84:87], s29 offen offset:0 sc1
  v_min_u32 v136, -2, v136
  v_min_u32 v137, -2, v137
  v_min_u32 v138, -2, v138
  v_min_u32 v139, -2, v139
  buffer_store_dwordx4 v[136:139], v243, s[84:87], s29 offen offset:1024 sc1
LG_nx0:
  v_cvt_pk_bf16_f32 v144, v144, v145
  v_cvt_pk_bf16_f32 v145, v146, v147
  v_cvt_pk_bf16_f32 v146, v148, v149
  v_cvt_pk_bf16_f32 v147, v150, v151
  v_cvt_pk_bf16_f32 v152, v152, v153
  v_cvt_pk_bf16_f32 v153, v154, v155
  v_cvt_pk_bf16_f32 v154, v156, v157
  v_cvt_pk_bf16_f32 v155, v158, v159
  s_cmp_lg_u32 s97, 1
  s_cbranch_scc1 LG_st1
  v_mov_b32 v0, v144
  v_mov_b32 v1, v145
  v_mov_b32 v2, v146
  v_mov_b32 v3, v147
  v_mov_b32 v16, v152
  v_mov_b32 v17, v153
  v_mov_b32 v18, v154
  v_mov_b32 v19, v155
  s_branch LG_nx1
LG_st1:
  v_min_u32 v144, -2, v144
  v_min_u32 v145, -2, v145
  v_min_u32 v146, -2, v146
  v_min_u32 v147, -2, v147
  buffer_store_dwordx4 v[144:147], v243, s[84:87], s29 offen offset:2048 sc1
  v_min_u32 v152, -2, v152
  v_min_u32 v153, -2, v153
  v_min_u32 v154, -2, v154
  v_min_u32 v155, -2, v155
  buffer_store_dwordx4 v[152:155], v243, s[84:87], s29 offen offset:3072 sc1
LG_nx1:
  v_cvt_pk_bf16_f32 v160, v160, v161
  v_cvt_pk_bf16_f32 v161, v162, v163
  v_cvt_pk_bf16_f32 v162, v164, v165
  v_cvt_pk_bf16_f32 v163, v166, v167
  v_cvt_pk_bf16_f32 v168, v168, v169
  v_cvt_pk_bf16_f32 v169, v170, v171
  v_cvt_pk_bf16_f32 v170, v172, v173
  v_cvt_pk_bf16_f32 v171, v174, v175
  s_cmp_lg_u32 s97, 2
  s_cbranch_scc1 LG_st2
  v_mov_b32 v0, v160
  v_mov_b32 v1, v161
  v_mov_b32 v2, v162
  v_mov_b32 v3, v163
  v_mov_b32 v16, v168
  v_mov_b32 v17, v169
  v_mov_b32 v18, v170
  v_mov_b32 v19, v171
  s_branch LG_nx2
LG_st2:
  v_min_u32 v160, -2, v160
  v_min_u32 v161, -2, v161
  v_min_u32 v162, -2, v162
  v_min_u32 v163, -2, v163
  buffer_store_dwordx4 v[160:163], v243, s[84:87], s30 offen offset:0 sc1
  v_min_u32 v168, -2, v168
  v_min_u32 v169, -2, v169
  v_min_u32 v170, -2, v170
  v_min_u32 v171, -2, v171
  buffer_store_dwordx4 v[168:171], v243, s[84:87], s30 offen offset:1024 sc1
LG_nx2:
  v_cvt_pk_bf16_f32 v176, v176, v177
  v_cvt_pk_bf16_f32 v177, v178, v179
  v_cvt_pk_bf16_f32 v178, v180, v181
  v_cvt_pk_bf16_f32 v179, v182, v183
  v_cvt_pk_bf16_f32 v184, v184, v185
  v_cvt_pk_bf16_f32 v185, v186, v187
  v_cvt_pk_bf16_f32 v186, v188, v189
  v_cvt_pk_bf16_f32 v187, v190, v191
  s_cmp_lg_u32 s97, 3
  s_cbranch_scc1 LG_st3
  v_mov_b32 v0, v176
  v_mov_b32 v1, v177
  v_mov_b32 v2, v178
  v_mov_b32 v3, v179
  v_mov_b32 v16, v184
  v_mov_b32 v17, v185
  v_mov_b32 v18, v186
  v_mov_b32 v19, v187
  s_branch LG_nx3
LG_st3:
  v_min_u32 v176, -2, v176
  v_min_u32 v177, -2, v177
  v_min_u32 v178, -2, v178
  v_min_u32 v179, -2, v179
  buffer_store_dwordx4 v[176:179], v243, s[84:87], s30 offen offset:2048 sc1
  v_min_u32 v184, -2, v184
  v_min_u32 v185, -2, v185
  v_min_u32 v186, -2, v186
  v_min_u32 v187, -2, v187
  buffer_store_dwordx4 v[184:187], v243, s[84:87], s30 offen offset:3072 sc1
LG_nx3:
  s_lshl_b32 s29, s97, 11
  s_add_u32 s30, s97, 1
  s_and_b32 s30, s30, 3
  s_lshl_b32 s30, s30, 13
  s_add_u32 s40, s30, s29
  buffer_load_dwordx4 v[4:7], v243, s[84:87], s40 offen offset:0 sc1
  buffer_load_dwordx4 v[20:23], v243, s[84:87], s40 offen offset:1024 sc1
  s_add_u32 s30, s97, 2
  s_and_b32 s30, s30, 3
  s_lshl_b32 s30, s30, 13
  s_add_u32 s41, s30, s29
  buffer_load_dwordx4 v[8:11], v243, s[84:87], s41 offen offset:0 sc1
  buffer_load_dwordx4 v[24:27], v243, s[84:87], s41 offen offset:1024 sc1
  s_add_u32 s30, s97, 3
  s_and_b32 s30, s30, 3
  s_lshl_b32 s30, s30, 13
  s_add_u32 s42, s30, s29
  buffer_load_dwordx4 v[12:15], v243, s[84:87], s42 offen offset:0 sc1
  buffer_load_dwordx4 v[28:31], v243, s[84:87], s42 offen offset:1024 sc1
  s_mov_b32 s26, 400000
  s_mul_i32 s29, s24, 258048
  s_mul_i32 s30, s23, 1152
  s_add_u32 s29, s29, s30
  s_mul_i32 s30, s89, 288
  s_add_u32 s29, s29, s30
  s_add_u32 s4, s98, s29
  s_addc_u32 s5, s99, 0
  s_sub_u32 s6, 2064384, s29
  s_mov_b32 s7, 0x20000
  v_and_b32 v40, 15, v242
  v_mul_u32_u24 v40, 2304, v40
  v_lshrrev_b32 v41, 4, v242
  v_lshl_add_u32 v40, v41, 3, v40
  v_add_u32 v44, s36, v40
  v_add_u32 v45, s37, v40
  v_add_u32 v46, s38, v40
  v_add_u32 v47, s39, v40
LG_p1:
  s_waitcnt vmcnt(0)
  v_max3_u32 v41, v4, v5, v6
  v_max3_u32 v42, v7, v20, v21
  v_max3_u32 v41, v41, v22, v23
  v_max_u32 v41, v41, v42
  v_cmp_eq_u32 vcc, -1, v41
  s_cbranch_vccz LG_q1
  buffer_load_dwordx4 v[4:7], v243, s[84:87], s40 offen offset:0 sc1
  buffer_load_dwordx4 v[20:23], v243, s[84:87], s40 offen offset:1024 sc1
  s_sub_u32 s26, s26, 1
  s_cbranch_scc0 LG_p1
  s_waitcnt vmcnt(0)
  s_branch L1_end
LG_q1:
LG_p2:
  s_waitcnt vmcnt(0)
  v_max3_u32 v41, v8, v9, v10
  v_max3_u32 v42, v11, v24, v25
  v_max3_u32 v41, v41, v26, v27
  v_max_u32 v41, v41, v42
  v_cmp_eq_u32 vcc, -1, v41
  s_cbranch_vccz LG_q2
  buffer_load_dwordx4 v[8:11], v243, s[84:87], s41 offen offset:0 sc1
  buffer_load_dwordx4 v[24:27], v243, s[84:87], s41 offen offset:1024 sc1
  s_sub_u32 s26, s26, 1
  s_cbranch_scc0 LG_p2
  s_waitcnt vmcnt(0)
  s_branch L1_end
LG_q2:
LG_p3:
  s_waitcnt vmcnt(0)
  v_max3_u32 v41, v12, v13, v14
  v_max3_u32 v42, v15, v28, v29
  v_max3_u32 v41, v41, v30, v31
  v_max_u32 v41, v41, v42
  v_cmp_eq_u32 vcc, -1, v41
  s_cbranch_vccz LG_q3
  buffer_load_dwordx4 v[12:15], v243, s[84:87], s42 offen offset:0 sc1
  buffer_load_dwordx4 v[28:31], v243, s[84:87], s42 offen offset:1024 sc1
  s_sub_u32 s26, s26, 1
  s_cbranch_scc0 LG_p3
  s_waitcnt vmcnt(0)
  s_branch L1_end
LG_q3:
  v_lshlrev_b32 v64, 16, v0
  v_and_b32 v65, 0xffff0000, v0
  v_lshlrev_b32 v66, 16, v4
  v_and_b32 v67, 0xffff0000, v4
  v_lshlrev_b32 v68, 16, v8
  v_and_b32 v69, 0xffff0000, v8
  v_lshlrev_b32 v70, 16, v12
  v_and_b32 v71, 0xffff0000, v12
  v_lshlrev_b32 v72, 16, v1
  v_and_b32 v73, 0xffff0000, v1
  v_lshlrev_b32 v74, 16, v5
  v_and_b32 v75, 0xffff0000, v5
  v_lshlrev_b32 v76, 16, v9
  v_and_b32 v77, 0xffff0000, v9
  v_lshlrev_b32 v78, 16, v13
  v_and_b32 v79, 0xffff0000, v13
  v_lshlrev_b32 v80, 16, v2
  v_and_b32 v81, 0xffff0000, v2
  v_lshlrev_b32 v82, 16, v6
  v_and_b32 v83, 0xffff0000, v6
  v_lshlrev_b32 v84, 16, v10
  v_and_b32 v85, 0xffff0000, v10
  v_lshlrev_b32 v86, 16, v14
  v_and_b32 v87, 0xffff0000, v14
  v_lshlrev_b32 v88, 16, v3
  v_and_b32 v89, 0xffff0000, v3
  v_lshlrev_b32 v90, 16, v7
  v_and_b32 v91, 0xffff0000, v7
  v_lshlrev_b32 v92, 16, v11
  v_and_b32 v93, 0xffff0000, v11
  v_lshlrev_b32 v94, 16, v15
  v_and_b32 v95, 0xffff0000, v15
  v_pk_add_f32 v[64:65], v[64:65], v[66:67]
  v_pk_add_f32 v[68:69], v[68:69], v[70:71]
  v_pk_add_f32 v[72:73], v[72:73], v[74:75]
  v_pk_add_f32 v[76:77], v[76:77], v[78:79]
  v_pk_add_f32 v[80:81], v[80:81], v[82:83]
  v_pk_add_f32 v[84:85], v[84:85], v[86:87]
  v_pk_add_f32 v[88:89], v[88:89], v[90:91]
  v_pk_add_f32 v[92:93], v[92:93], v[94:95]
  v_pk_add_f32 v[64:65], v[64:65], v[68:69]
  v_pk_add_f32 v[72:73], v[72:73], v[76:77]
  v_pk_add_f32 v[80:81], v[80:81], v[84:85]
  v_pk_add_f32 v[88:89], v[88:89], v[92:93]
  v_cvt_pk_bf16_f32 v48, v64, v65
  v_cvt_pk_bf16_f32 v49, v72, v73
  v_cvt_pk_bf16_f32 v50, v80, v81
  v_cvt_pk_bf16_f32 v51, v88, v89
  buffer_store_dwordx2 v[48:49], v44, s[4:7], 0 offen
  buffer_store_dwordx2 v[50:51], v45, s[4:7], 0 offen
  v_lshlrev_b32 v64, 16, v16
  v_and_b32 v65, 0xffff0000, v16
  v_lshlrev_b32 v66, 16, v20
  v_and_b32 v67, 0xffff0000, v20
  v_lshlrev_b32 v68, 16, v24
  v_and_b32 v69, 0xffff0000, v24
  v_lshlrev_b32 v70, 16, v28
  v_and_b32 v71, 0xffff0000, v28
  v_lshlrev_b32 v72, 16, v17
  v_and_b32 v73, 0xffff0000, v17
  v_lshlrev_b32 v74, 16, v21
  v_and_b32 v75, 0xffff0000, v21
  v_lshlrev_b32 v76, 16, v25
  v_and_b32 v77, 0xffff0000, v25
  v_lshlrev_b32 v78, 16, v29
  v_and_b32 v79, 0xffff0000, v29
  v_lshlrev_b32 v80, 16, v18
  v_and_b32 v81, 0xffff0000, v18
  v_lshlrev_b32 v82, 16, v22
  v_and_b32 v83, 0xffff0000, v22
  v_lshlrev_b32 v84, 16, v26
  v_and_b32 v85, 0xffff0000, v26
  v_lshlrev_b32 v86, 16, v30
  v_and_b32 v87, 0xffff0000, v30
  v_lshlrev_b32 v88, 16, v19
  v_and_b32 v89, 0xffff0000, v19
  v_lshlrev_b32 v90, 16, v23
  v_and_b32 v91, 0xffff0000, v23
  v_lshlrev_b32 v92, 16, v27
  v_and_b32 v93, 0xffff0000, v27
  v_lshlrev_b32 v94, 16, v31
  v_and_b32 v95, 0xffff0000, v31
  v_pk_add_f32 v[64:65], v[64:65], v[66:67]
  v_pk_add_f32 v[68:69], v[68:69], v[70:71]
  v_pk_add_f32 v[72:73], v[72:73], v[74:75]
  v_pk_add_f32 v[76:77], v[76:77], v[78:79]
  v_pk_add_f32 v[80:81], v[80:81], v[82:83]
  v_pk_add_f32 v[84:85], v[84:85], v[86:87]
  v_pk_add_f32 v[88:89], v[88:89], v[90:91]
  v_pk_add_f32 v[92:93], v[92:93], v[94:95]
  v_pk_add_f32 v[64:65], v[64:65], v[68:69]
  v_pk_add_f32 v[72:73], v[72:73], v[76:77]
  v_pk_add_f32 v[80:81], v[80:81], v[84:85]
  v_pk_add_f32 v[88:89], v[88:89], v[92:93]
  v_cvt_pk_bf16_f32 v52, v64, v65
  v_cvt_pk_bf16_f32 v53, v72, v73
  v_cvt_pk_bf16_f32 v54, v80, v81
  v_cvt_pk_bf16_f32 v55, v88, v89
  buffer_store_dwordx2 v[52:53], v46, s[4:7], 0 offen
  buffer_store_dwordx2 v[54:55], v47, s[4:7], 0 offen
  s_endpgm
L1_fb:
  s_cmp_eq_u32 s23, 0
  s_cbranch_scc1 L1_A_fallback
L1_B_fallback:
  s_mov_b32 s31, 1
  s_mov_b32 s26, 0
  s_mov_b32 s14, 0x20000
  s_mov_b32 s34, 0x20000
  s_mov_b32 s30, 16
  v_and_b32 v228, 0xffff, v228
  v_and_b32 v229, 0xffff, v229
  v_and_b32 v230, 0xffff, v230
  v_and_b32 v231, 0xffff, v231
  v_and_b32 v232, 0xffff, v232
  v_and_b32 v233, 0xffff, v233
  v_and_b32 v234, 0xffff, v234
  v_and_b32 v235, 0xffff, v235
  v_and_b32 v236, 0xffff, v236
  v_and_b32 v237, 0xffff, v237
  v_and_b32 v238, 0xffff, v238
  v_and_b32 v239, 0xffff, v239
  s_waitcnt lgkmcnt(0)
  v_mov_b32 v144, 0xff800000
  v_mov_b32 v145, 0xff800000
  v_mov_b32 v146, 0xff800000
  v_mov_b32 v147, 0xff800000
  v_mov_b32 v148, 0xff800000
  v_mov_b32 v149, 0xff800000
  v_mov_b32 v150, 0xff800000
L1_B_maxloop:
  s_barrier
  s_mov_b32 s27, 0
  s_add_u32 m0, s27, s28
  s_add_u32 s29, s26, 4096
  buffer_load_dwordx4 v240, s[12:15], s26 offen offset:0 nt lds
  buffer_load_dwordx4 v241, s[12:15], s26 offen offset:1024 nt lds
  buffer_load_dwordx4 v240, s[12:15], s26 offen offset:2048 nt lds
  buffer_load_dwordx4 v241, s[12:15], s26 offen offset:3072 nt lds
  s_add_u32 m0, m0, 4096
  s_xor_b32 s27, s27, 0x10000
  buffer_load_dwordx4 v240, s[12:15], s29 offen offset:0 nt lds
  buffer_load_dwordx4 v241, s[12:15], s29 offen offset:1024 nt lds
  buffer_load_dwordx4 v240, s[12:15], s29 offen offset:2048 nt lds
  buffer_load_dwordx4 v241, s[12:15], s29 offen offset:3072 nt lds
  s_add_u32 s26, s26, 8192
  s_waitcnt vmcnt(0)
  s_barrier
  ds_read_b128 a[224:227], v228 offset:0
  ds_read_b128 a[228:231], v229 offset:0
  ds_read_b128 a[232:235], v230 offset:0
  ds_read_b128 a[236:239], v231 offset:0
  ds_read_b128 a[240:243], v228 offset:4096
  ds_read_b128 a[244:247], v229 offset:4096
  ds_read_b128 a[248:251], v230 offset:4096
  ds_read_b128 a[252:255], v231 offset:4096
  s_waitcnt lgkmcnt(0)
  v_mfma_f32_16x16x32_bf16 v[0:3], a[224:227], a[112:115], 0
  v_mfma_f32_16x16x32_bf16 v[0:3], a[228:231], a[116:119], v[0:3]
  v_mfma_f32_16x16x32_bf16 v[0:3], a[232:235], a[120:123], v[0:3]
  v_mfma_f32_16x16x32_bf16 v[0:3], a[236:239], a[124:127], v[0:3]
  v_mfma_f32_16x16x32_bf16 v[4:7], a[240:243], a[112:115], 0
  v_mfma_f32_16x16x32_bf16 v[4:7], a[244:247], a[116:119], v[4:7]
  v_mfma_f32_16x16x32_bf16 v[4:7], a[248:251], a[120:123], v[4:7]
  v_mfma_f32_16x16x32_bf16 v[4:7], a[252:255], a[124:127], v[4:7]
  v_mfma_f32_16x16x32_bf16 v[8:11], a[224:227], a[128:131], 0
  v_mfma_f32_16x16x32_bf16 v[8:11], a[228:231], a[132:135], v[8:11]
  v_mfma_f32_16x16x32_bf16 v[8:11], a[232:235], a[136:139], v[8:11]
  v_mfma_f32_16x16x32_bf16 v[8:11], a[236:239], a[140:143], v[8:11]
  v_mfma_f32_16x16x32_bf16 v[12:15], a[240:243], a[128:131], 0
  v_mfma_f32_16x16x32_bf16 v[12:15], a[244:247], a[132:135], v[12:15]
  v_mfma_f32_16x16x32_bf16 v[12:15], a[248:251], a[136:139], v[12:15]
  v_mfma_f32_16x16x32_bf16 v[12:15], a[252:255], a[140:143], v[12:15]
  v_mfma_f32_16x16x32_bf16 v[16:19], a[224:227], a[144:147], 0
  v_mfma_f32_16x16x32_bf16 v[16:19], a[228:231], a[148:151], v[16:19]
  v_mfma_f32_16x16x32_bf16 v[16:19], a[232:235], a[152:155], v[16:19]
  v_mfma_f32_16x16x32_bf16 v[16:19], a[236:239], a[156:159], v[16:19]
  v_mfma_f32_16x16x32_bf16 v[20:23], a[240:243], a[144:147], 0
  v_mfma_f32_16x16x32_bf16 v[20:23], a[244:247], a[148:151], v[20:23]
  v_mfma_f32_16x16x32_bf16 v[20:23], a[248:251], a[152:155], v[20:23]
  v_mfma_f32_16x16x32_bf16 v[20:23], a[252:255], a[156:159], v[20:23]
  v_mfma_f32_16x16x32_bf16 v[24:27], a[224:227], a[160:163], 0
  v_mfma_f32_16x16x32_bf16 v[24:27], a[228:231], a[164:167], v[24:27]
  v_mfma_f32_16x16x32_bf16 v[24:27], a[232:235], a[168:171], v[24:27]
  v_mfma_f32_16x16x32_bf16 v[24:27], a[236:239], a[172:175], v[24:27]
  v_mfma_f32_16x16x32_bf16 v[28:31], a[240:243], a[160:163], 0
  v_mfma_f32_16x16x32_bf16 v[28:31], a[244:247], a[164:167], v[28:31]
  v_mfma_f32_16x16x32_bf16 v[28:31], a[248:251], a[168:171], v[28:31]
  v_mfma_f32_16x16x32_bf16 v[28:31], a[252:255], a[172:175], v[28:31]
  v_mfma_f32_16x16x32_bf16 v[32:35], a[224:227], a[176:179], 0
  v_mfma_f32_16x16x32_bf16 v[32:35], a[228:231], a[180:183], v[32:35]
  v_mfma_f32_16x16x32_bf16 v[32:35], a[232:235], a[184:187], v[32:35]
  v_mfma_f32_16x16x32_bf16 v[32:35], a[236:239], a[188:191], v[32:35]
  v_mfma_f32_16x16x32_bf16 v[36:39], a[240:243], a[176:179], 0
  v_mfma_f32_16x16x32_bf16 v[36:39], a[244:247], a[180:183], v[36:39]
  v_mfma_f32_16x16x32_bf16 v[36:39], a[248:251], a[184:187], v[36:39]
  v_mfma_f32_16x16x32_bf16 v[36:39], a[252:255], a[188:191], v[36:39]
  v_mfma_f32_16x16x32_bf16 v[40:43], a[224:227], a[192:195], 0
  v_mfma_f32_16x16x32_bf16 v[40:43], a[228:231], a[196:199], v[40:43]
  v_mfma_f32_16x16x32_bf16 v[40:43], a[232:235], a[200:203], v[40:43]
  v_mfma_f32_16x16x32_bf16 v[40:43], a[236:239], a[204:207], v[40:43]
  v_mfma_f32_16x16x32_bf16 v[44:47], a[240:243], a[192:195], 0
  v_mfma_f32_16x16x32_bf16 v[44:47], a[244:247], a[196:199], v[44:47]
  v_mfma_f32_16x16x32_bf16 v[44:47], a[248:251], a[200:203], v[44:47]
  v_mfma_f32_16x16x32_bf16 v[44:47], a[252:255], a[204:207], v[44:47]
  v_mfma_f32_16x16x32_bf16 v[48:51], a[224:227], a[208:211], 0
  v_mfma_f32_16x16x32_bf16 v[48:51], a[228:231], a[212:215], v[48:51]
  v_mfma_f32_16x16x32_bf16 v[48:51], a[232:235], a[216:219], v[48:51]
  v_mfma_f32_16x16x32_bf16 v[48:51], a[236:239], a[220:223], v[48:51]
  v_mfma_f32_16x16x32_bf16 v[52:55], a[240:243], a[208:211], 0
  v_mfma_f32_16x16x32_bf16 v[52:55], a[244:247], a[212:215], v[52:55]
  v_mfma_f32_16x16x32_bf16 v[52:55], a[248:251], a[216:219], v[52:55]
  v_mfma_f32_16x16x32_bf16 v[52:55], a[252:255], a[220:223], v[52:55]
  s_nop 7
  v_max3_f32 v144, v0, v1, v144
  v_max3_f32 v144, v2, v3, v144
  v_max3_f32 v144, v4, v5, v144
  v_max3_f32 v144, v6, v7, v144
  v_max3_f32 v145, v8, v9, v145
  v_max3_f32 v145, v10, v11, v145
  v_max3_f32 v145, v12, v13, v145
  v_max3_f32 v145, v14, v15, v145
  v_max3_f32 v146, v16, v17, v146
  v_max3_f32 v146, v18, v19, v146
  v_max3_f32 v146, v20, v21, v146
  v_max3_f32 v146, v22, v23, v146
  v_max3_f32 v147, v24, v25, v147
  v_max3_f32 v147, v26, v27, v147
  v_max3_f32 v147, v28, v29, v147
  v_max3_f32 v147, v30, v31, v147
  v_max3_f32 v148, v32, v33, v148
  v_max3_f32 v148, v34, v35, v148
  v_max3_f32 v148, v36, v37, v148
  v_max3_f32 v148, v38, v39, v148
  v_max3_f32 v149, v40, v41, v149
  v_max3_f32 v149, v42, v43, v149
  v_max3_f32 v149, v44, v45, v149
  v_max3_f32 v149, v46, v47, v149
  v_max3_f32 v150, v48, v49, v150
  v_max3_f32 v150, v50, v51, v150
  v_max3_f32 v150, v52, v53, v150
  v_max3_f32 v150, v54, v55, v150
  s_sub_u32 s30, s30, 1
  s_cmp_lg_u32 s30, 0
  s_cbranch_scc1 L1_B_maxloop
  s_barrier
  s_mov_b32 s26, 0
  s_mov_b32 s27, 0
  s_add_u32 m0, s27, s28
  s_add_u32 s29, s26, 4096
  buffer_load_dwordx4 v240, s[12:15], s26 offen offset:0 nt lds
  buffer_load_dwordx4 v241, s[12:15], s26 offen offset:1024 nt lds
  buffer_load_dwordx4 v240, s[12:15], s26 offen offset:2048 nt lds
  buffer_load_dwordx4 v241, s[12:15], s26 offen offset:3072 nt lds
  s_add_u32 m0, m0, 4096
  s_xor_b32 s27, s27, 0x10000
  buffer_load_dwordx4 v240, s[12:15], s29 offen offset:0 nt lds
  buffer_load_dwordx4 v241, s[12:15], s29 offen offset:1024 nt lds
  buffer_load_dwordx4 v240, s[12:15], s29 offen offset:2048 nt lds
  buffer_load_dwordx4 v241, s[12:15], s29 offen offset:3072 nt lds
  s_add_u32 m0, m0, 4096
  s_nop 0
  buffer_load_dwordx4 v240, s[32:35], s26 offen offset:0 nt lds
  buffer_load_dwordx4 v241, s[32:35], s26 offen offset:1024 nt lds
  buffer_load_dwordx4 v240, s[32:35], s26 offen offset:2048 nt lds
  buffer_load_dwordx4 v241, s[32:35], s26 offen offset:3072 nt lds
  s_add_u32 m0, m0, 4096
  s_nop 0
  buffer_load_dwordx4 v240, s[32:35], s29 offen offset:0 nt lds
  buffer_load_dwordx4 v241, s[32:35], s29 offen offset:1024 nt lds
  buffer_load_dwordx4 v240, s[32:35], s29 offen offset:2048 nt lds
  buffer_load_dwordx4 v241, s[32:35], s29 offen offset:3072 nt lds
  s_add_u32 s26, s26, 8192
  v_and_b32 v243, 15, v242
  v_lshlrev_b32 v243, 4, v243
  s_mul_i32 s30, s21, 3584
  s_add_u32 s30, s30, 131072
  v_add_u32 v243, s30, v243
  s_mul_i32 s30, s22, 1792
  v_lshrrev_b32 v244, 4, v242
  v_lshl_add_u32 v244, v244, 2, s30
  v_add_u32 v244, v243, v244
  ds_write_b32 v244, v144 offset:0
  ds_write_b32 v244, v145 offset:256
  ds_write_b32 v244, v146 offset:512
  ds_write_b32 v244, v147 offset:768
  ds_write_b32 v244, v148 offset:1024
  ds_write_b32 v244, v149 offset:1280
  ds_write_b32 v244, v150 offset:1536
  s_waitcnt vmcnt(0) lgkmcnt(0)
  s_barrier
  ds_read_b128 a[224:227], v228 offset:0
  ds_read_b128 a[228:231], v229 offset:0
  ds_read_b128 a[232:235], v230 offset:0
  ds_read_b128 a[236:239], v231 offset:0
  ds_read_b128 a[240:243], v228 offset:4096
  ds_read_b128 a[244:247], v229 offset:4096
  ds_read_b128 a[248:251], v230 offset:4096
  ds_read_b128 a[252:255], v231 offset:4096
  s_waitcnt lgkmcnt(0)
  ds_read_b128 v[0:3], v243 offset:0
  ds_read_b128 v[4:7], v243 offset:1792
  ds_read_b128 v[8:11], v243 offset:256
  ds_read_b128 v[12:15], v243 offset:2048
  ds_read_b128 v[16:19], v243 offset:512
  ds_read_b128 v[20:23], v243 offset:2304
  ds_read_b128 v[24:27], v243 offset:768
  ds_read_b128 v[28:31], v243 offset:2560
  ds_read_b128 v[32:35], v243 offset:1024
  ds_read_b128 v[36:39], v243 offset:2816
  ds_read_b128 v[40:43], v243 offset:1280
  ds_read_b128 v[44:47], v243 offset:3072
  ds_read_b128 v[48:51], v243 offset:1536
  ds_read_b128 v[52:55], v243 offset:3328
  s_waitcnt lgkmcnt(0)
  v_max3_f32 v0, v0, v1, v2
  v_max3_f32 v3, v3, v4, v5
  v_max3_f32 v0, v0, v6, v7
  v_max_f32 v0, v0, v3
  v_sub_f32 v168, 0, v0
  v_sub_f32 v169, 0, v0
  v_sub_f32 v170, 0, v0
  v_sub_f32 v171, 0, v0
  v_max3_f32 v8, v8, v9, v10
  v_max3_f32 v11, v11, v12, v13
  v_max3_f32 v8, v8, v14, v15
  v_max_f32 v8, v8, v11
  v_sub_f32 v172, 0, v8
  v_sub_f32 v173, 0, v8
  v_sub_f32 v174, 0, v8
  v_sub_f32 v175, 0, v8
  v_max3_f32 v16, v16, v17, v18
  v_max3_f32 v19, v19, v20, v21
  v_max3_f32 v16, v16, v22, v23
  v_max_f32 v16, v16, v19
  v_sub_f32 v176, 0, v16
  v_sub_f32 v177, 0, v16
  v_sub_f32 v178, 0, v16
  v_sub_f32 v179, 0, v16
  v_max3_f32 v24, v24, v25, v26
  v_max3_f32 v27, v27, v28, v29
  v_max3_f32 v24, v24, v30, v31
  v_max_f32 v24, v24, v27
  v_sub_f32 v180, 0, v24
  v_sub_f32 v181, 0, v24
  v_sub_f32 v182, 0, v24
  v_sub_f32 v183, 0, v24
  v_max3_f32 v32, v32, v33, v34
  v_max3_f32 v35, v35, v36, v37
  v_max3_f32 v32, v32, v38, v39
  v_max_f32 v32, v32, v35
  v_sub_f32 v184, 0, v32
  v_sub_f32 v185, 0, v32
  v_sub_f32 v186, 0, v32
  v_sub_f32 v187, 0, v32
  v_max3_f32 v40, v40, v41, v42
  v_max3_f32 v43, v43, v44, v45
  v_max3_f32 v40, v40, v46, v47
  v_max_f32 v40, v40, v43
  v_sub_f32 v188, 0, v40
  v_sub_f32 v189, 0, v40
  v_sub_f32 v190, 0, v40
  v_sub_f32 v191, 0, v40
  v_max3_f32 v48, v48, v49, v50
  v_max3_f32 v51, v51, v52, v53
  v_max3_f32 v48, v48, v54, v55
  v_max_f32 v48, v48, v51
  v_sub_f32 v192, 0, v48
  v_sub_f32 v193, 0, v48
  v_sub_f32 v194, 0, v48
  v_sub_f32 v195, 0, v48
  s_barrier
  s_nop 1
  s_branch L1_B_go
L1_A_fallback:
  s_mov_b32 s31, 1
  s_mov_b32 s26, 0
  s_mov_b32 s14, 0x20000
  s_mov_b32 s34, 0x20000
  s_mov_b32 s30, 16
  v_and_b32 v228, 0xffff, v228
  v_and_b32 v229, 0xffff, v229
  v_and_b32 v230, 0xffff, v230
  v_and_b32 v231, 0xffff, v231
  v_and_b32 v232, 0xffff, v232
  v_and_b32 v233, 0xffff, v233
  v_and_b32 v234, 0xffff, v234
  v_and_b32 v235, 0xffff, v235
  v_and_b32 v236, 0xffff, v236
  v_and_b32 v237, 0xffff, v237
  v_and_b32 v238, 0xffff, v238
  v_and_b32 v239, 0xffff, v239
  s_waitcnt lgkmcnt(0)
  v_mov_b32 v144, 0xff800000
  v_mov_b32 v145, 0xff800000
  v_mov_b32 v146, 0xff800000
  v_mov_b32 v147, 0xff800000
  v_mov_b32 v148, 0xff800000
  v_mov_b32 v149, 0xff800000
  v_mov_b32 v150, 0xff800000
L1_A_maxloop:
  s_barrier
  s_mov_b32 s27, 0
  s_add_u32 m0, s27, s28
  s_add_u32 s29, s26, 4096
  buffer_load_dwordx4 v240, s[12:15], s26 offen offset:0 nt lds
  buffer_load_dwordx4 v241, s[12:15], s26 offen offset:1024 nt lds
  buffer_load_dwordx4 v240, s[12:15], s26 offen offset:2048 nt lds
  buffer_load_dwordx4 v241, s[12:15], s26 offen offset:3072 nt lds
  s_add_u32 m0, m0, 4096
  s_add_u32 s27, s27, 0x8000
  buffer_load_dwordx4 v240, s[12:15], s29 offen offset:0 nt lds
  buffer_load_dwordx4 v241, s[12:15], s29 offen offset:1024 nt lds
  buffer_load_dwordx4 v240, s[12:15], s29 offen offset:2048 nt lds
  buffer_load_dwordx4 v241, s[12:15], s29 offen offset:3072 nt lds
  s_add_u32 s26, s26, 8192
  s_and_b32 s27, s27, 0x1ffff
  s_waitcnt vmcnt(0)
  s_barrier
  ds_read_b128 a[224:227], v228 offset:0
  ds_read_b128 a[228:231], v229 offset:0
  ds_read_b128 a[232:235], v230 offset:0
  ds_read_b128 a[236:239], v231 offset:0
  ds_read_b128 a[240:243], v228 offset:4096
  ds_read_b128 a[244:247], v229 offset:4096
  ds_read_b128 a[248:251], v230 offset:4096
  ds_read_b128 a[252:255], v231 offset:4096
  s_waitcnt lgkmcnt(0)
  v_mfma_f32_16x16x32_bf16 v[0:3], a[224:227], a[112:115], 0
  v_mfma_f32_16x16x32_bf16 v[0:3], a[228:231], a[116:119], v[0:3]
  v_mfma_f32_16x16x32_bf16 v[0:3], a[232:235], a[120:123], v[0:3]
  v_mfma_f32_16x16x32_bf16 v[0:3], a[236:239], a[124:127], v[0:3]
  v_mfma_f32_16x16x32_bf16 v[4:7], a[240:243], a[112:115], 0
  v_mfma_f32_16x16x32_bf16 v[4:7], a[244:247], a[116:119], v[4:7]
  v_mfma_f32_16x16x32_bf16 v[4:7], a[248:251], a[120:123], v[4:7]
  v_mfma_f32_16x16x32_bf16 v[4:7], a[252:255], a[124:127], v[4:7]
  v_mfma_f32_16x16x32_bf16 v[8:11], a[224:227], a[128:131], 0
  v_mfma_f32_16x16x32_bf16 v[8:11], a[228:231], a[132:135], v[8:11]
  v_mfma_f32_16x16x32_bf16 v[8:11], a[232:235], a[136:139], v[8:11]
  v_mfma_f32_16x16x32_bf16 v[8:11], a[236:239], a[140:143], v[8:11]
  v_mfma_f32_16x16x32_bf16 v[12:15], a[240:243], a[128:131], 0
  v_mfma_f32_16x16x32_bf16 v[12:15], a[244:247], a[132:135], v[12:15]
  v_mfma_f32_16x16x32_bf16 v[12:15], a[248:251], a[136:139], v[12:15]
  v_mfma_f32_16x16x32_bf16 v[12:15], a[252:255], a[140:143], v[12:15]
  v_mfma_f32_16x16x32_bf16 v[16:19], a[224:227], a[144:147], 0
  v_mfma_f32_16x16x32_bf16 v[16:19], a[228:231], a[148:151], v[16:19]
  v_mfma_f32_16x16x32_bf16 v[16:19], a[232:235], a[152:155], v[16:19]
  v_mfma_f32_16x16x32_bf16 v[16:19], a[236:239], a[156:159], v[16:19]
  v_mfma_f32_16x16x32_bf16 v[20:23], a[240:243], a[144:147], 0
  v_mfma_f32_16x16x32_bf16 v[20:23], a[244:247], a[148:151], v[20:23]
  v_mfma_f32_16x16x32_bf16 v[20:23], a[248:251], a[152:155], v[20:23]
  v_mfma_f32_16x16x32_bf16 v[20:23], a[252:255], a[156:159], v[20:23]
  v_mfma_f32_16x16x32_bf16 v[24:27], a[224:227], a[160:163], 0
  v_mfma_f32_16x16x32_bf16 v[24:27], a[228:231], a[164:167], v[24:27]
  v_mfma_f32_16x16x32_bf16 v[24:27], a[232:235], a[168:171], v[24:27]
  v_mfma_f32_16x16x32_bf16 v[24:27], a[236:239], a[172:175], v[24:27]
  v_mfma_f32_16x16x32_bf16 v[28:31], a[240:243], a[160:163], 0
  v_mfma_f32_16x16x32_bf16 v[28:31], a[244:247], a[164:167], v[28:31]
  v_mfma_f32_16x16x32_bf16 v[28:31], a[248:251], a[168:171], v[28:31]
  v_mfma_f32_16x16x32_bf16 v[28:31], a[252:255], a[172:175], v[28:31]
  v_mfma_f32_16x16x32_bf16 v[32:35], a[224:227], a[176:179], 0
  v_mfma_f32_16x16x32_bf16 v[32:35], a[228:231], a[180:183], v[32:35]
  v_mfma_f32_16x16x32_bf16 v[32:35], a[232:235], a[184:187], v[32:35]
  v_mfma_f32_16x16x32_bf16 v[32:35], a[236:239], a[188:191], v[32:35]
  v_mfma_f32_16x16x32_bf16 v[36:39], a[240:243], a[176:179], 0
  v_mfma_f32_16x16x32_bf16 v[36:39], a[244:247], a[180:183], v[36:39]
  v_mfma_f32_16x16x32_bf16 v[36:39], a[248:251], a[184:187], v[36:39]
  v_mfma_f32_16x16x32_bf16 v[36:39], a[252:255], a[188:191], v[36:39]
  v_mfma_f32_16x16x32_bf16 v[40:43], a[224:227], a[192:195], 0
  v_mfma_f32_16x16x32_bf16 v[40:43], a[228:231], a[196:199], v[40:43]
  v_mfma_f32_16x16x32_bf16 v[40:43], a[232:235], a[200:203], v[40:43]
  v_mfma_f32_16x16x32_bf16 v[40:43], a[236:239], a[204:207], v[40:43]
  v_mfma_f32_16x16x32_bf16 v[44:47], a[240:243], a[192:195], 0
  v_mfma_f32_16x16x32_bf16 v[44:47], a[244:247], a[196:199], v[44:47]
  v_mfma_f32_16x16x32_bf16 v[44:47], a[248:251], a[200:203], v[44:47]
  v_mfma_f32_16x16x32_bf16 v[44:47], a[252:255], a[204:207], v[44:47]
  v_mfma_f32_16x16x32_bf16 v[48:51], a[224:227], a[208:211], 0
  v_mfma_f32_16x16x32_bf16 v[48:51], a[228:231], a[212:215], v[48:51]
  v_mfma_f32_16x16x32_bf16 v[48:51], a[232:235], a[216:219], v[48:51]
  v_mfma_f32_16x16x32_bf16 v[48:51], a[236:239], a[220:223], v[48:51]
  v_mfma_f32_16x16x32_bf16 v[52:55], a[240:243], a[208:211], 0
  v_mfma_f32_16x16x32_bf16 v[52:55], a[244:247], a[212:215], v[52:55]
  v_mfma_f32_16x16x32_bf16 v[52:55], a[248:251], a[216:219], v[52:55]
  v_mfma_f32_16x16x32_bf16 v[52:55], a[252:255], a[220:223], v[52:55]
  s_nop 7
  v_max3_f32 v144, v0, v1, v144
  v_max3_f32 v144, v2, v3, v144
  v_max3_f32 v144, v4, v5, v144
  v_max3_f32 v144, v6, v7, v144
  v_max3_f32 v145, v8, v9, v145
  v_max3_f32 v145, v10, v11, v145
  v_max3_f32 v145, v12, v13, v145
  v_max3_f32 v145, v14, v15, v145
  v_max3_f32 v146, v16, v17, v146
  v_max3_f32 v146, v18, v19, v146
  v_max3_f32 v146, v20, v21, v146
  v_max3_f32 v146, v22, v23, v146
  v_max3_f32 v147, v24, v25, v147
  v_max3_f32 v147, v26, v27, v147
  v_max3_f32 v147, v28, v29, v147
  v_max3_f32 v147, v30, v31, v147
  v_max3_f32 v148, v32, v33, v148
  v_max3_f32 v148, v34, v35, v148
  v_max3_f32 v148, v36, v37, v148
  v_max3_f32 v148, v38, v39, v148
  v_max3_f32 v149, v40, v41, v149
  v_max3_f32 v149, v42, v43, v149
  v_max3_f32 v149, v44, v45, v149
  v_max3_f32 v149, v46, v47, v149
  v_max3_f32 v150, v48, v49, v150
  v_max3_f32 v150, v50, v51, v150
  v_max3_f32 v150, v52, v53, v150
  v_max3_f32 v150, v54, v55, v150
  s_sub_u32 s30, s30, 1
  s_cmp_lg_u32 s30, 0
  s_cbranch_scc1 L1_A_maxloop
  s_barrier
  s_mov_b32 s26, 0
  s_mov_b32 s27, 0
  s_add_u32 m0, s27, s28
  s_add_u32 s29, s26, 4096
  buffer_load_dwordx4 v240, s[12:15], s26 offen offset:0 nt lds
  buffer_load_dwordx4 v241, s[12:15], s26 offen offset:1024 nt lds
  buffer_load_dwordx4 v240, s[12:15], s26 offen offset:2048 nt lds
  buffer_load_dwordx4 v241, s[12:15], s26 offen offset:3072 nt lds
  s_add_u32 m0, m0, 4096
  s_add_u32 s27, s27, 0x8000
  buffer_load_dwordx4 v240, s[12:15], s29 offen offset:0 nt lds
  buffer_load_dwordx4 v241, s[12:15], s29 offen offset:1024 nt lds
  buffer_load_dwordx4 v240, s[12:15], s29 offen offset:2048 nt lds
  buffer_load_dwordx4 v241, s[12:15], s29 offen offset:3072 nt lds
  s_add_u32 s26, s26, 8192
  s_and_b32 s27, s27, 0x1ffff
  s_add_u32 m0, s27, s28
  s_add_u32 s29, s26, 4096
  buffer_load_dwordx4 v240, s[12:15], s26 offen offset:0 nt lds
  buffer_load_dwordx4 v241, s[12:15], s26 offen offset:1024 nt lds
  buffer_load_dwordx4 v240, s[12:15], s26 offen offset:2048 nt lds
  buffer_load_dwordx4 v241, s[12:15], s26 offen offset:3072 nt lds
  s_add_u32 m0, m0, 4096
  s_add_u32 s27, s27, 0x8000
  buffer_load_dwordx4 v240, s[12:15], s29 offen offset:0 nt lds
  buffer_load_dwordx4 v241, s[12:15], s29 offen offset:1024 nt lds
  buffer_load_dwordx4 v240, s[12:15], s29 offen offset:2048 nt lds
  buffer_load_dwordx4 v241, s[12:15], s29 offen offset:3072 nt lds
  s_add_u32 s26, s26, 8192
  s_and_b32 s27, s27, 0x1ffff
  v_and_b32 v243, 15, v242
  v_lshlrev_b32 v243, 4, v243
  s_mul_i32 s30, s21, 3584
  s_add_u32 s30, s30, 131072
  v_add_u32 v243, s30, v243
  s_mul_i32 s30, s22, 1792
  v_lshrrev_b32 v244, 4, v242
  v_lshl_add_u32 v244, v244, 2, s30
  v_add_u32 v244, v243, v244
  ds_write_b32 v244, v144 offset:0
  ds_write_b32 v244, v145 offset:256
  ds_write_b32 v244, v146 offset:512
  ds_write_b32 v244, v147 offset:768
  ds_write_b32 v244, v148 offset:1024
  ds_write_b32 v244, v149 offset:1280
  ds_write_b32 v244, v150 offset:1536
  s_waitcnt vmcnt(0) lgkmcnt(0)
  s_barrier
  ds_read_b128 a[224:227], v228 offset:0
  ds_read_b128 a[228:231], v229 offset:0
  ds_read_b128 a[232:235], v230 offset:0
  ds_read_b128 a[236:239], v231 offset:0
  ds_read_b128 a[240:243], v228 offset:4096
  ds_read_b128 a[244:247], v229 offset:4096
  ds_read_b128 a[248:251], v230 offset:4096
  ds_read_b128 a[252:255], v231 offset:4096
  s_waitcnt lgkmcnt(0)
  ds_read_b128 v[0:3], v243 offset:0
  ds_read_b128 v[4:7], v243 offset:1792
  ds_read_b128 v[8:11], v243 offset:256
  ds_read_b128 v[12:15], v243 offset:2048
  ds_read_b128 v[16:19], v243 offset:512
  ds_read_b128 v[20:23], v243 offset:2304
  ds_read_b128 v[24:27], v243 offset:768
  ds_read_b128 v[28:31], v243 offset:2560
  ds_read_b128 v[32:35], v243 offset:1024
  ds_read_b128 v[36:39], v243 offset:2816
  ds_read_b128 v[40:43], v243 offset:1280
  ds_read_b128 v[44:47], v243 offset:3072
  ds_read_b128 v[48:51], v243 offset:1536
  ds_read_b128 v[52:55], v243 offset:3328
  s_waitcnt lgkmcnt(0)
  v_max3_f32 v0, v0, v1, v2
  v_max3_f32 v3, v3, v4, v5
  v_max3_f32 v0, v0, v6, v7
  v_max_f32 v0, v0, v3
  v_sub_f32 v168, 0, v0
  v_sub_f32 v169, 0, v0
  v_sub_f32 v170, 0, v0
  v_sub_f32 v171, 0, v0
  v_max3_f32 v8, v8, v9, v10
  v_max3_f32 v11, v11, v12, v13
  v_max3_f32 v8, v8, v14, v15
  v_max_f32 v8, v8, v11
  v_sub_f32 v172, 0, v8
  v_sub_f32 v173, 0, v8
  v_sub_f32 v174, 0, v8
  v_sub_f32 v175, 0, v8
  v_max3_f32 v16, v16, v17, v18
  v_max3_f32 v19, v19, v20, v21
  v_max3_f32 v16, v16, v22, v23
  v_max_f32 v16, v16, v19
  v_sub_f32 v176, 0, v16
  v_sub_f32 v177, 0, v16
  v_sub_f32 v178, 0, v16
  v_sub_f32 v179, 0, v16
  v_max3_f32 v24, v24, v25, v26
  v_max3_f32 v27, v27, v28, v29
  v_max3_f32 v24, v24, v30, v31
  v_max_f32 v24, v24, v27
  v_sub_f32 v180, 0, v24
  v_sub_f32 v181, 0, v24
  v_sub_f32 v182, 0, v24
  v_sub_f32 v183, 0, v24
  v_max3_f32 v32, v32, v33, v34
  v_max3_f32 v35, v35, v36, v37
  v_max3_f32 v32, v32, v38, v39
  v_max_f32 v32, v32, v35
  v_sub_f32 v184, 0, v32
  v_sub_f32 v185, 0, v32
  v_sub_f32 v186, 0, v32
  v_sub_f32 v187, 0, v32
  v_max3_f32 v40, v40, v41, v42
  v_max3_f32 v43, v43, v44, v45
  v_max3_f32 v40, v40, v46, v47
  v_max_f32 v40, v40, v43
  v_sub_f32 v188, 0, v40
  v_sub_f32 v189, 0, v40
  v_sub_f32 v190, 0, v40
  v_sub_f32 v191, 0, v40
  v_max3_f32 v48, v48, v49, v50
  v_max3_f32 v51, v51, v52, v53
  v_max3_f32 v48, v48, v54, v55
  v_max_f32 v48, v48, v51
  v_sub_f32 v192, 0, v48
  v_sub_f32 v193, 0, v48
  v_sub_f32 v194, 0, v48
  v_sub_f32 v195, 0, v48
  s_barrier
  s_nop 1
  s_branch L1_A_go
L1_end:
  s_endpgm
.section .rodata,"a"
.p2align 6
.amdhsa_kernel concat_heads__gqa_block_cached__mha_block_cached__near_ridge_kernel
  .amdhsa_next_free_vgpr 512
  .amdhsa_next_free_sgpr 102
  .amdhsa_accum_offset 256
  .amdhsa_group_segment_fixed_size 0
  .amdhsa_kernarg_size 104
  .amdhsa_user_sgpr_count 2
  .amdhsa_user_sgpr_kernarg_segment_ptr 1
  .amdhsa_system_sgpr_workgroup_id_x 1
.end_amdhsa_kernel
```
